```python
import torch

def _softmax(x, axis=-1):
    return torch.softmax(x, dim=axis)
def _gelu(x):
    return torch.nn.functional.gelu(x, approximate="tanh")
def _silu(x):
    return torch.nn.functional.silu(x)
def _sigmoid(x):
    return torch.sigmoid(x)
def _layernorm(x, axis=-1, eps=1e-5):
    m = x.mean(dim=axis, keepdim=True)
    v = x.var(dim=axis, keepdim=True, unbiased=False)
    return (x - m) / torch.sqrt(v + eps)
def _scatter_add(tgt, idx, src, axis=0):
    return tgt.clone().index_add_(axis, idx, src)
def _segment_sum(src, seg, n):
    out = torch.zeros((n,) + src.shape[1:], dtype=src.dtype)
    return out.index_add_(0, seg, src)
def _pad(x, pw):
    flat = tuple(v for pair in reversed(pw) for v in pair)
    return torch.nn.functional.pad(x, flat)

kernel_name = 'recurrent_scan__sliding_local_dilated__glu_gated_glu__prompt'

def setup_inputs():

    _w = (lambda a: (lambda t: t.to(torch.bfloat16) if t.is_floating_point() else t)(torch.as_tensor(a)))
    def _A_setup():
        B, S, D = 1, 2048, 512
        return {
            "x": _w((lambda *s: torch.randn(*s, dtype=torch.bfloat16) * 0.05)(B, S, D)),
            "wqkv": _w((lambda *s: torch.randn(*s, dtype=torch.bfloat16) * 0.05)(D, 3 * D)),
            "wo": _w((lambda *s: torch.randn(*s, dtype=torch.bfloat16) * 0.05)(D, D)),
        }
    _A_in = _A_setup()

    def _B_setup():
        B, S, D, F = 1, 2048, 512, 1792
        return {
            "x": _w((lambda *s: torch.randn(*s, dtype=torch.bfloat16) * 0.05)(B, S, D)),
            "w_gate": _w((lambda *s: torch.randn(*s, dtype=torch.bfloat16) * 0.05)(D, F)),
            "w_up": _w((lambda *s: torch.randn(*s, dtype=torch.bfloat16) * 0.05)(D, F)),
            "w_down": _w((lambda *s: torch.randn(*s, dtype=torch.bfloat16) * 0.05)(F, D)),
        }
    _B_in = _B_setup()

    return {
        "A_x": _A_in["x"],
        "A_wqkv": _A_in["wqkv"],
        "A_wo": _A_in["wo"],
        "B_x": _B_in["x"],
        "B_w_gate": _B_in["w_gate"],
        "B_w_up": _B_in["w_up"],
        "B_w_down": _B_in["w_down"],
    }

def reference(A_x, A_wqkv, A_wo, B_x, B_w_gate, B_w_up, B_w_down):
    def _A_ref(x, wqkv, wo):
        B, S, D = x.shape
        H = 32; Dh = D // H
        W, dil = 8, 2
        qkv = (lambda x, *d: x.permute(*d))((x @ wqkv).reshape(B, S, 3, H, Dh), 2, 0, 3, 1, 4)
        q, k, v = qkv[0], qkv[1], qkv[2]
        scale = Dh ** -0.5
        pos = torch.arange(S)
        off = torch.arange(W) * dil
        idx = pos[:, None] - off[None, :]
        mask = idx >= 0
        idx_c = torch.where(mask, idx, 0).reshape(-1)
        kg = k[:, :, idx_c, :].reshape(B, H, S, W, Dh)
        vg = v[:, :, idx_c, :].reshape(B, H, S, W, Dh)
        logits = torch.einsum("bhsd,bhswd->bhsw", q, kg) * scale
        logits = torch.where(mask[None, None, :, :], logits, -1e9)
        attn = _softmax(logits, axis=-1)
        o = torch.einsum("bhsw,bhswd->bhsd", attn, vg)
        return (lambda x, *d: x.permute(*d))(o, 0, 2, 1, 3).reshape(B, S, D) @ wo

    def _B_ref(x, w_gate, w_up, w_down):
        g = torch.einsum("bsd,df->bsf", x, w_gate)
        u = torch.einsum("bsd,df->bsf", x, w_up)
        h = _sigmoid(g) * u
        return torch.einsum("bsf,fd->bsd", h, w_down)

    x = A_x
    xn = _layernorm(x, axis=-1)
    s = _A_ref(xn, A_wqkv, A_wo)
    g = _silu(_B_ref(xn, B_w_gate, B_w_up, B_w_down))
    return x + s * g
```

```asm
; @launch grid=(256,1,1) block=(512,1,1) lds=163840
.amdgcn_target "amdgcn-amd-amdhsa--gfx950"
.text
.globl recurrent_scan__sliding_local_dilated__glu_gated_glu__prompt_kernel
.p2align 8
.type recurrent_scan__sliding_local_dilated__glu_gated_glu__prompt_kernel,@function
recurrent_scan__sliding_local_dilated__glu_gated_glu__prompt_kernel:
s_cmp_ge_u32 s2, 256
s_cbranch_scc1 L_done
s_load_dwordx16 s[64:79], s[0:1], 0
s_load_dwordx4 s[80:83], s[0:1], 64
s_getpc_b64 s[48:49]
L_pc:
s_bfe_u32 s50, s2, 0x40003
v_lshrrev_b32 v1, 5, v0
v_lshlrev_b32 v10, 7, v0
v_cmp_eq_u32 vcc, s50, v1
s_cbranch_vccz L_nopf
s_mov_b64 exec, vcc
v_min_u32 v10, L_end - L_pc, v10
global_load_dword v255, v10, s[48:49]
s_mov_b64 exec, -1
s_nop 3
L_nopf:
v_lshrrev_b32 v1, 6, v0
s_bfe_u32 s47, s2, 0x30003
v_readfirstlane_b32 s3, v1
v_and_b32 v1, 63, v0
v_lshrrev_b32 v2, 4, v1
v_and_b32 v3, 15, v1
s_and_b32 s48, s2, 1
s_lshl3_add_u32 s40, s48, s47
s_lshl_b32 s57, s48, 2
s_mul_i32 s20, s48, 786432
s_mul_i32 s21, s48, 917504
s_lshl_b32 s22, s48, 9
s_and_b32 s48, s2, 6
s_bfe_u32 s49, s2, 0x10006
s_add_u32 s41, s48, s49
s_and_b32 s42, s3, 3
s_lshl_b32 s43, s42, 10
s_lshl_b32 s86, s42, 12
s_add_u32 s44, s86, 83968
s_and_b32 s48, s2, 7
s_lshr_b32 s49, s2, 6
s_lshl2_add_u32 s84, s48, s49
s_mov_b32 s85, s47
s_lshr_b32 s48, s2, 7
s_lshl3_add_u32 s62, s48, s41
s_lshl_b32 s87, s40, 11
s_lshl2_add_u32 s87, s62, s87
s_add_u32 s87, s87, 9805824
v_mov_b32 v10, 162048
v_mov_b32 v12, 0
v_mov_b32_e64 v13, 0
ds_write_b32 v10, v12 offset:8
ds_write_b64 v10, v[12:13] offset:16
ds_write_b64 v10, v[12:13] offset:24
ds_write_b32 v10, v12 offset:576
ds_write_b32 v10, v12 offset:832
ds_write_b32 v10, v12 offset:1088
s_lshr_b32 s48, s41, 1
s_mul_i32 s48, s48, 896
s_bfe_u32 s49, s2, 0x20006
s_lshl_b32 s49, s49, 7
s_add_u32 s52, s48, s49
s_cmp_ge_u32 s3, 4
s_cbranch_scc1 L_F16
s_mov_b32 s56, s48
v_lshrrev_b32 v10, 3, v1
v_and_b32 v11, 7, v1
v_lshrrev_b32 v14, 1, v10
v_xor_b32 v14, v14, v11
v_lshlrev_b32 v14, 4, v14
v_lshl_add_u32 v14, v10, 10, v14
v_xor_b32 v15, 64, v14
v_add_u32 v15, 8192, v15
s_lshl_b32 s48, s40, 17
s_lshl_b32 s49, s42, 15
s_add_u32 s48, s48, s49
v_add_u32 v28, s48, v14
v_add_u32 v29, s48, v15
s_waitcnt lgkmcnt(0)
s_mov_b32 s4, s64
s_and_b32 s5, s65, 0xffff
s_mov_b32 s6, 2097152
s_mov_b32 s7, 0x20000
s_add_u32 m0, s44, 0
s_add_u32 s46, s22, 0
buffer_load_dwordx4 v28, s[4:7], s46 offen lds
s_add_u32 m0, s44, 1024
s_add_u32 s46, s22, 0
buffer_load_dwordx4 v29, s[4:7], s46 offen lds
s_add_u32 m0, s44, 2048
s_add_u32 s46, s22, 16384
buffer_load_dwordx4 v28, s[4:7], s46 offen lds
s_add_u32 m0, s44, 3072
s_add_u32 s46, s22, 16384
buffer_load_dwordx4 v29, s[4:7], s46 offen lds
s_add_u32 m0, s44, 18432
s_add_u32 s46, s22, 128
buffer_load_dwordx4 v28, s[4:7], s46 offen lds
s_add_u32 m0, s44, 19456
s_add_u32 s46, s22, 128
buffer_load_dwordx4 v29, s[4:7], s46 offen lds
s_add_u32 m0, s44, 20480
s_add_u32 s46, s22, 16512
buffer_load_dwordx4 v28, s[4:7], s46 offen lds
s_add_u32 m0, s44, 21504
s_add_u32 s46, s22, 16512
buffer_load_dwordx4 v29, s[4:7], s46 offen lds
s_lshl_b32 s45, s41, 7
s_bitcmp1_b32 s2, 7
s_cbranch_scc0 L_H
s_and_b32 s49, s41, 1
s_lshl_b32 s50, s49, 8
s_lshl_b32 s49, s49, 6
s_add_u32 s45, s56, s50
s_add_u32 s45, s45, 512
s_add_u32 s53, s56, s49
s_add_u32 s53, s53, 640
s_branch L_F24
L_done:
s_endpgm
.p2align 3
L_F16:
v_lshrrev_b32 v10, 3, v1
v_and_b32 v11, 7, v1
v_and_b32 v12, 2, v10
s_and_b32 s48, s42, 1
s_lshl_b32 s48, s48, 2
v_or_b32 v12, s48, v12
v_xor_b32 v12, v12, v11
v_lshlrev_b32 v12, 4, v12
v_lshl_add_u32 v13, s42, 3, v10
v_mul_u32_u24 v30, 3584, v13
v_add_u32 v30, v30, v12
v_add_u32 v30, s52, v30
s_add_u32 s48, s62, 16
s_max_u32 s49, s40, 1
s_sub_u32 s49, s49, 1
s_lshl_b32 s48, s48, 8
s_mul_i32 s49, s49, 0x01010000
s_or_b32 s48, s48, s40
s_or_b32 s48, s48, s49
v_lshlrev_b32_e64 v11, 3, v2
v_lshrrev_b32 v32, v11, s48
v_and_b32 v32, 0xff, v32
v_lshlrev_b32_e64 v32, 7, v32
v_lshl_add_u32 v32, v3, 2, v32
v_add_u32 v32, 9437184, v32
s_waitcnt lgkmcnt(0)
s_mov_b32 s24, s82
s_and_b32 s25, s83, 0xffff
s_mov_b32 s26, 9838592
s_mov_b32 s27, 0x20000
buffer_load_dword v31, v32, s[24:27], 0 offen sc1
s_mov_b32 s12, s72
s_and_b32 s13, s73, 0xffff
s_mov_b32 s14, 1835008
s_mov_b32 s15, 0x20000
s_mov_b32 s16, s74
s_and_b32 s17, s75, 0xffff
s_mov_b32 s18, 1835008
s_mov_b32 s19, 0x20000
s_add_u32 m0, s43, 0
s_add_u32 s46, s21, 0
buffer_load_dwordx4 v30, s[12:15], s46 offen lds
s_add_u32 m0, s43, 4096
s_add_u32 s46, s21, 0
buffer_load_dwordx4 v30, s[16:19], s46 offen lds
s_add_u32 m0, s43, 8192
s_add_u32 s46, s21, 114688
buffer_load_dwordx4 v30, s[12:15], s46 offen lds
s_add_u32 m0, s43, 12288
s_add_u32 s46, s21, 114688
buffer_load_dwordx4 v30, s[16:19], s46 offen lds
s_add_u32 m0, s43, 16384
s_add_u32 s46, s21, 229376
buffer_load_dwordx4 v30, s[12:15], s46 offen lds
s_add_u32 m0, s43, 20480
s_add_u32 s46, s21, 229376
buffer_load_dwordx4 v30, s[16:19], s46 offen lds
s_add_u32 m0, s43, 24576
s_add_u32 s46, s21, 344064
buffer_load_dwordx4 v30, s[12:15], s46 offen lds
s_add_u32 m0, s43, 28672
s_add_u32 s46, s21, 344064
buffer_load_dwordx4 v30, s[16:19], s46 offen lds
s_mov_b32 s4, s64
s_and_b32 s5, s65, 0xffff
s_mov_b32 s6, 2097152
s_mov_b32 s7, 0x20000
s_mov_b32 s8, s68
s_and_b32 s9, s69, 0xffff
s_mov_b32 s10, 524288
s_mov_b32 s11, 0x20000
v_lshrrev_b32 v12, 2, v3
v_lshlrev_b32 v10, 7, v12
v_lshl_add_u32 v10, v2, 10, v10
v_and_b32 v13, 3, v3
v_lshl_add_u32 v10, v13, 3, v10
v_lshrrev_b32 v11, 3, v3
v_and_b32 v13, 1, v2
v_lshl_add_u32 v11, v13, 1, v11
s_and_b32 s50, s42, 1
s_lshl_b32 s48, s50, 1
s_add_u32 s49, s48, 1
v_xor_b32 v26, s48, v11
v_lshl_add_u32 v26, v26, 5, v10
v_xor_b32 v27, s49, v11
v_lshl_add_u32 v27, v27, 5, v10
v_lshrrev_b32 v14, 1, v3
v_xor_b32 v14, v14, v2
v_lshlrev_b32 v14, 4, v14
v_lshl_add_u32 v14, v3, 7, v14
s_lshr_b32 s63, s42, 1
s_lshl_b32 s48, s63, 13
s_add_u32 s48, s48, 83968
v_add_u32 v22, s48, v14
v_xor_b32 v23, 64, v22
v_add_u32 v24, 36864, v22
v_add_u32 v25, 36864, v23
s_mov_b32 s32, s78
s_and_b32 s33, s79, 0xffff
s_mov_b32 s34, 2097152
s_mov_b32 s35, 0x20000
s_mov_b32 s28, s76
s_and_b32 s29, s77, 0xffff
s_mov_b32 s30, 1835008
s_mov_b32 s31, 0x20000
s_lshl1_add_u32 s50, s84, s85
s_and_b32 s50, s50, 7
s_mul_i32 s51, s42, 14
s_add_u32 s50, s50, s51
s_lshl_b32 s51, s51, 15
s_add_u32 s55, s51, 262144
s_lshl_b32 s73, s50, 15
s_add_u32 s72, s73, 0x8000
s_cmp_ge_u32 s72, s55
s_cselect_b32 s72, s51, s72
s_add_u32 s71, s72, 0x8000
s_cmp_ge_u32 s71, s55
s_cselect_b32 s71, s51, s71
s_add_u32 s70, s71, 0x8000
s_cmp_ge_u32 s70, s55
s_cselect_b32 s70, s51, s70
s_add_u32 s69, s70, 0x8000
s_cmp_ge_u32 s69, s55
s_cselect_b32 s69, s51, s69
s_add_u32 s68, s69, 0x8000
s_cmp_ge_u32 s68, s55
s_cselect_b32 s68, s51, s68
s_add_u32 s67, s68, 0x8000
s_cmp_ge_u32 s67, s55
s_cselect_b32 s67, s51, s67
s_add_u32 s66, s67, 0x8000
s_cmp_ge_u32 s66, s55
s_cselect_b32 s66, s51, s66
s_add_u32 s50, s84, s85
s_and_b32 s50, s50, 3
s_lshl_b32 s50, s50, 15
s_add_u32 s65, s55, s50
s_add_u32 s51, s55, 196608
s_add_u32 s64, s65, 0x8000
s_cmp_ge_u32 s64, s51
s_cselect_b32 s64, s55, s64
s_add_u32 s74, s64, 0x8000
s_cmp_ge_u32 s74, s51
s_cselect_b32 s74, s55, s74
s_add_u32 s75, s74, 0x8000
s_cmp_ge_u32 s75, s51
s_cselect_b32 s75, s55, s75
s_add_u32 s76, s75, 0x8000
s_cmp_ge_u32 s76, s51
s_cselect_b32 s76, s55, s76
s_add_u32 s77, s76, 0x8000
s_cmp_ge_u32 s77, s51
s_cselect_b32 s77, s55, s77
v_lshrrev_b32 v10, 3, v1
v_and_b32 v11, 6, v10
v_and_b32 v12, 7, v1
v_xor_b32 v11, v11, v12
v_lshlrev_b32_e64 v11, 4, v11
v_lshl_add_u32 v4, v10, 10, v11
v_lshl_add_u32 v4, s85, 7, v4
v_add_u32 v5, 16384, v4
v_and_b32 v10, 1, v2
v_lshlrev_b32 v10, 2, v10
v_lshrrev_b32 v11, 2, v3
v_add_u32 v10, v10, v11
v_lshrrev_b32 v11, 1, v2
v_lshlrev_b32 v11, 11, v11
v_lshl_add_u32 v11, v10, 7, v11
v_and_b32 v12, 3, v3
v_lshl_add_u32 v11, v12, 3, v11
v_add_u32 v11, s86, v11
v_lshrrev_b32 v12, 1, v10
v_lshl_add_u32 v6, v12, 5, v11
v_xor_b32 v7, 32, v6
v_xor_b32 v8, 64, v6
v_xor_b32 v9, 96, v6
s_lshl2_add_u32 s48, s2, s42
s_mul_i32 s48, s48, 14
v_add_u32 v37, s48, v1
v_lshlrev_b32 v37, 7, v37
v_cmp_gt_u32 vcc, 14, v1
v_bfrev_b32 v10, 2
s_nop 0
v_cndmask_b32 v37, v10, v37, vcc
v_lshlrev_b32 v36, 7, v3
v_lshl_add_u32 v36, v2, 27, v36
s_lshr_b32 s48, s2, 3
s_lshl2_add_u32 s49, s48, s42
s_lshl_b32 s58, s49, 12
s_lshr_b32 s50, s48, 3
s_mul_i32 s50, s50, 458752
s_and_b32 s49, s49, 31
s_mul_i32 s49, s49, 6144
s_add_u32 s59, s49, s50
s_add_u32 s59, s59, 262144
v_lshl_add_u32 v33, s42, 6, v1
s_lshl_b32 s48, s40, 7
s_sub_u32 s48, s48, 16
v_add_u32 v33, s48, v33
v_add_u32 v10, 16, v33
v_cmp_gt_i32 vcc, 0, v33
s_nop 1
v_cndmask_b32 v33, v33, v10, vcc
v_lshlrev_b32 v33, 4, v33
v_add_u32 v33, 9441280, v33
v_mul_u32_u24 v34, 1280, v2
v_lshl_add_u32 v34, v3, 4, v34
v_lshl_add_u32 v34, s42, 8, v34
v_lshrrev_b32 v10, 2, v1
v_mul_u32_u24 v35, 1280, v10
v_and_b32 v10, 3, v1
v_lshl_add_u32 v35, v10, 4, v35
v_lshl_add_u32 v35, s42, 6, v35
s_mul_i32 s23, s62, 20480
s_add_u32 s23, s23, 9478144
s_cmp_lt_u32 s42, 3
s_cselect_b32 s48, 0, -1024
v_add_u32 v33, s48, v33
s_setprio 1
s_waitcnt vmcnt(6) lgkmcnt(0)
s_barrier
ds_read_b64_tr_b16 v[136:137], v26 offset:0
ds_read_b64_tr_b16 v[138:139], v26 offset:512
ds_read_b128 v[104:107], v22 offset:0
ds_read_b64_tr_b16 v[140:141], v26 offset:4096
ds_read_b64_tr_b16 v[142:143], v26 offset:4608
ds_read_b128 v[108:111], v22 offset:2048
s_add_u32 m0, s43, 32768
s_add_u32 s46, s21, 458752
buffer_load_dwordx4 v30, s[12:15], s46 offen lds
ds_read_b64_tr_b16 v[144:145], v27 offset:0
ds_read_b64_tr_b16 v[146:147], v27 offset:512
ds_read_b128 v[112:115], v22 offset:4096
ds_read_b64_tr_b16 v[148:149], v27 offset:4096
ds_read_b64_tr_b16 v[150:151], v27 offset:4608
ds_read_b128 v[116:119], v22 offset:6144
s_add_u32 m0, s43, 36864
s_add_u32 s46, s21, 458752
buffer_load_dwordx4 v30, s[16:19], s46 offen lds
s_waitcnt vmcnt(6) lgkmcnt(0)
s_barrier
ds_read_b64_tr_b16 v[152:153], v26 offset:8192
v_mfma_f32_16x16x32_bf16 v[40:43], v[136:139], v[104:107], 0
ds_read_b64_tr_b16 v[154:155], v26 offset:8704
v_mfma_f32_16x16x32_bf16 v[44:47], v[140:143], v[104:107], 0
ds_read_b128 v[120:123], v23 offset:0
v_mfma_f32_16x16x32_bf16 v[72:75], v[144:147], v[104:107], 0
ds_read_b64_tr_b16 v[156:157], v26 offset:12288
v_mfma_f32_16x16x32_bf16 v[76:79], v[148:151], v[104:107], 0
ds_read_b64_tr_b16 v[158:159], v26 offset:12800
v_mfma_f32_16x16x32_bf16 v[48:51], v[136:139], v[108:111], 0
ds_read_b128 v[124:127], v23 offset:2048
v_mfma_f32_16x16x32_bf16 v[52:55], v[140:143], v[108:111], 0
s_add_u32 m0, s43, 0
s_add_u32 s46, s21, 573440
buffer_load_dwordx4 v30, s[12:15], s46 offen lds
v_mfma_f32_16x16x32_bf16 v[80:83], v[144:147], v[108:111], 0
ds_read_b64_tr_b16 v[160:161], v27 offset:8192
v_mfma_f32_16x16x32_bf16 v[84:87], v[148:151], v[108:111], 0
ds_read_b64_tr_b16 v[162:163], v27 offset:8704
v_mfma_f32_16x16x32_bf16 v[56:59], v[136:139], v[112:115], 0
ds_read_b128 v[128:131], v23 offset:4096
v_mfma_f32_16x16x32_bf16 v[60:63], v[140:143], v[112:115], 0
ds_read_b64_tr_b16 v[164:165], v27 offset:12288
v_mfma_f32_16x16x32_bf16 v[88:91], v[144:147], v[112:115], 0
ds_read_b64_tr_b16 v[166:167], v27 offset:12800
v_mfma_f32_16x16x32_bf16 v[92:95], v[148:151], v[112:115], 0
ds_read_b128 v[132:135], v23 offset:6144
v_mfma_f32_16x16x32_bf16 v[64:67], v[136:139], v[116:119], 0
s_add_u32 m0, s43, 4096
s_add_u32 s46, s21, 573440
buffer_load_dwordx4 v30, s[16:19], s46 offen lds
v_mfma_f32_16x16x32_bf16 v[68:71], v[140:143], v[116:119], 0
v_mfma_f32_16x16x32_bf16 v[96:99], v[144:147], v[116:119], 0
v_mfma_f32_16x16x32_bf16 v[100:103], v[148:151], v[116:119], 0
s_waitcnt vmcnt(6) lgkmcnt(0)
s_barrier
ds_read_b64_tr_b16 v[136:137], v26 offset:16384
v_mfma_f32_16x16x32_bf16 v[40:43], v[152:155], v[120:123], v[40:43]
ds_read_b64_tr_b16 v[138:139], v26 offset:16896
v_mfma_f32_16x16x32_bf16 v[44:47], v[156:159], v[120:123], v[44:47]
ds_read_b128 v[104:107], v22 offset:18432
v_mfma_f32_16x16x32_bf16 v[72:75], v[160:163], v[120:123], v[72:75]
ds_read_b64_tr_b16 v[140:141], v26 offset:20480
v_mfma_f32_16x16x32_bf16 v[76:79], v[164:167], v[120:123], v[76:79]
ds_read_b64_tr_b16 v[142:143], v26 offset:20992
v_mfma_f32_16x16x32_bf16 v[48:51], v[152:155], v[124:127], v[48:51]
ds_read_b128 v[108:111], v22 offset:20480
v_mfma_f32_16x16x32_bf16 v[52:55], v[156:159], v[124:127], v[52:55]
s_add_u32 m0, s43, 8192
s_add_u32 s46, s21, 688128
buffer_load_dwordx4 v30, s[12:15], s46 offen lds
v_mfma_f32_16x16x32_bf16 v[80:83], v[160:163], v[124:127], v[80:83]
ds_read_b64_tr_b16 v[144:145], v27 offset:16384
v_mfma_f32_16x16x32_bf16 v[84:87], v[164:167], v[124:127], v[84:87]
ds_read_b64_tr_b16 v[146:147], v27 offset:16896
v_mfma_f32_16x16x32_bf16 v[56:59], v[152:155], v[128:131], v[56:59]
ds_read_b128 v[112:115], v22 offset:22528
v_mfma_f32_16x16x32_bf16 v[60:63], v[156:159], v[128:131], v[60:63]
ds_read_b64_tr_b16 v[148:149], v27 offset:20480
v_mfma_f32_16x16x32_bf16 v[88:91], v[160:163], v[128:131], v[88:91]
ds_read_b64_tr_b16 v[150:151], v27 offset:20992
v_mfma_f32_16x16x32_bf16 v[92:95], v[164:167], v[128:131], v[92:95]
ds_read_b128 v[116:119], v22 offset:24576
v_mfma_f32_16x16x32_bf16 v[64:67], v[152:155], v[132:135], v[64:67]
s_add_u32 m0, s43, 12288
s_add_u32 s46, s21, 688128
buffer_load_dwordx4 v30, s[16:19], s46 offen lds
v_mfma_f32_16x16x32_bf16 v[68:71], v[156:159], v[132:135], v[68:71]
v_mfma_f32_16x16x32_bf16 v[96:99], v[160:163], v[132:135], v[96:99]
v_mfma_f32_16x16x32_bf16 v[100:103], v[164:167], v[132:135], v[100:103]
s_waitcnt vmcnt(6) lgkmcnt(0)
s_barrier
ds_read_b64_tr_b16 v[152:153], v26 offset:24576
v_mfma_f32_16x16x32_bf16 v[40:43], v[136:139], v[104:107], v[40:43]
ds_read_b64_tr_b16 v[154:155], v26 offset:25088
v_mfma_f32_16x16x32_bf16 v[44:47], v[140:143], v[104:107], v[44:47]
ds_read_b128 v[120:123], v23 offset:18432
v_mfma_f32_16x16x32_bf16 v[72:75], v[144:147], v[104:107], v[72:75]
ds_read_b64_tr_b16 v[156:157], v26 offset:28672
v_mfma_f32_16x16x32_bf16 v[76:79], v[148:151], v[104:107], v[76:79]
ds_read_b64_tr_b16 v[158:159], v26 offset:29184
v_mfma_f32_16x16x32_bf16 v[48:51], v[136:139], v[108:111], v[48:51]
ds_read_b128 v[124:127], v23 offset:20480
v_mfma_f32_16x16x32_bf16 v[52:55], v[140:143], v[108:111], v[52:55]
s_add_u32 m0, s43, 16384
s_add_u32 s46, s21, 802816
buffer_load_dwordx4 v30, s[12:15], s46 offen lds
v_mfma_f32_16x16x32_bf16 v[80:83], v[144:147], v[108:111], v[80:83]
ds_read_b64_tr_b16 v[160:161], v27 offset:24576
v_mfma_f32_16x16x32_bf16 v[84:87], v[148:151], v[108:111], v[84:87]
ds_read_b64_tr_b16 v[162:163], v27 offset:25088
v_mfma_f32_16x16x32_bf16 v[56:59], v[136:139], v[112:115], v[56:59]
ds_read_b128 v[128:131], v23 offset:22528
v_mfma_f32_16x16x32_bf16 v[60:63], v[140:143], v[112:115], v[60:63]
ds_read_b64_tr_b16 v[164:165], v27 offset:28672
v_mfma_f32_16x16x32_bf16 v[88:91], v[144:147], v[112:115], v[88:91]
ds_read_b64_tr_b16 v[166:167], v27 offset:29184
v_mfma_f32_16x16x32_bf16 v[92:95], v[148:151], v[112:115], v[92:95]
ds_read_b128 v[132:135], v23 offset:24576
v_mfma_f32_16x16x32_bf16 v[64:67], v[136:139], v[116:119], v[64:67]
s_add_u32 m0, s43, 20480
s_add_u32 s46, s21, 802816
buffer_load_dwordx4 v30, s[16:19], s46 offen lds
v_mfma_f32_16x16x32_bf16 v[68:71], v[140:143], v[116:119], v[68:71]
v_mfma_f32_16x16x32_bf16 v[96:99], v[144:147], v[116:119], v[96:99]
v_mfma_f32_16x16x32_bf16 v[100:103], v[148:151], v[116:119], v[100:103]
s_waitcnt vmcnt(6) lgkmcnt(0)
s_barrier
ds_read_b64_tr_b16 v[136:137], v26 offset:32768
v_mfma_f32_16x16x32_bf16 v[40:43], v[152:155], v[120:123], v[40:43]
ds_read_b64_tr_b16 v[138:139], v26 offset:33280
v_mfma_f32_16x16x32_bf16 v[44:47], v[156:159], v[120:123], v[44:47]
ds_read_b128 v[104:107], v24 offset:0
v_mfma_f32_16x16x32_bf16 v[72:75], v[160:163], v[120:123], v[72:75]
ds_read_b64_tr_b16 v[140:141], v26 offset:36864
v_mfma_f32_16x16x32_bf16 v[76:79], v[164:167], v[120:123], v[76:79]
s_add_u32 m0, s43, 24576
s_sub_u32 s46, 917504, s21
buffer_load_dwordx4 v30, s[12:15], s46 offen lds
v_mfma_f32_16x16x32_bf16 v[48:51], v[152:155], v[124:127], v[48:51]
ds_read_b64_tr_b16 v[142:143], v26 offset:37376
v_mfma_f32_16x16x32_bf16 v[52:55], v[156:159], v[124:127], v[52:55]
ds_read_b128 v[108:111], v24 offset:2048
ds_read_b64_tr_b16 v[144:145], v27 offset:32768
v_mfma_f32_16x16x32_bf16 v[80:83], v[160:163], v[124:127], v[80:83]
ds_read_b64_tr_b16 v[146:147], v27 offset:33280
v_mfma_f32_16x16x32_bf16 v[84:87], v[164:167], v[124:127], v[84:87]
s_add_u32 m0, s43, 28672
s_sub_u32 s46, 917504, s21
buffer_load_dwordx4 v30, s[16:19], s46 offen lds
v_mfma_f32_16x16x32_bf16 v[56:59], v[152:155], v[128:131], v[56:59]
ds_read_b128 v[112:115], v24 offset:4096
v_mfma_f32_16x16x32_bf16 v[60:63], v[156:159], v[128:131], v[60:63]
ds_read_b64_tr_b16 v[148:149], v27 offset:36864
v_mfma_f32_16x16x32_bf16 v[88:91], v[160:163], v[128:131], v[88:91]
ds_read_b64_tr_b16 v[150:151], v27 offset:37376
v_mfma_f32_16x16x32_bf16 v[92:95], v[164:167], v[128:131], v[92:95]
ds_read_b128 v[116:119], v24 offset:6144
v_mfma_f32_16x16x32_bf16 v[64:67], v[152:155], v[132:135], v[64:67]
buffer_load_dword v38, v37, s[28:31], 0 offen
v_mfma_f32_16x16x32_bf16 v[68:71], v[156:159], v[132:135], v[68:71]
v_mfma_f32_16x16x32_bf16 v[96:99], v[160:163], v[132:135], v[96:99]
v_mfma_f32_16x16x32_bf16 v[100:103], v[164:167], v[132:135], v[100:103]
s_waitcnt vmcnt(7) lgkmcnt(0)
s_barrier
ds_read_b64_tr_b16 v[152:153], v26 offset:0
v_mfma_f32_16x16x32_bf16 v[40:43], v[136:139], v[104:107], v[40:43]
ds_read_b64_tr_b16 v[154:155], v26 offset:512
v_mfma_f32_16x16x32_bf16 v[44:47], v[140:143], v[104:107], v[44:47]
ds_read_b128 v[120:123], v25 offset:0
v_mfma_f32_16x16x32_bf16 v[72:75], v[144:147], v[104:107], v[72:75]
ds_read_b64_tr_b16 v[156:157], v26 offset:4096
v_mfma_f32_16x16x32_bf16 v[76:79], v[148:151], v[104:107], v[76:79]
ds_read_b64_tr_b16 v[158:159], v26 offset:4608
v_mfma_f32_16x16x32_bf16 v[48:51], v[136:139], v[108:111], v[48:51]
ds_read_b128 v[124:127], v25 offset:2048
v_mfma_f32_16x16x32_bf16 v[52:55], v[140:143], v[108:111], v[52:55]
s_add_u32 m0, s43, 32768
s_sub_u32 s46, 1032192, s21
buffer_load_dwordx4 v30, s[12:15], s46 offen lds
v_mfma_f32_16x16x32_bf16 v[80:83], v[144:147], v[108:111], v[80:83]
ds_read_b64_tr_b16 v[160:161], v27 offset:0
v_mfma_f32_16x16x32_bf16 v[84:87], v[148:151], v[108:111], v[84:87]
ds_read_b64_tr_b16 v[162:163], v27 offset:512
v_mfma_f32_16x16x32_bf16 v[56:59], v[136:139], v[112:115], v[56:59]
ds_read_b128 v[128:131], v25 offset:4096
v_mfma_f32_16x16x32_bf16 v[60:63], v[140:143], v[112:115], v[60:63]
ds_read_b64_tr_b16 v[164:165], v27 offset:4096
v_mfma_f32_16x16x32_bf16 v[88:91], v[144:147], v[112:115], v[88:91]
ds_read_b64_tr_b16 v[166:167], v27 offset:4608
v_mfma_f32_16x16x32_bf16 v[92:95], v[148:151], v[112:115], v[92:95]
ds_read_b128 v[132:135], v25 offset:6144
v_mfma_f32_16x16x32_bf16 v[64:67], v[136:139], v[116:119], v[64:67]
s_add_u32 m0, s43, 36864
s_sub_u32 s46, 1032192, s21
buffer_load_dwordx4 v30, s[16:19], s46 offen lds
v_mfma_f32_16x16x32_bf16 v[68:71], v[140:143], v[116:119], v[68:71]
v_mfma_f32_16x16x32_bf16 v[96:99], v[144:147], v[116:119], v[96:99]
v_mfma_f32_16x16x32_bf16 v[100:103], v[148:151], v[116:119], v[100:103]
s_waitcnt vmcnt(7) lgkmcnt(0)
s_barrier
ds_read_b64_tr_b16 v[136:137], v26 offset:8192
v_mfma_f32_16x16x32_bf16 v[40:43], v[152:155], v[120:123], v[40:43]
ds_read_b64_tr_b16 v[138:139], v26 offset:8704
v_mfma_f32_16x16x32_bf16 v[44:47], v[156:159], v[120:123], v[44:47]
ds_read_b128 v[104:107], v24 offset:18432
v_mfma_f32_16x16x32_bf16 v[72:75], v[160:163], v[120:123], v[72:75]
ds_read_b64_tr_b16 v[140:141], v26 offset:12288
v_mfma_f32_16x16x32_bf16 v[76:79], v[164:167], v[120:123], v[76:79]
ds_read_b64_tr_b16 v[142:143], v26 offset:12800
v_mfma_f32_16x16x32_bf16 v[48:51], v[152:155], v[124:127], v[48:51]
ds_read_b128 v[108:111], v24 offset:20480
v_mfma_f32_16x16x32_bf16 v[52:55], v[156:159], v[124:127], v[52:55]
s_add_u32 m0, s43, 0
s_sub_u32 s46, 1146880, s21
buffer_load_dwordx4 v30, s[12:15], s46 offen lds
v_mfma_f32_16x16x32_bf16 v[80:83], v[160:163], v[124:127], v[80:83]
ds_read_b64_tr_b16 v[144:145], v27 offset:8192
v_mfma_f32_16x16x32_bf16 v[84:87], v[164:167], v[124:127], v[84:87]
ds_read_b64_tr_b16 v[146:147], v27 offset:8704
v_mfma_f32_16x16x32_bf16 v[56:59], v[152:155], v[128:131], v[56:59]
ds_read_b128 v[112:115], v24 offset:22528
v_mfma_f32_16x16x32_bf16 v[60:63], v[156:159], v[128:131], v[60:63]
ds_read_b64_tr_b16 v[148:149], v27 offset:12288
v_mfma_f32_16x16x32_bf16 v[88:91], v[160:163], v[128:131], v[88:91]
ds_read_b64_tr_b16 v[150:151], v27 offset:12800
v_mfma_f32_16x16x32_bf16 v[92:95], v[164:167], v[128:131], v[92:95]
ds_read_b128 v[116:119], v24 offset:24576
v_mfma_f32_16x16x32_bf16 v[64:67], v[152:155], v[132:135], v[64:67]
s_add_u32 m0, s43, 4096
s_sub_u32 s46, 1146880, s21
buffer_load_dwordx4 v30, s[16:19], s46 offen lds
v_mfma_f32_16x16x32_bf16 v[68:71], v[156:159], v[132:135], v[68:71]
v_mfma_f32_16x16x32_bf16 v[96:99], v[160:163], v[132:135], v[96:99]
v_mfma_f32_16x16x32_bf16 v[100:103], v[164:167], v[132:135], v[100:103]
s_waitcnt vmcnt(7) lgkmcnt(0)
s_barrier
ds_read_b64_tr_b16 v[152:153], v26 offset:16384
v_mfma_f32_16x16x32_bf16 v[40:43], v[136:139], v[104:107], v[40:43]
ds_read_b64_tr_b16 v[154:155], v26 offset:16896
v_mfma_f32_16x16x32_bf16 v[44:47], v[140:143], v[104:107], v[44:47]
ds_read_b128 v[120:123], v25 offset:18432
v_mfma_f32_16x16x32_bf16 v[72:75], v[144:147], v[104:107], v[72:75]
ds_read_b64_tr_b16 v[156:157], v26 offset:20480
v_mfma_f32_16x16x32_bf16 v[76:79], v[148:151], v[104:107], v[76:79]
ds_read_b64_tr_b16 v[158:159], v26 offset:20992
v_mfma_f32_16x16x32_bf16 v[48:51], v[136:139], v[108:111], v[48:51]
ds_read_b128 v[124:127], v25 offset:20480
v_mfma_f32_16x16x32_bf16 v[52:55], v[140:143], v[108:111], v[52:55]
s_add_u32 m0, s43, 8192
s_sub_u32 s46, 1261568, s21
buffer_load_dwordx4 v30, s[12:15], s46 offen lds
v_mfma_f32_16x16x32_bf16 v[80:83], v[144:147], v[108:111], v[80:83]
ds_read_b64_tr_b16 v[160:161], v27 offset:16384
v_mfma_f32_16x16x32_bf16 v[84:87], v[148:151], v[108:111], v[84:87]
ds_read_b64_tr_b16 v[162:163], v27 offset:16896
v_mfma_f32_16x16x32_bf16 v[56:59], v[136:139], v[112:115], v[56:59]
ds_read_b128 v[128:131], v25 offset:22528
v_mfma_f32_16x16x32_bf16 v[60:63], v[140:143], v[112:115], v[60:63]
ds_read_b64_tr_b16 v[164:165], v27 offset:20480
v_mfma_f32_16x16x32_bf16 v[88:91], v[144:147], v[112:115], v[88:91]
ds_read_b64_tr_b16 v[166:167], v27 offset:20992
v_mfma_f32_16x16x32_bf16 v[92:95], v[148:151], v[112:115], v[92:95]
ds_read_b128 v[132:135], v25 offset:24576
v_mfma_f32_16x16x32_bf16 v[64:67], v[136:139], v[116:119], v[64:67]
s_add_u32 m0, s43, 12288
s_sub_u32 s46, 1261568, s21
buffer_load_dwordx4 v30, s[16:19], s46 offen lds
v_mfma_f32_16x16x32_bf16 v[68:71], v[140:143], v[116:119], v[68:71]
v_mfma_f32_16x16x32_bf16 v[96:99], v[144:147], v[116:119], v[96:99]
v_mfma_f32_16x16x32_bf16 v[100:103], v[148:151], v[116:119], v[100:103]
s_waitcnt vmcnt(7) lgkmcnt(0)
s_barrier
ds_read_b64_tr_b16 v[136:137], v26 offset:24576
v_mfma_f32_16x16x32_bf16 v[40:43], v[152:155], v[120:123], v[40:43]
ds_read_b64_tr_b16 v[138:139], v26 offset:25088
v_mfma_f32_16x16x32_bf16 v[44:47], v[156:159], v[120:123], v[44:47]
ds_read_b128 v[104:107], v22 offset:0
v_mfma_f32_16x16x32_bf16 v[72:75], v[160:163], v[120:123], v[72:75]
ds_read_b64_tr_b16 v[140:141], v26 offset:28672
v_mfma_f32_16x16x32_bf16 v[76:79], v[164:167], v[120:123], v[76:79]
ds_read_b64_tr_b16 v[142:143], v26 offset:29184
v_mfma_f32_16x16x32_bf16 v[48:51], v[152:155], v[124:127], v[48:51]
ds_read_b128 v[108:111], v22 offset:2048
v_mfma_f32_16x16x32_bf16 v[52:55], v[156:159], v[124:127], v[52:55]
s_add_u32 m0, s43, 16384
s_sub_u32 s46, 1376256, s21
buffer_load_dwordx4 v30, s[12:15], s46 offen lds
v_mfma_f32_16x16x32_bf16 v[80:83], v[160:163], v[124:127], v[80:83]
ds_read_b64_tr_b16 v[144:145], v27 offset:24576
v_mfma_f32_16x16x32_bf16 v[84:87], v[164:167], v[124:127], v[84:87]
ds_read_b64_tr_b16 v[146:147], v27 offset:25088
v_mfma_f32_16x16x32_bf16 v[56:59], v[152:155], v[128:131], v[56:59]
ds_read_b128 v[112:115], v22 offset:4096
v_mfma_f32_16x16x32_bf16 v[60:63], v[156:159], v[128:131], v[60:63]
ds_read_b64_tr_b16 v[148:149], v27 offset:28672
v_mfma_f32_16x16x32_bf16 v[88:91], v[160:163], v[128:131], v[88:91]
ds_read_b64_tr_b16 v[150:151], v27 offset:29184
v_mfma_f32_16x16x32_bf16 v[92:95], v[164:167], v[128:131], v[92:95]
ds_read_b128 v[116:119], v22 offset:6144
v_mfma_f32_16x16x32_bf16 v[64:67], v[152:155], v[132:135], v[64:67]
s_add_u32 m0, s43, 20480
s_sub_u32 s46, 1376256, s21
buffer_load_dwordx4 v30, s[16:19], s46 offen lds
v_mfma_f32_16x16x32_bf16 v[68:71], v[156:159], v[132:135], v[68:71]
v_mfma_f32_16x16x32_bf16 v[96:99], v[160:163], v[132:135], v[96:99]
v_mfma_f32_16x16x32_bf16 v[100:103], v[164:167], v[132:135], v[100:103]
s_waitcnt vmcnt(6) lgkmcnt(0)
s_barrier
ds_read_b64_tr_b16 v[152:153], v26 offset:32768
v_mfma_f32_16x16x32_bf16 v[40:43], v[136:139], v[104:107], v[40:43]
ds_read_b64_tr_b16 v[154:155], v26 offset:33280
v_mfma_f32_16x16x32_bf16 v[44:47], v[140:143], v[104:107], v[44:47]
ds_read_b128 v[120:123], v23 offset:0
v_mfma_f32_16x16x32_bf16 v[72:75], v[144:147], v[104:107], v[72:75]
ds_read_b64_tr_b16 v[156:157], v26 offset:36864
v_mfma_f32_16x16x32_bf16 v[76:79], v[148:151], v[104:107], v[76:79]
ds_read_b64_tr_b16 v[158:159], v26 offset:37376
v_mfma_f32_16x16x32_bf16 v[48:51], v[136:139], v[108:111], v[48:51]
ds_read_b128 v[124:127], v23 offset:2048
v_mfma_f32_16x16x32_bf16 v[52:55], v[140:143], v[108:111], v[52:55]
s_add_u32 m0, s43, 24576
s_sub_u32 s46, 1490944, s21
buffer_load_dwordx4 v30, s[12:15], s46 offen lds
v_mfma_f32_16x16x32_bf16 v[80:83], v[144:147], v[108:111], v[80:83]
ds_read_b64_tr_b16 v[160:161], v27 offset:32768
v_mfma_f32_16x16x32_bf16 v[84:87], v[148:151], v[108:111], v[84:87]
ds_read_b64_tr_b16 v[162:163], v27 offset:33280
v_mfma_f32_16x16x32_bf16 v[56:59], v[136:139], v[112:115], v[56:59]
ds_read_b128 v[128:131], v23 offset:4096
v_mfma_f32_16x16x32_bf16 v[60:63], v[140:143], v[112:115], v[60:63]
ds_read_b64_tr_b16 v[164:165], v27 offset:36864
v_mfma_f32_16x16x32_bf16 v[88:91], v[144:147], v[112:115], v[88:91]
ds_read_b64_tr_b16 v[166:167], v27 offset:37376
v_mfma_f32_16x16x32_bf16 v[92:95], v[148:151], v[112:115], v[92:95]
ds_read_b128 v[132:135], v23 offset:6144
v_mfma_f32_16x16x32_bf16 v[64:67], v[136:139], v[116:119], v[64:67]
s_add_u32 m0, s43, 28672
s_sub_u32 s46, 1490944, s21
buffer_load_dwordx4 v30, s[16:19], s46 offen lds
v_mfma_f32_16x16x32_bf16 v[68:71], v[140:143], v[116:119], v[68:71]
v_mfma_f32_16x16x32_bf16 v[96:99], v[144:147], v[116:119], v[96:99]
v_mfma_f32_16x16x32_bf16 v[100:103], v[148:151], v[116:119], v[100:103]
s_waitcnt vmcnt(6) lgkmcnt(0)
s_barrier
ds_read_b64_tr_b16 v[136:137], v26 offset:0
v_mfma_f32_16x16x32_bf16 v[40:43], v[152:155], v[120:123], v[40:43]
ds_read_b64_tr_b16 v[138:139], v26 offset:512
v_mfma_f32_16x16x32_bf16 v[44:47], v[156:159], v[120:123], v[44:47]
ds_read_b128 v[104:107], v22 offset:18432
v_mfma_f32_16x16x32_bf16 v[72:75], v[160:163], v[120:123], v[72:75]
ds_read_b64_tr_b16 v[140:141], v26 offset:4096
v_mfma_f32_16x16x32_bf16 v[76:79], v[164:167], v[120:123], v[76:79]
ds_read_b64_tr_b16 v[142:143], v26 offset:4608
v_mfma_f32_16x16x32_bf16 v[48:51], v[152:155], v[124:127], v[48:51]
ds_read_b128 v[108:111], v22 offset:20480
v_mfma_f32_16x16x32_bf16 v[52:55], v[156:159], v[124:127], v[52:55]
s_add_u32 m0, s43, 32768
s_sub_u32 s46, 1605632, s21
buffer_load_dwordx4 v30, s[12:15], s46 offen lds
v_mfma_f32_16x16x32_bf16 v[80:83], v[160:163], v[124:127], v[80:83]
ds_read_b64_tr_b16 v[144:145], v27 offset:0
v_mfma_f32_16x16x32_bf16 v[84:87], v[164:167], v[124:127], v[84:87]
ds_read_b64_tr_b16 v[146:147], v27 offset:512
v_mfma_f32_16x16x32_bf16 v[56:59], v[152:155], v[128:131], v[56:59]
ds_read_b128 v[112:115], v22 offset:22528
v_mfma_f32_16x16x32_bf16 v[60:63], v[156:159], v[128:131], v[60:63]
ds_read_b64_tr_b16 v[148:149], v27 offset:4096
v_mfma_f32_16x16x32_bf16 v[88:91], v[160:163], v[128:131], v[88:91]
ds_read_b64_tr_b16 v[150:151], v27 offset:4608
v_mfma_f32_16x16x32_bf16 v[92:95], v[164:167], v[128:131], v[92:95]
ds_read_b128 v[116:119], v22 offset:24576
v_mfma_f32_16x16x32_bf16 v[64:67], v[152:155], v[132:135], v[64:67]
s_add_u32 m0, s43, 36864
s_sub_u32 s46, 1605632, s21
buffer_load_dwordx4 v30, s[16:19], s46 offen lds
v_mfma_f32_16x16x32_bf16 v[68:71], v[156:159], v[132:135], v[68:71]
v_mfma_f32_16x16x32_bf16 v[96:99], v[160:163], v[132:135], v[96:99]
v_mfma_f32_16x16x32_bf16 v[100:103], v[164:167], v[132:135], v[100:103]
s_waitcnt vmcnt(6) lgkmcnt(0)
s_barrier
ds_read_b64_tr_b16 v[152:153], v26 offset:8192
v_mfma_f32_16x16x32_bf16 v[40:43], v[136:139], v[104:107], v[40:43]
ds_read_b64_tr_b16 v[154:155], v26 offset:8704
v_mfma_f32_16x16x32_bf16 v[44:47], v[140:143], v[104:107], v[44:47]
ds_read_b128 v[120:123], v23 offset:18432
v_mfma_f32_16x16x32_bf16 v[72:75], v[144:147], v[104:107], v[72:75]
ds_read_b64_tr_b16 v[156:157], v26 offset:12288
v_mfma_f32_16x16x32_bf16 v[76:79], v[148:151], v[104:107], v[76:79]
ds_read_b64_tr_b16 v[158:159], v26 offset:12800
v_mfma_f32_16x16x32_bf16 v[48:51], v[136:139], v[108:111], v[48:51]
ds_read_b128 v[124:127], v23 offset:20480
v_mfma_f32_16x16x32_bf16 v[52:55], v[140:143], v[108:111], v[52:55]
s_add_u32 m0, s43, 0
s_sub_u32 s46, 1720320, s21
buffer_load_dwordx4 v30, s[12:15], s46 offen lds
v_mfma_f32_16x16x32_bf16 v[80:83], v[144:147], v[108:111], v[80:83]
ds_read_b64_tr_b16 v[160:161], v27 offset:8192
v_mfma_f32_16x16x32_bf16 v[84:87], v[148:151], v[108:111], v[84:87]
ds_read_b64_tr_b16 v[162:163], v27 offset:8704
v_mfma_f32_16x16x32_bf16 v[56:59], v[136:139], v[112:115], v[56:59]
ds_read_b128 v[128:131], v23 offset:22528
v_mfma_f32_16x16x32_bf16 v[60:63], v[140:143], v[112:115], v[60:63]
ds_read_b64_tr_b16 v[164:165], v27 offset:12288
v_mfma_f32_16x16x32_bf16 v[88:91], v[144:147], v[112:115], v[88:91]
ds_read_b64_tr_b16 v[166:167], v27 offset:12800
v_mfma_f32_16x16x32_bf16 v[92:95], v[148:151], v[112:115], v[92:95]
ds_read_b128 v[132:135], v23 offset:24576
v_mfma_f32_16x16x32_bf16 v[64:67], v[136:139], v[116:119], v[64:67]
s_add_u32 m0, s43, 4096
s_sub_u32 s46, 1720320, s21
buffer_load_dwordx4 v30, s[16:19], s46 offen lds
v_mfma_f32_16x16x32_bf16 v[68:71], v[140:143], v[116:119], v[68:71]
v_mfma_f32_16x16x32_bf16 v[96:99], v[144:147], v[116:119], v[96:99]
v_mfma_f32_16x16x32_bf16 v[100:103], v[148:151], v[116:119], v[100:103]
s_waitcnt vmcnt(6) lgkmcnt(0)
s_barrier
v_mfma_f32_16x16x32_bf16 v[40:43], v[152:155], v[120:123], v[40:43]
v_mfma_f32_16x16x32_bf16 v[44:47], v[156:159], v[120:123], v[44:47]
ds_read_b64_tr_b16 v[136:137], v26 offset:16384
v_mfma_f32_16x16x32_bf16 v[72:75], v[160:163], v[120:123], v[72:75]
ds_read_b64_tr_b16 v[138:139], v26 offset:16896
v_mfma_f32_16x16x32_bf16 v[76:79], v[164:167], v[120:123], v[76:79]
ds_read_b128 v[104:107], v24 offset:0
v_mfma_f32_16x16x32_bf16 v[48:51], v[152:155], v[124:127], v[48:51]
ds_read_b64_tr_b16 v[140:141], v26 offset:20480
v_mfma_f32_16x16x32_bf16 v[52:55], v[156:159], v[124:127], v[52:55]
ds_read_b64_tr_b16 v[142:143], v26 offset:20992
v_mfma_f32_16x16x32_bf16 v[80:83], v[160:163], v[124:127], v[80:83]
ds_read_b128 v[108:111], v24 offset:2048
v_mfma_f32_16x16x32_bf16 v[84:87], v[164:167], v[124:127], v[84:87]
ds_read_b64_tr_b16 v[144:145], v27 offset:16384
v_mfma_f32_16x16x32_bf16 v[56:59], v[152:155], v[128:131], v[56:59]
ds_read_b64_tr_b16 v[146:147], v27 offset:16896
v_mfma_f32_16x16x32_bf16 v[60:63], v[156:159], v[128:131], v[60:63]
ds_read_b128 v[112:115], v24 offset:4096
v_mfma_f32_16x16x32_bf16 v[88:91], v[160:163], v[128:131], v[88:91]
ds_read_b64_tr_b16 v[148:149], v27 offset:20480
v_mfma_f32_16x16x32_bf16 v[92:95], v[164:167], v[128:131], v[92:95]
ds_read_b64_tr_b16 v[150:151], v27 offset:20992
v_mfma_f32_16x16x32_bf16 v[64:67], v[152:155], v[132:135], v[64:67]
ds_read_b128 v[116:119], v24 offset:6144
v_mfma_f32_16x16x32_bf16 v[68:71], v[156:159], v[132:135], v[68:71]
v_mfma_f32_16x16x32_bf16 v[96:99], v[160:163], v[132:135], v[96:99]
v_mfma_f32_16x16x32_bf16 v[100:103], v[164:167], v[132:135], v[100:103]
s_waitcnt vmcnt(4) lgkmcnt(0)
s_barrier
v_mfma_f32_16x16x32_bf16 v[40:43], v[136:139], v[104:107], v[40:43]
v_mfma_f32_16x16x32_bf16 v[44:47], v[140:143], v[104:107], v[44:47]
ds_read_b64_tr_b16 v[152:153], v26 offset:24576
v_mfma_f32_16x16x32_bf16 v[72:75], v[144:147], v[104:107], v[72:75]
ds_read_b64_tr_b16 v[154:155], v26 offset:25088
v_mfma_f32_16x16x32_bf16 v[76:79], v[148:151], v[104:107], v[76:79]
ds_read_b128 v[120:123], v25 offset:0
v_mfma_f32_16x16x32_bf16 v[48:51], v[136:139], v[108:111], v[48:51]
ds_read_b64_tr_b16 v[156:157], v26 offset:28672
v_mfma_f32_16x16x32_bf16 v[52:55], v[140:143], v[108:111], v[52:55]
ds_read_b64_tr_b16 v[158:159], v26 offset:29184
v_mfma_f32_16x16x32_bf16 v[80:83], v[144:147], v[108:111], v[80:83]
ds_read_b128 v[124:127], v25 offset:2048
v_mfma_f32_16x16x32_bf16 v[84:87], v[148:151], v[108:111], v[84:87]
ds_read_b64_tr_b16 v[160:161], v27 offset:24576
v_mfma_f32_16x16x32_bf16 v[56:59], v[136:139], v[112:115], v[56:59]
ds_read_b64_tr_b16 v[162:163], v27 offset:25088
v_mfma_f32_16x16x32_bf16 v[60:63], v[140:143], v[112:115], v[60:63]
ds_read_b128 v[128:131], v25 offset:4096
v_mfma_f32_16x16x32_bf16 v[88:91], v[144:147], v[112:115], v[88:91]
ds_read_b64_tr_b16 v[164:165], v27 offset:28672
v_mfma_f32_16x16x32_bf16 v[92:95], v[148:151], v[112:115], v[92:95]
ds_read_b64_tr_b16 v[166:167], v27 offset:29184
v_mfma_f32_16x16x32_bf16 v[64:67], v[136:139], v[116:119], v[64:67]
ds_read_b128 v[132:135], v25 offset:6144
v_mfma_f32_16x16x32_bf16 v[68:71], v[140:143], v[116:119], v[68:71]
v_mfma_f32_16x16x32_bf16 v[96:99], v[144:147], v[116:119], v[96:99]
v_mfma_f32_16x16x32_bf16 v[100:103], v[148:151], v[116:119], v[100:103]
s_waitcnt vmcnt(2) lgkmcnt(0)
s_barrier
v_mfma_f32_16x16x32_bf16 v[40:43], v[152:155], v[120:123], v[40:43]
v_mfma_f32_16x16x32_bf16 v[44:47], v[156:159], v[120:123], v[44:47]
ds_read_b64_tr_b16 v[136:137], v26 offset:32768
v_mfma_f32_16x16x32_bf16 v[72:75], v[160:163], v[120:123], v[72:75]
ds_read_b64_tr_b16 v[138:139], v26 offset:33280
v_mfma_f32_16x16x32_bf16 v[76:79], v[164:167], v[120:123], v[76:79]
ds_read_b128 v[104:107], v24 offset:18432
v_mfma_f32_16x16x32_bf16 v[48:51], v[152:155], v[124:127], v[48:51]
ds_read_b64_tr_b16 v[140:141], v26 offset:36864
v_mfma_f32_16x16x32_bf16 v[52:55], v[156:159], v[124:127], v[52:55]
ds_read_b64_tr_b16 v[142:143], v26 offset:37376
v_mfma_f32_16x16x32_bf16 v[80:83], v[160:163], v[124:127], v[80:83]
ds_read_b128 v[108:111], v24 offset:20480
v_mfma_f32_16x16x32_bf16 v[84:87], v[164:167], v[124:127], v[84:87]
ds_read_b64_tr_b16 v[144:145], v27 offset:32768
v_mfma_f32_16x16x32_bf16 v[56:59], v[152:155], v[128:131], v[56:59]
ds_read_b64_tr_b16 v[146:147], v27 offset:33280
v_mfma_f32_16x16x32_bf16 v[60:63], v[156:159], v[128:131], v[60:63]
ds_read_b128 v[112:115], v24 offset:22528
v_mfma_f32_16x16x32_bf16 v[88:91], v[160:163], v[128:131], v[88:91]
ds_read_b64_tr_b16 v[148:149], v27 offset:36864
v_mfma_f32_16x16x32_bf16 v[92:95], v[164:167], v[128:131], v[92:95]
ds_read_b64_tr_b16 v[150:151], v27 offset:37376
v_mfma_f32_16x16x32_bf16 v[64:67], v[152:155], v[132:135], v[64:67]
ds_read_b128 v[116:119], v24 offset:24576
v_mfma_f32_16x16x32_bf16 v[68:71], v[156:159], v[132:135], v[68:71]
v_mfma_f32_16x16x32_bf16 v[96:99], v[160:163], v[132:135], v[96:99]
v_mfma_f32_16x16x32_bf16 v[100:103], v[164:167], v[132:135], v[100:103]
s_waitcnt vmcnt(0) lgkmcnt(0)
s_barrier
v_mfma_f32_16x16x32_bf16 v[40:43], v[136:139], v[104:107], v[40:43]
ds_read_b64_tr_b16 v[152:153], v26 offset:0
v_mfma_f32_16x16x32_bf16 v[44:47], v[140:143], v[104:107], v[44:47]
ds_read_b64_tr_b16 v[154:155], v26 offset:512
v_mfma_f32_16x16x32_bf16 v[72:75], v[144:147], v[104:107], v[72:75]
ds_read_b128 v[120:123], v25 offset:18432
v_mfma_f32_16x16x32_bf16 v[76:79], v[148:151], v[104:107], v[76:79]
ds_read_b64_tr_b16 v[156:157], v26 offset:4096
v_mfma_f32_16x16x32_bf16 v[48:51], v[136:139], v[108:111], v[48:51]
ds_read_b64_tr_b16 v[158:159], v26 offset:4608
v_mfma_f32_16x16x32_bf16 v[52:55], v[140:143], v[108:111], v[52:55]
ds_read_b128 v[124:127], v25 offset:20480
v_mfma_f32_16x16x32_bf16 v[80:83], v[144:147], v[108:111], v[80:83]
ds_read_b64_tr_b16 v[160:161], v27 offset:0
v_mfma_f32_16x16x32_bf16 v[84:87], v[148:151], v[108:111], v[84:87]
ds_read_b64_tr_b16 v[162:163], v27 offset:512
v_mfma_f32_16x16x32_bf16 v[56:59], v[136:139], v[112:115], v[56:59]
ds_read_b128 v[128:131], v25 offset:22528
v_mfma_f32_16x16x32_bf16 v[60:63], v[140:143], v[112:115], v[60:63]
ds_read_b64_tr_b16 v[164:165], v27 offset:4096
v_mfma_f32_16x16x32_bf16 v[88:91], v[144:147], v[112:115], v[88:91]
ds_read_b64_tr_b16 v[166:167], v27 offset:4608
v_mfma_f32_16x16x32_bf16 v[92:95], v[148:151], v[112:115], v[92:95]
ds_read_b128 v[132:135], v25 offset:24576
v_mfma_f32_16x16x32_bf16 v[64:67], v[136:139], v[116:119], v[64:67]
buffer_load_dword v37, v32, s[24:27], 0 offen sc1
v_mfma_f32_16x16x32_bf16 v[68:71], v[140:143], v[116:119], v[68:71]
v_mfma_f32_16x16x32_bf16 v[96:99], v[144:147], v[116:119], v[96:99]
v_mfma_f32_16x16x32_bf16 v[100:103], v[148:151], v[116:119], v[100:103]
s_waitcnt vmcnt(1) lgkmcnt(0)
s_barrier
v_mfma_f32_16x16x32_bf16 v[40:43], v[152:155], v[120:123], v[40:43]
v_mfma_f32_16x16x32_bf16 v[44:47], v[156:159], v[120:123], v[44:47]
v_mfma_f32_16x16x32_bf16 v[72:75], v[160:163], v[120:123], v[72:75]
v_mfma_f32_16x16x32_bf16 v[76:79], v[164:167], v[120:123], v[76:79]
v_mfma_f32_16x16x32_bf16 v[48:51], v[152:155], v[124:127], v[48:51]
v_mfma_f32_16x16x32_bf16 v[52:55], v[156:159], v[124:127], v[52:55]
v_mfma_f32_16x16x32_bf16 v[80:83], v[160:163], v[124:127], v[80:83]
v_mfma_f32_16x16x32_bf16 v[84:87], v[164:167], v[124:127], v[84:87]
v_mfma_f32_16x16x32_bf16 v[56:59], v[152:155], v[128:131], v[56:59]
v_mfma_f32_16x16x32_bf16 v[60:63], v[156:159], v[128:131], v[60:63]
v_mfma_f32_16x16x32_bf16 v[88:91], v[160:163], v[128:131], v[88:91]
v_mfma_f32_16x16x32_bf16 v[92:95], v[164:167], v[128:131], v[92:95]
v_mfma_f32_16x16x32_bf16 v[64:67], v[152:155], v[132:135], v[64:67]
v_mfma_f32_16x16x32_bf16 v[68:71], v[156:159], v[132:135], v[68:71]
v_mfma_f32_16x16x32_bf16 v[96:99], v[160:163], v[132:135], v[96:99]
v_mfma_f32_16x16x32_bf16 v[100:103], v[164:167], v[132:135], v[100:103]
s_setprio 0
s_waitcnt vmcnt(1) lgkmcnt(0)
s_barrier
s_waitcnt vmcnt(0)
v_add_u32 v31, 1, v31
s_mov_b32 s48, 0
L_F16_ck:
v_cmp_ne_u32 vcc, v37, v31
s_add_u32 s48, s48, 1
s_nop 2
s_cmp_eq_u64 vcc, 0
s_cbranch_scc1 L_F16_ok
s_cmp_gt_u32 s48, 20000
s_cbranch_scc1 L_F16_ok
s_sleep 4
buffer_load_dword v37, v32, s[24:27], 0 offen sc1
s_waitcnt vmcnt(0)
s_branch L_F16_ck
L_F16_ok:
s_add_u32 s46, s23, 0
buffer_load_dwordx4 v[104:107], v34, s[24:27], s46 offen sc1
s_add_u32 s46, s23, 5120
buffer_load_dwordx4 v[108:111], v34, s[24:27], s46 offen sc1
s_add_u32 s46, s23, 10240
buffer_load_dwordx4 v[112:115], v34, s[24:27], s46 offen sc1
s_add_u32 s46, s23, 15360
buffer_load_dwordx4 v[116:119], v34, s[24:27], s46 offen sc1
buffer_load_dwordx4 v[120:123], v35, s[24:27], s23 offen offset:1024 sc1
s_min_u32 s46, s43, 2048
s_add_u32 m0, s46, 157696
s_nop 0
buffer_load_dwordx4 v33, s[24:27], 0 offen sc1 lds
s_waitcnt vmcnt(7) lgkmcnt(0)
s_barrier
s_add_u32 m0, s86, 61440
s_nop 0
buffer_load_dwordx4 v4, s[28:31], s73 offen lds
s_add_u32 m0, s86, 62464
s_add_u32 s46, s73, 8192
buffer_load_dwordx4 v4, s[28:31], s46 offen lds
s_add_u32 m0, s86, 63488
s_nop 0
buffer_load_dwordx4 v5, s[28:31], s73 offen lds
s_add_u32 m0, s86, 64512
s_add_u32 s46, s73, 8192
buffer_load_dwordx4 v5, s[28:31], s46 offen lds
s_waitcnt vmcnt(4)
v_add_f32_dpp v120, v120, v120 row_ror:4 row_mask:0xf bank_mask:0xf
v_add_f32_dpp v121, v121, v121 row_ror:4 row_mask:0xf bank_mask:0xf
v_add_f32_dpp v122, v122, v122 row_ror:4 row_mask:0xf bank_mask:0xf
v_add_f32_dpp v123, v123, v123 row_ror:4 row_mask:0xf bank_mask:0xf
v_add_f32 v104, v104, v108
v_add_f32 v112, v112, v116
v_add_f32 v105, v105, v109
v_add_f32 v113, v113, v117
v_add_f32 v106, v106, v110
v_add_f32 v114, v114, v118
v_add_f32 v107, v107, v111
v_add_f32 v115, v115, v119
v_add_f32_dpp v120, v120, v120 row_ror:8 row_mask:0xf bank_mask:0xf
v_add_f32_dpp v121, v121, v121 row_ror:8 row_mask:0xf bank_mask:0xf
v_add_f32_dpp v122, v122, v122 row_ror:8 row_mask:0xf bank_mask:0xf
v_add_f32_dpp v123, v123, v123 row_ror:8 row_mask:0xf bank_mask:0xf
v_add_f32 v104, v104, v112
v_add_f32 v105, v105, v113
v_add_f32 v106, v106, v114
v_add_f32 v107, v107, v115
v_permlane32_swap_b32 v120, v122
v_permlane32_swap_b32 v121, v123
v_permlane32_swap_b32 v104, v106
v_permlane32_swap_b32 v105, v107
s_nop 0
v_add_f32 v120, v120, v122
v_add_f32 v121, v121, v123
v_add_f32 v104, v104, v106
v_add_f32 v105, v105, v107
v_lshlrev_b32 v108, 2, v2
v_lshl_add_u32 v112, v3, 4, v108
v_and_b32 v116, 3, v3
v_lshl_add_u32 v116, v116, 4, v108
v_permlane16_swap_b32 v120, v121
v_permlane16_swap_b32 v104, v105
v_lshl_add_u32 v112, s42, 8, v112
v_lshl_add_u32 v116, s42, 6, v116
v_add_u32 v112, 160768, v112
v_add_u32 v116, 161792, v116
v_add_f32 v104, v104, v105
v_add_f32_e64 v120, v120, v121
ds_write_b32 v112, v104
ds_write_b32 v116, v120
s_waitcnt vmcnt(11) lgkmcnt(0)
s_barrier
s_waitcnt vmcnt(0)
ds_read_b64_tr_b16 v[240:241], v6 offset:61440
ds_read_b64_tr_b16 v[242:243], v6 offset:62464
ds_read_b64_tr_b16 v[244:245], v7 offset:61440
ds_read_b64_tr_b16 v[246:247], v7 offset:62464
ds_read_b64_tr_b16 v[248:249], v8 offset:61440
ds_read_b64_tr_b16 v[250:251], v8 offset:62464
ds_read_b64_tr_b16 v[252:253], v9 offset:61440
ds_read_b64_tr_b16 v[254:255], v9 offset:62464
s_waitcnt lgkmcnt(0)
s_add_u32 m0, s86, 61440
s_nop 0
buffer_load_dwordx4 v4, s[28:31], s72 offen lds
s_add_u32 m0, s86, 62464
s_add_u32 s46, s72, 8192
buffer_load_dwordx4 v4, s[28:31], s46 offen lds
s_add_u32 m0, s86, 63488
s_nop 0
buffer_load_dwordx4 v5, s[28:31], s72 offen lds
s_add_u32 m0, s86, 64512
s_add_u32 s46, s72, 8192
buffer_load_dwordx4 v5, s[28:31], s46 offen lds
s_and_b32 s50, s42, 1
s_lshl_b32 s48, s50, 7
s_add_u32 s48, s48, 160768
v_lshl_add_u32 v14, v2, 4, s48
ds_read_b128 v[120:123], v14 offset:768
ds_read_b128 v[144:147], v14 offset:1024
ds_read_b128 v[124:127], v14 offset:832
ds_read_b128 v[148:151], v14 offset:1088
s_lshl_b32 s49, s63, 10
s_add_u32 s49, s49, 157952
v_lshl_add_u32 v10, v3, 4, s49
ds_read_b128 v[104:107], v10 offset:0
ds_read_b128 v[108:111], v10 offset:256
ds_read_b128 v[112:115], v10 offset:512
ds_read_b128 v[116:119], v10 offset:768
v_lshrrev_b32 v15, 5, v1
v_lshlrev_b32 v15, 10, v15
v_and_b32 v16, 31, v1
v_lshl_add_u32 v132, v16, 4, v15
s_lshl1_add_u32 s48, s40, s63
s_mul_i32 s60, s48, 294912
s_add_u32 s60, s60, 65536
s_lshr_b32 s48, s52, 6
s_add_u32 s48, s48, s50
s_lshl_b32 s48, s48, 12
s_add_u32 s60, s60, s48
s_waitcnt lgkmcnt(0)
v_mul_f32 v104, 0xbfb8aa3b, v104
v_mul_f32 v107, 0xbfb8aa3b, v107
v_mul_f32 v108, 0xbfb8aa3b, v108
v_mul_f32 v111, 0xbfb8aa3b, v111
v_mul_f32 v112, 0xbfb8aa3b, v112
v_mul_f32 v115, 0xbfb8aa3b, v115
v_mul_f32 v116, 0xbfb8aa3b, v116
v_mul_f32 v119, 0xbfb8aa3b, v119
v_mul_f32 v10, v124, v115
v_mul_f32 v11, v125, v115
v_mul_f32 v12, v126, v115
v_mul_f32 v13, v127, v115
v_mul_f32 v14, v124, v119
v_mul_f32 v15, v125, v119
v_mul_f32 v16, v126, v119
v_mul_f32 v17, v127, v119
v_fma_f32 v88, v88, v112, v10
v_fma_f32 v89, v89, v112, v11
v_fma_f32 v90, v90, v112, v12
v_fma_f32 v91, v91, v112, v13
v_fma_f32 v96, v96, v116, v14
v_fma_f32 v97, v97, v116, v15
s_waitcnt vmcnt(15) lgkmcnt(0)
s_barrier
s_waitcnt vmcnt(0)
ds_read_b64_tr_b16 v[224:225], v6 offset:61440
ds_read_b64_tr_b16 v[226:227], v6 offset:62464
ds_read_b64_tr_b16 v[228:229], v7 offset:61440
ds_read_b64_tr_b16 v[230:231], v7 offset:62464
ds_read_b64_tr_b16 v[232:233], v8 offset:61440
ds_read_b64_tr_b16 v[234:235], v8 offset:62464
ds_read_b64_tr_b16 v[236:237], v9 offset:61440
ds_read_b64_tr_b16 v[238:239], v9 offset:62464
s_waitcnt lgkmcnt(0)
s_add_u32 m0, s86, 61440
s_nop 0
buffer_load_dwordx4 v4, s[28:31], s71 offen lds
s_add_u32 m0, s86, 62464
s_add_u32 s46, s71, 8192
buffer_load_dwordx4 v4, s[28:31], s46 offen lds
s_add_u32 m0, s86, 63488
s_nop 0
buffer_load_dwordx4 v5, s[28:31], s71 offen lds
s_add_u32 m0, s86, 64512
s_add_u32 s46, s71, 8192
buffer_load_dwordx4 v5, s[28:31], s46 offen lds
v_fma_f32 v98, v98, v116, v16
v_fma_f32 v99, v99, v116, v17
v_exp_f32 v88, v88
v_exp_f32 v89, v89
v_exp_f32 v90, v90
v_exp_f32 v91, v91
v_exp_f32 v96, v96
v_exp_f32 v97, v97
v_exp_f32 v98, v98
v_exp_f32 v99, v99
v_fmac_f32 v92, v148, v113
v_fmac_f32 v93, v149, v113
v_fmac_f32 v94, v150, v113
v_fmac_f32 v95, v151, v113
v_fmac_f32 v100, v148, v117
v_fmac_f32 v101, v149, v117
v_fmac_f32 v102, v150, v117
v_fmac_f32 v103, v151, v117
v_fma_f32 v88, v88, v114, v114
v_fma_f32 v89, v89, v114, v114
v_fma_f32 v90, v90, v114, v114
v_fma_f32 v91, v91, v114, v114
v_fma_f32 v96, v96, v118, v118
v_fma_f32 v97, v97, v118, v118
v_fma_f32 v98, v98, v118, v118
v_fma_f32 v99, v99, v118, v118
v_rcp_f32 v88, v88
v_rcp_f32 v89, v89
v_rcp_f32 v90, v90
v_rcp_f32 v91, v91
v_rcp_f32 v96, v96
v_rcp_f32 v97, v97
v_rcp_f32 v98, v98
v_rcp_f32 v99, v99
s_nop 0
v_mul_f32 v92, v92, v88
v_mul_f32 v93, v93, v89
v_mul_f32 v94, v94, v90
v_mul_f32 v95, v95, v91
v_mul_f32 v100, v100, v96
v_mul_f32 v101, v101, v97
v_mul_f32 v102, v102, v98
v_mul_f32 v103, v103, v99
s_waitcnt vmcnt(19) lgkmcnt(0)
s_barrier
s_waitcnt vmcnt(0)
ds_read_b64_tr_b16 v[208:209], v6 offset:61440
ds_read_b64_tr_b16 v[210:211], v6 offset:62464
ds_read_b64_tr_b16 v[212:213], v7 offset:61440
ds_read_b64_tr_b16 v[214:215], v7 offset:62464
ds_read_b64_tr_b16 v[216:217], v8 offset:61440
ds_read_b64_tr_b16 v[218:219], v8 offset:62464
ds_read_b64_tr_b16 v[220:221], v9 offset:61440
ds_read_b64_tr_b16 v[222:223], v9 offset:62464
s_waitcnt lgkmcnt(0)
s_add_u32 m0, s86, 61440
s_nop 0
buffer_load_dwordx4 v4, s[28:31], s70 offen lds
s_add_u32 m0, s86, 62464
s_add_u32 s46, s70, 8192
buffer_load_dwordx4 v4, s[28:31], s46 offen lds
s_add_u32 m0, s86, 63488
s_nop 0
buffer_load_dwordx4 v5, s[28:31], s70 offen lds
s_add_u32 m0, s86, 64512
s_add_u32 s46, s70, 8192
buffer_load_dwordx4 v5, s[28:31], s46 offen lds
v_cvt_pk_bf16_f32 v136, v92, v93
v_cvt_pk_bf16_f32 v137, v94, v95
v_cvt_pk_bf16_f32 v138, v100, v101
v_cvt_pk_bf16_f32 v139, v102, v103
s_nop 1
v_permlane32_swap_b32 v136, v138
v_permlane32_swap_b32 v137, v139
buffer_store_dwordx4 v[136:139], v132, s[24:27], s60 offen offset:2560 sc1
v_mul_f32 v10, v124, v107
v_mul_f32 v11, v125, v107
v_mul_f32 v12, v126, v107
v_mul_f32 v13, v127, v107
v_mul_f32 v14, v124, v111
v_mul_f32 v15, v125, v111
v_mul_f32 v16, v126, v111
v_mul_f32 v17, v127, v111
v_fma_f32 v72, v72, v104, v10
v_fma_f32 v73, v73, v104, v11
v_fma_f32 v74, v74, v104, v12
v_fma_f32 v75, v75, v104, v13
v_fma_f32 v80, v80, v108, v14
v_fma_f32 v81, v81, v108, v15
v_fma_f32 v82, v82, v108, v16
v_fma_f32 v83, v83, v108, v17
v_exp_f32 v72, v72
v_exp_f32 v73, v73
v_exp_f32 v74, v74
v_exp_f32 v75, v75
v_exp_f32 v80, v80
v_exp_f32 v81, v81
v_exp_f32 v82, v82
v_exp_f32 v83, v83
v_fmac_f32 v76, v148, v105
v_fmac_f32 v77, v149, v105
v_fmac_f32 v78, v150, v105
v_fmac_f32 v79, v151, v105
v_fmac_f32 v84, v148, v109
v_fmac_f32 v85, v149, v109
s_waitcnt vmcnt(24) lgkmcnt(0)
s_barrier
s_waitcnt vmcnt(1)
ds_read_b64_tr_b16 v[192:193], v6 offset:61440
ds_read_b64_tr_b16 v[194:195], v6 offset:62464
ds_read_b64_tr_b16 v[196:197], v7 offset:61440
ds_read_b64_tr_b16 v[198:199], v7 offset:62464
ds_read_b64_tr_b16 v[200:201], v8 offset:61440
ds_read_b64_tr_b16 v[202:203], v8 offset:62464
ds_read_b64_tr_b16 v[204:205], v9 offset:61440
ds_read_b64_tr_b16 v[206:207], v9 offset:62464
s_waitcnt lgkmcnt(0)
s_add_u32 m0, s86, 61440
s_nop 0
buffer_load_dwordx4 v4, s[28:31], s69 offen lds
s_add_u32 m0, s86, 62464
s_add_u32 s46, s69, 8192
buffer_load_dwordx4 v4, s[28:31], s46 offen lds
s_add_u32 m0, s86, 63488
s_nop 0
buffer_load_dwordx4 v5, s[28:31], s69 offen lds
s_add_u32 m0, s86, 64512
s_add_u32 s46, s69, 8192
buffer_load_dwordx4 v5, s[28:31], s46 offen lds
s_add_u32 m0, s86, 139264
s_nop 0
buffer_load_dwordx4 v4, s[28:31], s68 offen lds
s_add_u32 m0, s86, 140288
s_add_u32 s46, s68, 8192
buffer_load_dwordx4 v4, s[28:31], s46 offen lds
s_add_u32 m0, s86, 141312
s_nop 0
buffer_load_dwordx4 v5, s[28:31], s68 offen lds
s_add_u32 m0, s86, 142336
s_add_u32 s46, s68, 8192
buffer_load_dwordx4 v5, s[28:31], s46 offen lds
v_fmac_f32 v86, v150, v109
v_fmac_f32 v87, v151, v109
v_fma_f32 v72, v72, v106, v106
v_fma_f32 v73, v73, v106, v106
v_fma_f32 v74, v74, v106, v106
v_fma_f32 v75, v75, v106, v106
v_fma_f32 v80, v80, v110, v110
v_fma_f32 v81, v81, v110, v110
v_fma_f32 v82, v82, v110, v110
v_fma_f32 v83, v83, v110, v110
v_rcp_f32 v72, v72
v_rcp_f32 v73, v73
v_rcp_f32 v74, v74
v_rcp_f32 v75, v75
v_rcp_f32 v80, v80
v_rcp_f32 v81, v81
v_rcp_f32 v82, v82
v_rcp_f32 v83, v83
s_nop 0
v_mul_f32 v76, v76, v72
v_mul_f32 v77, v77, v73
s_waitcnt vmcnt(32) lgkmcnt(0)
s_barrier
s_waitcnt vmcnt(4)
ds_read_b64_tr_b16 v[176:177], v6 offset:61440
ds_read_b64_tr_b16 v[178:179], v6 offset:62464
ds_read_b64_tr_b16 v[180:181], v7 offset:61440
ds_read_b64_tr_b16 v[182:183], v7 offset:62464
ds_read_b64_tr_b16 v[184:185], v8 offset:61440
ds_read_b64_tr_b16 v[186:187], v8 offset:62464
ds_read_b64_tr_b16 v[188:189], v9 offset:61440
ds_read_b64_tr_b16 v[190:191], v9 offset:62464
s_waitcnt lgkmcnt(0)
s_add_u32 m0, s86, 61440
s_nop 0
buffer_load_dwordx4 v4, s[28:31], s67 offen lds
s_add_u32 m0, s86, 62464
s_add_u32 s46, s67, 8192
buffer_load_dwordx4 v4, s[28:31], s46 offen lds
s_add_u32 m0, s86, 63488
s_nop 0
buffer_load_dwordx4 v5, s[28:31], s67 offen lds
s_add_u32 m0, s86, 64512
s_add_u32 s46, s67, 8192
buffer_load_dwordx4 v5, s[28:31], s46 offen lds
s_add_u32 m0, s86, 120832
s_nop 0
buffer_load_dwordx4 v4, s[28:31], s66 offen lds
s_add_u32 m0, s86, 121856
s_add_u32 s46, s66, 8192
buffer_load_dwordx4 v4, s[28:31], s46 offen lds
s_add_u32 m0, s86, 122880
s_nop 0
buffer_load_dwordx4 v5, s[28:31], s66 offen lds
s_add_u32 m0, s86, 123904
s_add_u32 s46, s66, 8192
buffer_load_dwordx4 v5, s[28:31], s46 offen lds
v_mul_f32 v78, v78, v74
v_mul_f32 v79, v79, v75
v_mul_f32 v84, v84, v80
v_mul_f32 v85, v85, v81
v_mul_f32 v86, v86, v82
v_mul_f32_e64 v87, v87, v83
v_cvt_pk_bf16_f32 v140, v76, v77
v_cvt_pk_bf16_f32 v141, v78, v79
v_cvt_pk_bf16_f32 v142, v84, v85
v_cvt_pk_bf16_f32 v143, v86, v87
s_nop 1
v_permlane32_swap_b32 v140, v142
v_permlane32_swap_b32 v141, v143
buffer_store_dwordx4 v[140:143], v132, s[24:27], s60 offen offset:512 sc1
v_mul_f32 v10, v120, v115
v_mul_f32 v11, v121, v115
s_waitcnt vmcnt(41) lgkmcnt(0)
s_barrier
v_mul_f32 v12, v122, v115
v_mul_f32 v13, v123, v115
v_mul_f32 v14, v120, v119
v_mul_f32 v15, v121, v119
v_mul_f32 v16, v122, v119
v_mul_f32_e64 v17, v123, v119
v_fma_f32 v56, v56, v112, v10
v_fma_f32 v57, v57, v112, v11
v_fma_f32 v58, v58, v112, v12
v_fma_f32 v59, v59, v112, v13
v_fma_f32 v64, v64, v116, v14
v_fma_f32 v65, v65, v116, v15
v_fma_f32 v66, v66, v116, v16
v_fma_f32 v67, v67, v116, v17
v_exp_f32 v56, v56
v_exp_f32 v57, v57
v_exp_f32 v58, v58
v_exp_f32 v59, v59
v_exp_f32 v64, v64
v_exp_f32 v65, v65
v_exp_f32 v66, v66
v_exp_f32 v67, v67
v_fmac_f32 v60, v144, v113
v_fmac_f32 v61, v145, v113
v_fmac_f32 v62, v146, v113
v_fmac_f32 v63, v147, v113
v_fmac_f32 v68, v144, v117
v_fmac_f32 v69, v145, v117
v_fmac_f32 v70, v146, v117
v_fmac_f32 v71, v147, v117
v_fma_f32 v56, v56, v114, v114
v_fma_f32 v57, v57, v114, v114
v_fma_f32 v58, v58, v114, v114
v_fma_f32 v59, v59, v114, v114
v_fma_f32 v64, v64, v118, v118
v_fma_f32 v65, v65, v118, v118
v_fma_f32 v66, v66, v118, v118
v_fma_f32 v67, v67, v118, v118
s_waitcnt vmcnt(41) lgkmcnt(0)
s_barrier
s_setprio 2
v_rcp_f32 v56, v56
v_rcp_f32 v57, v57
v_rcp_f32 v58, v58
v_rcp_f32 v59, v59
v_rcp_f32 v64, v64
v_rcp_f32 v65, v65
v_rcp_f32 v66, v66
v_rcp_f32 v67, v67
s_nop 0
v_pk_mul_f32 v[60:61], v[60:61], v[56:57]
v_pk_mul_f32 v[62:63], v[62:63], v[58:59]
v_pk_mul_f32 v[68:69], v[68:69], v[64:65]
v_pk_mul_f32 v[70:71], v[70:71], v[66:67]
v_cvt_pk_bf16_f32 v136, v60, v61
v_cvt_pk_bf16_f32 v137, v62, v63
v_cvt_pk_bf16_f32 v138, v68, v69
v_cvt_pk_bf16_f32 v139, v70, v71
s_nop 1
v_permlane32_swap_b32 v136, v138
v_permlane32_swap_b32 v137, v139
buffer_store_dwordx4 v[136:139], v132, s[24:27], s60 offen offset:2048 sc1
v_pk_mul_f32 v[10:11], v[120:121], v[106:107] op_sel:[0,1] op_sel_hi:[1,1]
v_pk_mul_f32 v[12:13], v[122:123], v[106:107] op_sel:[0,1] op_sel_hi:[1,1]
v_pk_mul_f32 v[14:15], v[120:121], v[110:111] op_sel:[0,1] op_sel_hi:[1,1]
v_pk_mul_f32 v[16:17], v[122:123], v[110:111] op_sel:[0,1] op_sel_hi:[1,1]
v_pk_fma_f32 v[40:41], v[40:41], v[104:105], v[10:11] op_sel:[0,0,0] op_sel_hi:[1,0,1]
v_pk_fma_f32 v[42:43], v[42:43], v[104:105], v[12:13] op_sel:[0,0,0] op_sel_hi:[1,0,1]
v_pk_fma_f32 v[48:49], v[48:49], v[108:109], v[14:15] op_sel:[0,0,0] op_sel_hi:[1,0,1]
v_pk_fma_f32 v[50:51], v[50:51], v[108:109], v[16:17] op_sel:[0,0,0] op_sel_hi:[1,0,1]
v_exp_f32 v40, v40
v_exp_f32 v41, v41
v_exp_f32 v42, v42
v_exp_f32 v43, v43
v_exp_f32 v48, v48
v_exp_f32 v49, v49
v_exp_f32 v50, v50
v_exp_f32_e64 v51, v51
v_pk_fma_f32 v[44:45], v[144:145], v[104:105], v[44:45] op_sel:[0,1,0] op_sel_hi:[1,1,1]
v_pk_fma_f32 v[46:47], v[146:147], v[104:105], v[46:47] op_sel:[0,1,0] op_sel_hi:[1,1,1]
v_pk_fma_f32 v[52:53], v[144:145], v[108:109], v[52:53] op_sel:[0,1,0] op_sel_hi:[1,1,1]
v_pk_fma_f32 v[54:55], v[146:147], v[108:109], v[54:55] op_sel:[0,1,0] op_sel_hi:[1,1,1]
v_pk_fma_f32 v[40:41], v[40:41], v[106:107], v[106:107] op_sel:[0,0,0] op_sel_hi:[1,0,0]
v_pk_fma_f32 v[42:43], v[42:43], v[106:107], v[106:107] op_sel:[0,0,0] op_sel_hi:[1,0,0]
v_pk_fma_f32 v[48:49], v[48:49], v[110:111], v[110:111] op_sel:[0,0,0] op_sel_hi:[1,0,0]
v_pk_fma_f32 v[50:51], v[50:51], v[110:111], v[110:111] op_sel:[0,0,0] op_sel_hi:[1,0,0]
v_rcp_f32 v40, v40
v_rcp_f32 v41, v41
v_rcp_f32 v42, v42
v_rcp_f32 v43, v43
v_rcp_f32 v48, v48
v_rcp_f32 v49, v49
v_rcp_f32 v50, v50
v_rcp_f32 v51, v51
s_nop 0
v_pk_mul_f32 v[44:45], v[44:45], v[40:41]
v_pk_mul_f32 v[46:47], v[46:47], v[42:43]
v_pk_mul_f32 v[52:53], v[52:53], v[48:49]
v_pk_mul_f32 v[54:55], v[54:55], v[50:51]
v_cvt_pk_bf16_f32 v140, v44, v45
v_cvt_pk_bf16_f32 v141, v46, v47
v_cvt_pk_bf16_f32 v142, v52, v53
v_cvt_pk_bf16_f32 v143, v54, v55
s_nop 1
v_permlane32_swap_b32 v140, v142
v_permlane32_swap_b32 v141, v143
buffer_store_dwordx4 v[140:143], v132, s[24:27], s60 offen offset:0 sc1
v_lshlrev_b32 v10, 2, v1
v_add_u32 v10, 162880, v10
v_mov_b32 v14, 1
v_lshlrev_b32_e64 v13, 2, v3
v_add_u32 v13, 162432, v13
ds_read_b32 v11, v13
v_lshlrev_b32 v15, 7, v3
v_lshl_add_u32 v15, v2, 27, v15
s_waitcnt vmcnt(0)
ds_add_rtn_u32 v12, v10, v14
s_waitcnt lgkmcnt(0)
v_readfirstlane_b32 s48, v12
s_nop 3
s_cmp_eq_u32 s48, 3
s_cbranch_scc0 L_F16_nosig
buffer_store_dword v11, v15, s[24:27], s87 offen offset:64 sc1
L_F16_nosig:
s_waitcnt vmcnt(7)
ds_read_b64_tr_b16 v[144:145], v6 offset:61440
ds_read_b64_tr_b16 v[146:147], v6 offset:62464
ds_read_b64_tr_b16 v[148:149], v7 offset:61440
ds_read_b64_tr_b16 v[150:151], v7 offset:62464
ds_read_b64_tr_b16 v[152:153], v8 offset:61440
ds_read_b64_tr_b16 v[154:155], v8 offset:62464
ds_read_b64_tr_b16 v[156:157], v9 offset:61440
ds_read_b64_tr_b16 v[158:159], v9 offset:62464
s_waitcnt vmcnt(11)
v_add_u32 v18, 139264, v6
ds_read_b64_tr_b16 v[160:161], v18
ds_read_b64_tr_b16 v[162:163], v18 offset:1024
v_add_u32 v19, 139264, v7
ds_read_b64_tr_b16 v[164:165], v19
ds_read_b64_tr_b16 v[166:167], v19 offset:1024
v_add_u32 v20, 139264, v8
ds_read_b64_tr_b16 v[168:169], v20
ds_read_b64_tr_b16 v[170:171], v20 offset:1024
v_add_u32 v21, 139264, v9
ds_read_b64_tr_b16 v[172:173], v21
ds_read_b64_tr_b16 v[174:175], v21 offset:1024
s_waitcnt vmcnt(3)
v_add_u32 v18, 120832, v6
ds_read_b64_tr_b16 v[128:129], v18
ds_read_b64_tr_b16 v[130:131], v18 offset:1024
v_add_u32 v19, 120832, v7
ds_read_b64_tr_b16 v[132:133], v19
ds_read_b64_tr_b16 v[134:135], v19 offset:1024
v_add_u32 v20, 120832, v8
ds_read_b64_tr_b16 v[136:137], v20
ds_read_b64_tr_b16 v[138:139], v20 offset:1024
v_add_u32 v21, 120832, v9
ds_read_b64_tr_b16 v[140:141], v21
ds_read_b64_tr_b16 v[142:143], v21 offset:1024
s_branch L_P2_1
.p2align 3
L_H:
s_lshl_b32 s48, s40, 17
s_sub_u32 s49, s48, 16384
s_cmp_eq_u32 s40, 0
s_cselect_b32 s48, 0, s49
s_bitcmp1_b32 s42, 0
s_cselect_b64 vcc, -1, 0
v_cndmask_b32 v30, v14, v15, vcc
v_add_u32 v30, s48, v30
s_and_b32 s48, s42, 1
s_lshl_b32 s48, s48, 10
s_add_u32 s53, s48, 100352
v_and_b32 v12, 2, v10
s_and_b32 s48, s42, 1
s_lshl_b32 s48, s48, 2
v_or_b32 v12, s48, v12
v_xor_b32 v12, v12, v11
v_lshlrev_b32_e64 v12, 4, v12
v_lshl_add_u32 v13, s42, 3, v10
v_mul_u32_u24 v184, 3584, v13
v_add_u32_e64 v184, v184, v12
v_mul_u32_u24 v27, 3072, v13
v_add3_u32 v27, v27, v12, s45
v_add_u32 v184, s52, v184
s_mov_b32 s8, s66
s_and_b32 s9, s67, 0xffff
s_mov_b32 s10, 1572864
s_mov_b32 s11, 0x20000
s_mov_b32 s12, s72
s_and_b32 s13, s73, 0xffff
s_mov_b32 s14, 1835008
s_mov_b32 s15, 0x20000
s_mov_b32 s16, s74
s_and_b32 s17, s75, 0xffff
s_mov_b32 s18, 1835008
s_mov_b32 s19, 0x20000
s_mov_b32 s24, s82
s_and_b32 s25, s83, 0xffff
s_mov_b32 s26, 9838592
s_mov_b32 s27, 0x20000
v_lshrrev_b32 v12, 2, v3
v_lshlrev_b32 v10, 7, v12
v_lshl_add_u32 v10, v2, 10, v10
v_and_b32 v13, 3, v3
v_lshl_add_u32 v10, v13, 3, v10
v_lshrrev_b32 v11, 3, v3
v_and_b32 v13, 1, v2
v_lshl_add_u32 v11, v13, 1, v11
s_and_b32 s50, s42, 1
s_lshl_b32 s48, s50, 1
s_add_u32 s49, s48, 1
v_xor_b32 v26, s42, v11
v_lshl_add_u32 v26, v26, 5, v10
v_add_u32 v33, 61440, v26
v_lshrrev_b32 v14, 1, v3
v_xor_b32 v14, v14, v2
v_lshlrev_b32_e64 v14, 4, v14
v_lshl_add_u32 v14, v3, 7, v14
v_add_u32 v22, 83968, v14
v_xor_b32_e64 v23, 64, v22
v_add_u32 v24, 36864, v22
v_add_u32 v25, 36864, v23
v_mov_b32 v36, 0x3f803f80
v_mov_b32 v37, 0x3f803f80
v_mov_b32 v38, 0x3f803f80
v_mov_b32 v39, 0x3f803f80
s_mov_b32 s32, s78
s_and_b32 s33, s79, 0xffff
s_mov_b32 s34, 2097152
s_mov_b32 s35, 0x20000
s_mov_b32 s28, s68
s_and_b32 s29, s69, 0xffff
s_mov_b32 s30, 524288
s_mov_b32 s31, 0x20000
s_add_u32 s50, s84, s85
s_lshl_b32 s51, s42, 17
s_add_u32 s55, s50, 0
s_and_b32 s55, s55, 3
s_lshl_b32 s55, s55, 15
s_add_u32 s73, s55, s51
s_add_u32 s55, s50, 1
s_and_b32 s55, s55, 3
s_lshl_b32 s55, s55, 15
s_add_u32 s72, s55, s51
s_add_u32 s55, s50, 2
s_and_b32 s55, s55, 3
s_lshl_b32 s55, s55, 15
s_add_u32 s71, s55, s51
s_add_u32 s55, s50, 3
s_and_b32 s55, s55, 3
s_lshl_b32 s55, s55, 15
s_add_u32 s70, s55, s51
v_lshrrev_b32 v10, 3, v1
v_and_b32 v11, 6, v10
v_and_b32 v12, 7, v1
v_xor_b32 v11, v11, v12
v_lshlrev_b32_e64 v11, 4, v11
v_lshl_add_u32 v4, v10, 10, v11
v_lshl_add_u32 v4, s85, 7, v4
v_add_u32 v5, 16384, v4
v_and_b32 v10, 1, v2
v_lshlrev_b32 v10, 2, v10
v_lshrrev_b32 v11, 2, v3
v_add_u32 v10, v10, v11
v_lshrrev_b32 v11, 1, v2
v_lshlrev_b32 v11, 11, v11
v_lshl_add_u32 v11, v10, 7, v11
v_and_b32 v12, 3, v3
v_lshl_add_u32 v11, v12, 3, v11
v_add_u32 v11, s86, v11
v_lshrrev_b32 v12, 1, v10
v_lshl_add_u32 v6, v12, 5, v11
v_xor_b32 v7, 32, v6
v_xor_b32 v8, 64, v6
v_xor_b32 v9, 96, v6
s_lshl2_add_u32 s48, s2, s42
s_mul_i32 s48, s48, 4
v_add_u32 v31, s48, v1
v_lshlrev_b32 v31, 7, v31
v_cmp_gt_u32 vcc, 4, v1
v_bfrev_b32 v10, 2
s_nop 0
v_cndmask_b32 v31, v10, v31, vcc
s_add_u32 s48, s62, 16
s_max_u32 s49, s40, 1
s_sub_u32 s49, s49, 1
s_lshl_b32 s48, s48, 8
s_mul_i32 s49, s49, 0x01010000
s_or_b32 s48, s48, s40
s_or_b32 s48, s48, s49
v_lshlrev_b32 v11, 3, v2
v_lshrrev_b32 v186, v11, s48
v_and_b32 v186, 0xff, v186
v_lshlrev_b32_e64 v186, 7, v186
v_lshl_add_u32 v186, v3, 2, v186
v_add_u32 v186, 9437184, v186
s_lshl3_add_u32 s48, s84, s85
s_lshl_b32 s48, s48, 7
s_add_u32 s48, s48, 9805696
v_lshl_add_u32 v10, v1, 2, s48
v_lshlrev_b32 v11, 7, v3
v_lshl_add_u32 v11, v2, 6, v11
v_add_u32 v11, s87, v11
v_cmp_gt_u32 vcc, 32, v1
s_nop 1
v_cndmask_b32 v188, v10, v11, vcc
s_lshl_b32 s48, s40, 7
s_lshl_b32 s49, s62, 3
s_add_u32 s48, s48, s49
s_lshl_b32 s49, s42, 1
s_add_u32 s48, s48, s49
v_lshrrev_b32 v187, 5, v1
v_add_u32 v187, s48, v187
v_and_b32 v10, 31, v1
v_lshlrev_b32 v10, 4, v10
v_lshl_add_u32 v189, v187, 10, v10
v_lshlrev_b32 v187, 4, v187
v_add_u32 v187, 9441280, v187
v_and_b32 v11, 31, v1
v_lshl_add_u32 v187, v11, 26, v187
v_lshlrev_b32 v194, 16, v1
v_bfrev_b32 v10, 2
v_cmp_gt_u32 vcc, 11, v1
s_nop 1
v_cndmask_b32 v194, v10, v194, vcc
s_mul_i32 s60, s40, 589824
s_mul_i32 s61, s84, 294912
s_lshl_b32 s56, s84, 16
s_lshl_b32 s58, 1, s62
s_lshl_b32 s48, 0x10000, s40
s_or_b32 s58, s58, s48
s_mov_b32 s59, 0
s_mul_i32 s50, s40, 114688
s_mul_i32 s51, s40, 98304
s_cmp_eq_u32 s3, 3
s_cbranch_scc0 L_H_nf
buffer_load_dword v185, v186, s[24:27], 0 offen sc1
buffer_load_dword v188, v188, s[24:27], 0 offen sc1
L_H_nf:
buffer_load_dwordx4 v[176:179], v189, s[4:7], 0 offen
buffer_load_dwordx4 v[180:183], v189, s[4:7], 0 offen offset:512
s_add_u32 m0, s43, 61440
s_add_u32 s46, s51, 0
buffer_load_dwordx4 v27, s[8:11], s46 offen lds
s_add_u32 m0, s43, 65536
s_add_u32 s46, s51, 1024
buffer_load_dwordx4 v27, s[8:11], s46 offen lds
s_add_u32 m0, s43, 69632
s_add_u32 s46, s51, 2048
buffer_load_dwordx4 v27, s[8:11], s46 offen lds
s_add_u32 m0, s43, 73728
s_add_u32 s46, s50, 0
buffer_load_dwordx4 v184, s[12:15], s46 offen lds
s_add_u32 m0, s43, 77824
s_add_u32 s46, s50, 0
buffer_load_dwordx4 v184, s[16:19], s46 offen lds
s_waitcnt vmcnt(11) lgkmcnt(0)
s_barrier
s_add_u32 m0, s44, 36864
s_add_u32 s46, s22, 256
buffer_load_dwordx4 v28, s[4:7], s46 offen lds
s_add_u32 m0, s44, 37888
s_add_u32 s46, s22, 256
buffer_load_dwordx4 v29, s[4:7], s46 offen lds
s_add_u32 m0, s44, 38912
s_add_u32 s46, s22, 16640
buffer_load_dwordx4 v28, s[4:7], s46 offen lds
s_add_u32 m0, s44, 39936
s_add_u32 s46, s22, 16640
buffer_load_dwordx4 v29, s[4:7], s46 offen lds
s_waitcnt vmcnt(15) lgkmcnt(0)
s_barrier
s_add_u32 m0, s44, 55296
s_add_u32 s46, s22, 384
buffer_load_dwordx4 v28, s[4:7], s46 offen lds
s_add_u32 m0, s44, 56320
s_add_u32 s46, s22, 384
buffer_load_dwordx4 v29, s[4:7], s46 offen lds
s_waitcnt vmcnt(13) lgkmcnt(0)
s_barrier
s_waitcnt vmcnt(11)
v_lshlrev_b32 v10, 16, v176
v_and_b32 v11, 0xffff0000, v176
v_mov_b32 v14, v10
v_mov_b32 v15, v11
v_mul_f32 v16, v10, v10
v_mul_f32 v17, v11, v11
v_lshlrev_b32 v12, 16, v177
v_and_b32 v13, 0xffff0000, v177
v_add_f32 v14, v14, v12
v_add_f32 v15, v15, v13
v_fmac_f32 v16, v12, v12
v_fmac_f32 v17, v13, v13
v_lshlrev_b32 v10, 16, v178
v_and_b32 v11, 0xffff0000, v178
s_add_u32 m0, s44, 57344
s_add_u32 s46, s22, 16768
buffer_load_dwordx4 v28, s[4:7], s46 offen lds
v_add_f32 v14, v14, v10
v_add_f32 v15, v15, v11
v_fmac_f32 v16, v10, v10
v_fmac_f32 v17, v11, v11
v_lshlrev_b32 v12, 16, v179
v_and_b32 v13, 0xffff0000, v179
v_add_f32 v14, v14, v12
v_add_f32 v15, v15, v13
v_fmac_f32 v16, v12, v12
v_fmac_f32 v17, v13, v13
v_lshlrev_b32 v10, 16, v180
v_and_b32 v11, 0xffff0000, v180
v_add_f32 v14, v14, v10
v_add_f32 v15, v15, v11
v_fmac_f32 v16, v10, v10
v_fmac_f32 v17, v11, v11
v_lshlrev_b32_e64 v12, 16, v181
v_and_b32 v13, 0xffff0000, v181
s_add_u32 m0, s44, 58368
s_add_u32 s46, s22, 16768
buffer_load_dwordx4 v29, s[4:7], s46 offen lds
v_add_f32 v14, v14, v12
v_add_f32 v15, v15, v13
v_fmac_f32 v16, v12, v12
v_fmac_f32 v17, v13, v13
s_waitcnt vmcnt(15) lgkmcnt(0)
s_barrier
v_lshlrev_b32 v10, 16, v182
v_and_b32 v11, 0xffff0000, v182
v_add_f32 v14, v14, v10
v_add_f32 v15, v15, v11
v_fmac_f32 v16, v10, v10
v_fmac_f32 v17, v11, v11
v_lshlrev_b32 v12, 16, v183
v_and_b32 v13, 0xffff0000, v183
s_cmp_lt_u32 s42, 2
s_cbranch_scc0 L_H_hx4
s_add_u32 m0, s53, 0
s_sub_u32 s46, 512, s22
buffer_load_dwordx4 v30, s[4:7], s46 offen lds
L_H_hx4:
v_add_f32 v14, v14, v12
v_add_f32 v15, v15, v13
v_fmac_f32 v16, v12, v12
v_fmac_f32 v17, v13, v13
v_add_f32 v14, v14, v15
v_add_f32 v16, v16, v17
s_nop 0
v_add_f32_dpp v14, v14, v14 row_ror:8 row_mask:0xf bank_mask:0xf
v_add_f32_dpp v16, v16, v16 row_ror:8 row_mask:0xf bank_mask:0xf
s_nop 0
v_add_f32_dpp v14, v14, v14 row_ror:4 row_mask:0xf bank_mask:0xf
v_add_f32_dpp v16, v16, v16 row_ror:4 row_mask:0xf bank_mask:0xf
s_nop 0
s_add_u32 m0, s44, 0
s_sub_u32 s46, 512, s22
buffer_load_dwordx4 v28, s[4:7], s46 offen lds
v_add_f32_dpp v14, v14, v14 row_ror:2 row_mask:0xf bank_mask:0xf
v_add_f32_dpp v16, v16, v16 row_ror:2 row_mask:0xf bank_mask:0xf
s_nop 0
v_add_f32_dpp v14, v14, v14 row_ror:1 row_mask:0xf bank_mask:0xf
v_add_f32_dpp v16, v16, v16 row_ror:1 row_mask:0xf bank_mask:0xf
s_nop 0
v_mov_b32 v15, v14
v_mov_b32 v17, v16
s_nop 1
v_permlane16_swap_b32 v14, v15
v_permlane16_swap_b32 v16, v17
s_nop 0
v_add_f32 v14, v14, v15
v_add_f32_e64 v16, v16, v17
s_add_u32 m0, s44, 1024
s_sub_u32 s46, 512, s22
buffer_load_dwordx4 v29, s[4:7], s46 offen lds
v_mul_f32 v14, 0x3b000000, v14
s_waitcnt vmcnt(6) lgkmcnt(0)
s_barrier
v_mul_f32 v16, 0x3b000000, v16
v_fma_f32 v16, -v14, v14, v16
v_max_f32 v16, 0, v16
v_cvt_pk_bf16_f32 v16, v16, v16
v_lshlrev_b32 v16, 16, v16
s_add_u32 m0, s44, 2048
s_sub_u32 s46, 16896, s22
buffer_load_dwordx4 v28, s[4:7], s46 offen lds
v_add_f32 v16, 0x3727c5ac, v16
v_cvt_pk_bf16_f32 v16, v16, v16
v_lshlrev_b32 v16, 16, v16
v_sqrt_f32 v16, v16
v_cvt_pk_bf16_f32 v14, v14, v14
v_lshlrev_b32_e64 v14, 16, v14
s_add_u32 m0, s44, 3072
s_sub_u32 s46, 16896, s22
buffer_load_dwordx4 v29, s[4:7], s46 offen lds
v_cvt_pk_bf16_f32 v178, v16, v16
v_lshlrev_b32 v178, 16, v178
v_rcp_f32 v176, v178
v_sub_f32 v177, 0, v14
v_mul_f32 v179, v176, v177
buffer_load_dword v32, v31, s[28:31], 0 offen
buffer_store_dwordx4 v[176:179], v187, s[24:27], 0 offen sc1
s_waitcnt vmcnt(10) lgkmcnt(0)
s_barrier
ds_read_b64_tr_b16 v[136:137], v33 offset:0
ds_read_b64_tr_b16 v[138:139], v33 offset:512
ds_read_b64_tr_b16 v[140:141], v33 offset:4096
ds_read_b64_tr_b16 v[142:143], v33 offset:4608
s_cmp_lt_u32 s42, 2
s_cbranch_scc0 L_H_hx5
s_add_u32 m0, s53, 18432
s_sub_u32 s46, 640, s22
buffer_load_dwordx4 v30, s[4:7], s46 offen lds
L_H_hx5:
ds_read_b64_tr_b16 v[144:145], v33 offset:8192
ds_read_b64_tr_b16 v[146:147], v33 offset:8704
ds_read_b64_tr_b16 v[148:149], v33 offset:12288
ds_read_b64_tr_b16 v[150:151], v33 offset:12800
ds_read_b64_tr_b16 v[152:153], v33 offset:16384
ds_read_b64_tr_b16 v[154:155], v33 offset:16896
s_add_u32 m0, s44, 18432
s_sub_u32 s46, 640, s22
buffer_load_dwordx4 v28, s[4:7], s46 offen lds
s_mul_i32 s23, s62, 20480
s_mul_i32 s48, s40, 1280
s_add_u32 s23, s23, s48
s_add_u32 s23, s23, 9478144
s_lshl_b32 s48, s42, 6
s_add_u32 s48, s48, s23
s_mov_b32 s50, 0x100c0400
v_lshlrev_b32 v10, 3, v2
v_lshrrev_b32 v10, v10, s50
v_and_b32 v10, 0xff, v10
v_lshlrev_b32 v10, 6, v10
v_lshl_add_u32 v189, v3, 2, v10
v_lshlrev_b32 v11, 2, v3
v_lshl_add_u32 v11, v2, 27, v11
s_add_u32 m0, s44, 19456
s_sub_u32 s46, 640, s22
buffer_load_dwordx4 v29, s[4:7], s46 offen lds
s_add_u32 s49, s48, 512
s_waitcnt vmcnt(8) lgkmcnt(0)
s_barrier
s_add_u32 m0, s44, 20480
s_sub_u32 s46, 17024, s22
buffer_load_dwordx4 v28, s[4:7], s46 offen lds
s_add_u32 m0, s44, 21504
s_sub_u32 s46, 17024, s22
buffer_load_dwordx4 v29, s[4:7], s46 offen lds
s_waitcnt vmcnt(10) lgkmcnt(0)
s_barrier
s_cmp_lt_u32 s42, 2
s_cbranch_scc0 L_H_hx6
s_add_u32 m0, s53, 36864
s_sub_u32 s46, 768, s22
buffer_load_dwordx4 v30, s[4:7], s46 offen lds
L_H_hx6:
s_add_u32 m0, s44, 36864
s_sub_u32 s46, 768, s22
buffer_load_dwordx4 v28, s[4:7], s46 offen lds
s_add_u32 m0, s44, 37888
s_sub_u32 s46, 768, s22
buffer_load_dwordx4 v29, s[4:7], s46 offen lds
s_waitcnt vmcnt(8) lgkmcnt(0)
s_barrier
s_waitcnt lgkmcnt(0)
v_mfma_f32_16x16x32_bf16 v[156:159], v[36:39], v[136:139], 0
v_mfma_f32_16x16x32_bf16 v[160:163], v[36:39], v[140:143], 0
v_mfma_f32_16x16x32_bf16 v[168:171], v[36:39], v[148:151], 0
v_mfma_f32_16x16x32_bf16 v[172:175], v[36:39], v[152:155], 0
v_mfma_f32_16x16x32_bf16 v[164:167], v[36:39], v[144:147], 0
s_mov_b32 vcc_lo, 0xffff0000
s_mov_b32 vcc_hi, 0xffff0000
s_nop 5
v_cndmask_b32 v156, v156, v160, vcc
v_cndmask_b32 v168, v168, v172, vcc
s_mov_b32 vcc_lo, 0
s_mov_b32 vcc_hi, -1
s_nop 1
v_cndmask_b32 v156, v156, v168, vcc
s_add_u32 m0, s44, 38912
s_sub_u32 s46, 17152, s22
buffer_load_dwordx4 v28, s[4:7], s46 offen lds
buffer_store_dword v156, v189, s[24:27], s48 offen sc1
s_add_u32 m0, s44, 39936
s_sub_u32 s46, 17152, s22
buffer_load_dwordx4 v29, s[4:7], s46 offen lds
buffer_store_dword v164, v11, s[24:27], s49 offen sc1
s_waitcnt vmcnt(12) lgkmcnt(0)
s_barrier
s_cmp_lt_u32 s42, 2
s_cbranch_scc0 L_H_hx7
s_add_u32 m0, s53, 55296
s_sub_u32 s46, 896, s22
buffer_load_dwordx4 v30, s[4:7], s46 offen lds
L_H_hx7:
s_add_u32 m0, s44, 55296
s_sub_u32 s46, 896, s22
buffer_load_dwordx4 v28, s[4:7], s46 offen lds
s_cmp_eq_u32 s3, 3
s_cbranch_scc0 L_H_ns
v_lshlrev_b32 v11, 2, v1
v_add_u32 v11, 162112, v11
v_add_u32 v185, 1, v185
v_add_u32_e64 v188, 1, v188
ds_write_b32 v11, v188 offset:256
L_H_ns:
s_add_u32 m0, s44, 56320
s_sub_u32 s46, 896, s22
buffer_load_dwordx4 v29, s[4:7], s46 offen lds
v_bfrev_b32 v10, 2
v_cndmask_b32 v188, v10, v186, s[58:59]
s_waitcnt vmcnt(8) lgkmcnt(0)
s_barrier
s_add_u32 m0, s44, 57344
s_sub_u32 s46, 17280, s22
buffer_load_dwordx4 v28, s[4:7], s46 offen lds
s_add_u32 m0, s44, 58368
s_sub_u32 s46, 17280, s22
buffer_load_dwordx4 v29, s[4:7], s46 offen lds
s_waitcnt vmcnt(4) lgkmcnt(0)
s_barrier
s_cmp_eq_u32 s3, 3
s_cbranch_scc0 L_H_np
buffer_store_dword v185, v188, s[24:27], 0 offen sc1
L_H_np:
s_add_u32 m0, s43, 49152
s_sub_u32 s46, 1474560, s20
buffer_load_dwordx4 v27, s[8:11], s46 offen lds
s_add_u32 m0, s43, 53248
s_sub_u32 s46, 1475584, s20
buffer_load_dwordx4 v27, s[8:11], s46 offen lds
s_add_u32 m0, s43, 57344
s_sub_u32 s46, 1476608, s20
buffer_load_dwordx4 v27, s[8:11], s46 offen lds
s_waitcnt vmcnt(7) lgkmcnt(0)
s_barrier
s_add_u32 m0, s43, 61440
s_sub_u32 s46, 1376256, s20
buffer_load_dwordx4 v27, s[8:11], s46 offen lds
s_add_u32 m0, s43, 65536
s_sub_u32 s46, 1377280, s20
buffer_load_dwordx4 v27, s[8:11], s46 offen lds
s_add_u32 m0, s43, 69632
s_sub_u32 s46, 1378304, s20
buffer_load_dwordx4 v27, s[8:11], s46 offen lds
s_waitcnt vmcnt(10) lgkmcnt(0)
s_barrier
s_add_u32 m0, s43, 12288
s_sub_u32 s46, 1277952, s20
buffer_load_dwordx4 v27, s[8:11], s46 offen lds
s_add_u32 m0, s43, 16384
s_sub_u32 s46, 1278976, s20
buffer_load_dwordx4 v27, s[8:11], s46 offen lds
s_add_u32 m0, s43, 20480
s_sub_u32 s46, 1280000, s20
buffer_load_dwordx4 v27, s[8:11], s46 offen lds
s_waitcnt vmcnt(9) lgkmcnt(0)
s_barrier
s_waitcnt vmcnt(9) lgkmcnt(0)
s_barrier
s_add_u32 m0, s43, 24576
s_sub_u32 s46, 1179648, s20
buffer_load_dwordx4 v27, s[8:11], s46 offen lds
s_add_u32 m0, s43, 28672
s_sub_u32 s46, 1180672, s20
buffer_load_dwordx4 v27, s[8:11], s46 offen lds
s_add_u32 m0, s43, 32768
s_sub_u32 s46, 1181696, s20
buffer_load_dwordx4 v27, s[8:11], s46 offen lds
s_add_u32 m0, s43, 36864
s_sub_u32 s46, 1081344, s20
buffer_load_dwordx4 v27, s[8:11], s46 offen lds
s_add_u32 m0, s43, 40960
s_sub_u32 s46, 1082368, s20
buffer_load_dwordx4 v27, s[8:11], s46 offen lds
s_add_u32 m0, s43, 45056
s_sub_u32 s46, 1083392, s20
buffer_load_dwordx4 v27, s[8:11], s46 offen lds
s_waitcnt vmcnt(12) lgkmcnt(0)
s_barrier
ds_read_b128 v[40:43], v25 offset:18432
ds_read_b64_tr_b16 v[112:113], v26 offset:49152
ds_read_b128 v[44:47], v25 offset:20480
ds_read_b64_tr_b16 v[114:115], v26 offset:49664
s_add_u32 m0, s43, 0
s_sub_u32 s46, 983040, s20
buffer_load_dwordx4 v27, s[8:11], s46 offen lds
ds_read_b128 v[48:51], v25 offset:22528
ds_read_b128 v[52:55], v25 offset:24576
ds_read_b64_tr_b16 v[116:117], v26 offset:53248
ds_read_b128 v[56:59], v25 offset:26624
ds_read_b64_tr_b16 v[118:119], v26 offset:53760
s_add_u32 m0, s43, 4096
s_sub_u32 s46, 984064, s20
buffer_load_dwordx4 v27, s[8:11], s46 offen lds
ds_read_b128 v[60:63], v25 offset:28672
ds_read_b128 v[64:67], v25 offset:30720
ds_read_b64_tr_b16 v[120:121], v26 offset:57344
ds_read_b128 v[68:71], v25 offset:32768
ds_read_b64_tr_b16 v[122:123], v26 offset:57856
s_add_u32 m0, s43, 8192
s_sub_u32 s46, 985088, s20
buffer_load_dwordx4 v27, s[8:11], s46 offen lds
ds_read_b128 v[72:75], v25 offset:34816
s_setprio 1
s_waitcnt vmcnt(9) lgkmcnt(0)
s_barrier
v_mfma_f32_16x16x32_bf16 v[208:211], v[112:115], v[40:43], 0
v_mfma_f32_16x16x32_bf16 v[136:139], v[116:119], v[40:43], 0
ds_read_b128 v[76:79], v24 offset:18432
v_mfma_f32_16x16x32_bf16 v[172:175], v[40:43], v[120:123], 0
ds_read_b64_tr_b16 v[124:125], v33 offset:0
v_mfma_f32_16x16x32_bf16 v[212:215], v[112:115], v[44:47], 0
ds_read_b128 v[80:83], v24 offset:20480
v_mfma_f32_16x16x32_bf16 v[140:143], v[116:119], v[44:47], 0
v_mfma_f32_16x16x32_bf16 v[176:179], v[44:47], v[120:123], 0
ds_read_b64_tr_b16 v[126:127], v33 offset:512
v_mfma_f32_16x16x32_bf16 v[216:219], v[112:115], v[48:51], 0
ds_read_b128 v[84:87], v24 offset:22528
v_mfma_f32_16x16x32_bf16 v[144:147], v[116:119], v[48:51], 0
s_add_u32 m0, s43, 49152
s_sub_u32 s46, 884736, s20
buffer_load_dwordx4 v27, s[8:11], s46 offen lds
v_mfma_f32_16x16x32_bf16 v[180:183], v[48:51], v[120:123], 0
ds_read_b128 v[88:91], v24 offset:24576
v_mfma_f32_16x16x32_bf16 v[220:223], v[112:115], v[52:55], 0
v_mfma_f32_16x16x32_bf16 v[148:151], v[116:119], v[52:55], 0
ds_read_b64_tr_b16 v[128:129], v33 offset:4096
v_mfma_f32_16x16x32_bf16 v[184:187], v[52:55], v[120:123], 0
ds_read_b128 v[92:95], v24 offset:26624
v_mfma_f32_16x16x32_bf16 v[224:227], v[112:115], v[56:59], 0
ds_read_b64_tr_b16 v[130:131], v33 offset:4608
v_mfma_f32_16x16x32_bf16 v[152:155], v[116:119], v[56:59], 0
v_mfma_f32_16x16x32_bf16 v[188:191], v[56:59], v[120:123], 0
ds_read_b128 v[96:99], v24 offset:28672
v_mfma_f32_16x16x32_bf16 v[228:231], v[112:115], v[60:63], 0
s_add_u32 m0, s43, 53248
s_sub_u32 s46, 885760, s20
buffer_load_dwordx4 v27, s[8:11], s46 offen lds
v_mfma_f32_16x16x32_bf16 v[156:159], v[116:119], v[60:63], 0
ds_read_b128 v[100:103], v24 offset:30720
v_mfma_f32_16x16x32_bf16 v[192:195], v[60:63], v[120:123], 0
ds_read_b64_tr_b16 v[132:133], v33 offset:8192
v_mfma_f32_16x16x32_bf16 v[232:235], v[112:115], v[64:67], 0
v_mfma_f32_16x16x32_bf16 v[160:163], v[116:119], v[64:67], 0
ds_read_b128 v[104:107], v24 offset:32768
v_mfma_f32_16x16x32_bf16 v[196:199], v[64:67], v[120:123], 0
ds_read_b64_tr_b16 v[134:135], v33 offset:8704
v_mfma_f32_16x16x32_bf16 v[236:239], v[112:115], v[68:71], 0
ds_read_b128 v[108:111], v24 offset:34816
v_mfma_f32_16x16x32_bf16 v[164:167], v[116:119], v[68:71], 0
s_add_u32 m0, s43, 57344
s_sub_u32 s46, 886784, s20
buffer_load_dwordx4 v27, s[8:11], s46 offen lds
v_mfma_f32_16x16x32_bf16 v[200:203], v[68:71], v[120:123], 0
v_mfma_f32_16x16x32_bf16 v[168:171], v[116:119], v[72:75], 0
v_mfma_f32_16x16x32_bf16 v[204:207], v[72:75], v[120:123], 0
s_waitcnt lgkmcnt(0)
v_mfma_f32_16x16x32_bf16 v[208:211], v[124:127], v[76:79], v[208:211]
v_mfma_f32_16x16x32_bf16 v[136:139], v[128:131], v[76:79], v[136:139]
ds_read_b128 v[40:43], v25 offset:0
v_mfma_f32_16x16x32_bf16 v[172:175], v[76:79], v[132:135], v[172:175]
v_mfma_f32_16x16x32_bf16 v[212:215], v[124:127], v[80:83], v[212:215]
ds_read_b64_tr_b16 v[112:113], v26 offset:12288
v_mfma_f32_16x16x32_bf16 v[140:143], v[128:131], v[80:83], v[140:143]
ds_read_b128 v[44:47], v25 offset:2048
v_mfma_f32_16x16x32_bf16 v[176:179], v[80:83], v[132:135], v[176:179]
v_mfma_f32_16x16x32_bf16 v[216:219], v[124:127], v[84:87], v[216:219]
ds_read_b64_tr_b16 v[114:115], v26 offset:12800
v_mfma_f32_16x16x32_bf16 v[144:147], v[128:131], v[84:87], v[144:147]
ds_read_b128 v[48:51], v25 offset:4096
v_mfma_f32_16x16x32_bf16 v[180:183], v[84:87], v[132:135], v[180:183]
v_mfma_f32_16x16x32_bf16 v[220:223], v[124:127], v[88:91], v[220:223]
ds_read_b128 v[52:55], v25 offset:6144
v_mfma_f32_16x16x32_bf16 v[148:151], v[128:131], v[88:91], v[148:151]
ds_read_b64_tr_b16 v[116:117], v26 offset:16384
v_mfma_f32_16x16x32_bf16 v[184:187], v[88:91], v[132:135], v[184:187]
v_mfma_f32_16x16x32_bf16 v[224:227], v[124:127], v[92:95], v[224:227]
ds_read_b128 v[56:59], v25 offset:8192
v_mfma_f32_16x16x32_bf16 v[152:155], v[128:131], v[92:95], v[152:155]
ds_read_b64_tr_b16 v[118:119], v26 offset:16896
v_mfma_f32_16x16x32_bf16 v[188:191], v[92:95], v[132:135], v[188:191]
v_mfma_f32_16x16x32_bf16 v[228:231], v[124:127], v[96:99], v[228:231]
ds_read_b128 v[60:63], v25 offset:10240
v_mfma_f32_16x16x32_bf16 v[156:159], v[128:131], v[96:99], v[156:159]
ds_read_b128 v[64:67], v25 offset:12288
v_mfma_f32_16x16x32_bf16 v[192:195], v[96:99], v[132:135], v[192:195]
v_mfma_f32_16x16x32_bf16 v[232:235], v[124:127], v[100:103], v[232:235]
ds_read_b64_tr_b16 v[120:121], v26 offset:20480
v_mfma_f32_16x16x32_bf16 v[160:163], v[128:131], v[100:103], v[160:163]
ds_read_b128 v[68:71], v25 offset:14336
v_mfma_f32_16x16x32_bf16 v[196:199], v[100:103], v[132:135], v[196:199]
v_mfma_f32_16x16x32_bf16 v[236:239], v[124:127], v[104:107], v[236:239]
ds_read_b64_tr_b16 v[122:123], v26 offset:20992
v_mfma_f32_16x16x32_bf16 v[164:167], v[128:131], v[104:107], v[164:167]
ds_read_b128 v[72:75], v25 offset:16384
v_mfma_f32_16x16x32_bf16 v[200:203], v[104:107], v[132:135], v[200:203]
v_mfma_f32_16x16x32_bf16 v[168:171], v[128:131], v[108:111], v[168:171]
v_mfma_f32_16x16x32_bf16 v[204:207], v[108:111], v[132:135], v[204:207]
s_waitcnt vmcnt(6) lgkmcnt(0)
s_barrier
v_mfma_f32_16x16x32_bf16 v[208:211], v[112:115], v[40:43], v[208:211]
v_mfma_f32_16x16x32_bf16 v[136:139], v[116:119], v[40:43], v[136:139]
ds_read_b128 v[76:79], v24 offset:0
v_mfma_f32_16x16x32_bf16 v[172:175], v[40:43], v[120:123], v[172:175]
ds_read_b64_tr_b16 v[124:125], v26 offset:24576
v_mfma_f32_16x16x32_bf16 v[212:215], v[112:115], v[44:47], v[212:215]
ds_read_b128 v[80:83], v24 offset:2048
v_mfma_f32_16x16x32_bf16 v[140:143], v[116:119], v[44:47], v[140:143]
s_add_u32 m0, s43, 12288
s_sub_u32 s46, 786432, s20
buffer_load_dwordx4 v27, s[8:11], s46 offen lds
v_mfma_f32_16x16x32_bf16 v[176:179], v[44:47], v[120:123], v[176:179]
ds_read_b64_tr_b16 v[126:127], v26 offset:25088
v_mfma_f32_16x16x32_bf16 v[216:219], v[112:115], v[48:51], v[216:219]
ds_read_b128 v[84:87], v24 offset:4096
v_mfma_f32_16x16x32_bf16 v[144:147], v[116:119], v[48:51], v[144:147]
s_add_u32 m0, s43, 16384
s_sub_u32 s46, 787456, s20
buffer_load_dwordx4 v27, s[8:11], s46 offen lds
v_mfma_f32_16x16x32_bf16 v[180:183], v[48:51], v[120:123], v[180:183]
ds_read_b128 v[88:91], v24 offset:6144
v_mfma_f32_16x16x32_bf16 v[220:223], v[112:115], v[52:55], v[220:223]
ds_read_b64_tr_b16 v[128:129], v26 offset:28672
v_mfma_f32_16x16x32_bf16 v[148:151], v[116:119], v[52:55], v[148:151]
ds_read_b128 v[92:95], v24 offset:8192
v_mfma_f32_16x16x32_bf16 v[184:187], v[52:55], v[120:123], v[184:187]
v_mfma_f32_16x16x32_bf16 v[224:227], v[112:115], v[56:59], v[224:227]
s_add_u32 m0, s43, 20480
s_sub_u32 s46, 788480, s20
buffer_load_dwordx4 v27, s[8:11], s46 offen lds
v_mfma_f32_16x16x32_bf16 v[152:155], v[116:119], v[56:59], v[152:155]
ds_read_b64_tr_b16 v[130:131], v26 offset:29184
v_mfma_f32_16x16x32_bf16 v[188:191], v[56:59], v[120:123], v[188:191]
ds_read_b128 v[96:99], v24 offset:10240
v_mfma_f32_16x16x32_bf16 v[228:231], v[112:115], v[60:63], v[228:231]
s_cmp_lt_u32 s42, 2
s_cbranch_scc0 L_H_hxr3
s_add_u32 m0, s53, 55296
s_add_u32 s46, s22, 384
buffer_load_dwordx4 v30, s[4:7], s46 offen lds
L_H_hxr3:
v_mfma_f32_16x16x32_bf16 v[156:159], v[116:119], v[60:63], v[156:159]
ds_read_b128 v[100:103], v24 offset:12288
v_mfma_f32_16x16x32_bf16 v[192:195], v[60:63], v[120:123], v[192:195]
ds_read_b64_tr_b16 v[132:133], v26 offset:32768
v_mfma_f32_16x16x32_bf16 v[232:235], v[112:115], v[64:67], v[232:235]
ds_read_b128 v[104:107], v24 offset:14336
v_mfma_f32_16x16x32_bf16 v[160:163], v[116:119], v[64:67], v[160:163]
s_add_u32 m0, s44, 55296
s_add_u32 s46, s22, 384
buffer_load_dwordx4 v28, s[4:7], s46 offen lds
v_mfma_f32_16x16x32_bf16 v[196:199], v[64:67], v[120:123], v[196:199]
ds_read_b64_tr_b16 v[134:135], v26 offset:33280
v_mfma_f32_16x16x32_bf16 v[236:239], v[112:115], v[68:71], v[236:239]
ds_read_b128 v[108:111], v24 offset:16384
v_mfma_f32_16x16x32_bf16 v[164:167], v[116:119], v[68:71], v[164:167]
s_add_u32 m0, s44, 56320
s_add_u32 s46, s22, 384
buffer_load_dwordx4 v29, s[4:7], s46 offen lds
v_mfma_f32_16x16x32_bf16 v[200:203], v[68:71], v[120:123], v[200:203]
v_mfma_f32_16x16x32_bf16 v[168:171], v[116:119], v[72:75], v[168:171]
v_mfma_f32_16x16x32_bf16 v[204:207], v[72:75], v[120:123], v[204:207]
s_waitcnt lgkmcnt(0)
v_mfma_f32_16x16x32_bf16 v[208:211], v[124:127], v[76:79], v[208:211]
v_mfma_f32_16x16x32_bf16 v[136:139], v[128:131], v[76:79], v[136:139]
ds_read_b128 v[40:43], v23 offset:18432
v_mfma_f32_16x16x32_bf16 v[172:175], v[76:79], v[132:135], v[172:175]
ds_read_b64_tr_b16 v[112:113], v26 offset:36864
v_mfma_f32_16x16x32_bf16 v[212:215], v[124:127], v[80:83], v[212:215]
v_mfma_f32_16x16x32_bf16 v[140:143], v[128:131], v[80:83], v[140:143]
ds_read_b128 v[44:47], v23 offset:20480
v_mfma_f32_16x16x32_bf16 v[176:179], v[80:83], v[132:135], v[176:179]
ds_read_b64_tr_b16 v[114:115], v26 offset:37376
v_mfma_f32_16x16x32_bf16 v[216:219], v[124:127], v[84:87], v[216:219]
ds_read_b128 v[48:51], v23 offset:22528
v_mfma_f32_16x16x32_bf16 v[144:147], v[128:131], v[84:87], v[144:147]
v_mfma_f32_16x16x32_bf16 v[180:183], v[84:87], v[132:135], v[180:183]
ds_read_b128 v[52:55], v23 offset:24576
v_mfma_f32_16x16x32_bf16 v[220:223], v[124:127], v[88:91], v[220:223]
ds_read_b64_tr_b16 v[116:117], v26 offset:40960
v_mfma_f32_16x16x32_bf16 v[148:151], v[128:131], v[88:91], v[148:151]
ds_read_b128 v[56:59], v23 offset:26624
v_mfma_f32_16x16x32_bf16 v[184:187], v[88:91], v[132:135], v[184:187]
v_mfma_f32_16x16x32_bf16 v[224:227], v[124:127], v[92:95], v[224:227]
s_add_u32 m0, s44, 57344
s_add_u32 s46, s22, 16768
buffer_load_dwordx4 v28, s[4:7], s46 offen lds
v_mfma_f32_16x16x32_bf16 v[152:155], v[128:131], v[92:95], v[152:155]
ds_read_b64_tr_b16 v[118:119], v26 offset:41472
v_mfma_f32_16x16x32_bf16 v[188:191], v[92:95], v[132:135], v[188:191]
ds_read_b128 v[60:63], v23 offset:28672
v_mfma_f32_16x16x32_bf16 v[228:231], v[124:127], v[96:99], v[228:231]
v_mfma_f32_16x16x32_bf16 v[156:159], v[128:131], v[96:99], v[156:159]
ds_read_b128 v[64:67], v23 offset:30720
v_mfma_f32_16x16x32_bf16 v[192:195], v[96:99], v[132:135], v[192:195]
ds_read_b64_tr_b16 v[120:121], v26 offset:45056
v_mfma_f32_16x16x32_bf16 v[232:235], v[124:127], v[100:103], v[232:235]
ds_read_b128 v[68:71], v23 offset:32768
v_mfma_f32_16x16x32_bf16 v[160:163], v[128:131], v[100:103], v[160:163]
v_mfma_f32_16x16x32_bf16 v[196:199], v[100:103], v[132:135], v[196:199]
ds_read_b64_tr_b16 v[122:123], v26 offset:45568
v_mfma_f32_16x16x32_bf16 v[236:239], v[124:127], v[104:107], v[236:239]
ds_read_b128 v[72:75], v23 offset:34816
v_mfma_f32_16x16x32_bf16 v[164:167], v[128:131], v[104:107], v[164:167]
s_add_u32 m0, s44, 58368
s_add_u32 s46, s22, 16768
buffer_load_dwordx4 v29, s[4:7], s46 offen lds
v_mfma_f32_16x16x32_bf16 v[200:203], v[104:107], v[132:135], v[200:203]
v_mfma_f32_16x16x32_bf16 v[168:171], v[128:131], v[108:111], v[168:171]
v_mfma_f32_16x16x32_bf16 v[204:207], v[108:111], v[132:135], v[204:207]
s_waitcnt vmcnt(7) lgkmcnt(0)
s_barrier
v_mfma_f32_16x16x32_bf16 v[208:211], v[112:115], v[40:43], v[208:211]
v_mfma_f32_16x16x32_bf16 v[136:139], v[116:119], v[40:43], v[136:139]
ds_read_b128 v[76:79], v22 offset:18432
v_mfma_f32_16x16x32_bf16 v[172:175], v[40:43], v[120:123], v[172:175]
ds_read_b64_tr_b16 v[124:125], v26 offset:0
v_mfma_f32_16x16x32_bf16 v[212:215], v[112:115], v[44:47], v[212:215]
ds_read_b128 v[80:83], v22 offset:20480
v_mfma_f32_16x16x32_bf16 v[140:143], v[116:119], v[44:47], v[140:143]
s_add_u32 m0, s43, 24576
s_add_u32 s46, s20, 688128
buffer_load_dwordx4 v27, s[8:11], s46 offen lds
v_mfma_f32_16x16x32_bf16 v[176:179], v[44:47], v[120:123], v[176:179]
ds_read_b64_tr_b16 v[126:127], v26 offset:512
v_mfma_f32_16x16x32_bf16 v[216:219], v[112:115], v[48:51], v[216:219]
ds_read_b128 v[84:87], v22 offset:22528
v_mfma_f32_16x16x32_bf16 v[144:147], v[116:119], v[48:51], v[144:147]
s_add_u32 m0, s43, 28672
s_add_u32 s46, s20, 689152
buffer_load_dwordx4 v27, s[8:11], s46 offen lds
v_mfma_f32_16x16x32_bf16 v[180:183], v[48:51], v[120:123], v[180:183]
ds_read_b128 v[88:91], v22 offset:24576
v_mfma_f32_16x16x32_bf16 v[220:223], v[112:115], v[52:55], v[220:223]
ds_read_b64_tr_b16 v[128:129], v26 offset:4096
v_mfma_f32_16x16x32_bf16 v[148:151], v[116:119], v[52:55], v[148:151]
ds_read_b128 v[92:95], v22 offset:26624
v_mfma_f32_16x16x32_bf16 v[184:187], v[52:55], v[120:123], v[184:187]
v_mfma_f32_16x16x32_bf16 v[224:227], v[112:115], v[56:59], v[224:227]
s_add_u32 m0, s43, 32768
s_add_u32 s46, s20, 690176
buffer_load_dwordx4 v27, s[8:11], s46 offen lds
v_mfma_f32_16x16x32_bf16 v[152:155], v[116:119], v[56:59], v[152:155]
ds_read_b64_tr_b16 v[130:131], v26 offset:4608
v_mfma_f32_16x16x32_bf16 v[188:191], v[56:59], v[120:123], v[188:191]
ds_read_b128 v[96:99], v22 offset:28672
v_mfma_f32_16x16x32_bf16 v[228:231], v[112:115], v[60:63], v[228:231]
s_cmp_lt_u32 s42, 2
s_cbranch_scc0 L_H_hxr2
s_add_u32 m0, s53, 36864
s_add_u32 s46, s22, 256
buffer_load_dwordx4 v30, s[4:7], s46 offen lds
L_H_hxr2:
v_mfma_f32_16x16x32_bf16 v[156:159], v[116:119], v[60:63], v[156:159]
ds_read_b128 v[100:103], v22 offset:30720
v_mfma_f32_16x16x32_bf16 v[192:195], v[60:63], v[120:123], v[192:195]
ds_read_b64_tr_b16 v[132:133], v26 offset:8192
v_mfma_f32_16x16x32_bf16 v[232:235], v[112:115], v[64:67], v[232:235]
ds_read_b128 v[104:107], v22 offset:32768
v_mfma_f32_16x16x32_bf16 v[160:163], v[116:119], v[64:67], v[160:163]
s_add_u32 m0, s44, 36864
s_add_u32 s46, s22, 256
buffer_load_dwordx4 v28, s[4:7], s46 offen lds
v_mfma_f32_16x16x32_bf16 v[196:199], v[64:67], v[120:123], v[196:199]
ds_read_b64_tr_b16 v[134:135], v26 offset:8704
v_mfma_f32_16x16x32_bf16 v[236:239], v[112:115], v[68:71], v[236:239]
ds_read_b128 v[108:111], v22 offset:34816
v_mfma_f32_16x16x32_bf16 v[164:167], v[116:119], v[68:71], v[164:167]
s_add_u32 m0, s44, 37888
s_add_u32 s46, s22, 256
buffer_load_dwordx4 v29, s[4:7], s46 offen lds
v_mfma_f32_16x16x32_bf16 v[200:203], v[68:71], v[120:123], v[200:203]
v_mfma_f32_16x16x32_bf16 v[168:171], v[116:119], v[72:75], v[168:171]
v_mfma_f32_16x16x32_bf16 v[204:207], v[72:75], v[120:123], v[204:207]
s_waitcnt lgkmcnt(0)
v_mfma_f32_16x16x32_bf16 v[208:211], v[124:127], v[76:79], v[208:211]
v_mfma_f32_16x16x32_bf16 v[136:139], v[128:131], v[76:79], v[136:139]
ds_read_b128 v[40:43], v23 offset:0
v_mfma_f32_16x16x32_bf16 v[172:175], v[76:79], v[132:135], v[172:175]
ds_read_b64_tr_b16 v[112:113], v26 offset:49152
v_mfma_f32_16x16x32_bf16 v[212:215], v[124:127], v[80:83], v[212:215]
ds_read_b128 v[44:47], v23 offset:2048
v_mfma_f32_16x16x32_bf16 v[140:143], v[128:131], v[80:83], v[140:143]
s_add_u32 m0, s43, 36864
s_add_u32 s46, s20, 589824
buffer_load_dwordx4 v27, s[8:11], s46 offen lds
v_mfma_f32_16x16x32_bf16 v[176:179], v[80:83], v[132:135], v[176:179]
ds_read_b64_tr_b16 v[114:115], v26 offset:49664
v_mfma_f32_16x16x32_bf16 v[216:219], v[124:127], v[84:87], v[216:219]
ds_read_b128 v[48:51], v23 offset:4096
v_mfma_f32_16x16x32_bf16 v[144:147], v[128:131], v[84:87], v[144:147]
v_mfma_f32_16x16x32_bf16 v[180:183], v[84:87], v[132:135], v[180:183]
ds_read_b128 v[52:55], v23 offset:6144
v_mfma_f32_16x16x32_bf16 v[220:223], v[124:127], v[88:91], v[220:223]
s_add_u32 m0, s43, 40960
s_add_u32 s46, s20, 590848
buffer_load_dwordx4 v27, s[8:11], s46 offen lds
v_mfma_f32_16x16x32_bf16 v[148:151], v[128:131], v[88:91], v[148:151]
ds_read_b64_tr_b16 v[116:117], v26 offset:53248
v_mfma_f32_16x16x32_bf16 v[184:187], v[88:91], v[132:135], v[184:187]
ds_read_b128 v[56:59], v23 offset:8192
v_mfma_f32_16x16x32_bf16 v[224:227], v[124:127], v[92:95], v[224:227]
ds_read_b64_tr_b16 v[118:119], v26 offset:53760
v_mfma_f32_16x16x32_bf16 v[152:155], v[128:131], v[92:95], v[152:155]
s_add_u32 m0, s43, 45056
s_add_u32 s46, s20, 591872
buffer_load_dwordx4 v27, s[8:11], s46 offen lds
v_mfma_f32_16x16x32_bf16 v[188:191], v[92:95], v[132:135], v[188:191]
ds_read_b128 v[60:63], v23 offset:10240
v_mfma_f32_16x16x32_bf16 v[228:231], v[124:127], v[96:99], v[228:231]
v_mfma_f32_16x16x32_bf16 v[156:159], v[128:131], v[96:99], v[156:159]
ds_read_b128 v[64:67], v23 offset:12288
v_mfma_f32_16x16x32_bf16 v[192:195], v[96:99], v[132:135], v[192:195]
ds_read_b64_tr_b16 v[120:121], v26 offset:57344
v_mfma_f32_16x16x32_bf16 v[232:235], v[124:127], v[100:103], v[232:235]
s_add_u32 m0, s44, 38912
s_add_u32 s46, s22, 16640
buffer_load_dwordx4 v28, s[4:7], s46 offen lds
v_mfma_f32_16x16x32_bf16 v[160:163], v[128:131], v[100:103], v[160:163]
ds_read_b128 v[68:71], v23 offset:14336
v_mfma_f32_16x16x32_bf16 v[196:199], v[100:103], v[132:135], v[196:199]
ds_read_b64_tr_b16 v[122:123], v26 offset:57856
v_mfma_f32_16x16x32_bf16 v[236:239], v[124:127], v[104:107], v[236:239]
ds_read_b128 v[72:75], v23 offset:16384
v_mfma_f32_16x16x32_bf16 v[164:167], v[128:131], v[104:107], v[164:167]
s_add_u32 m0, s44, 39936
s_add_u32 s46, s22, 16640
buffer_load_dwordx4 v29, s[4:7], s46 offen lds
v_mfma_f32_16x16x32_bf16 v[200:203], v[104:107], v[132:135], v[200:203]
v_mfma_f32_16x16x32_bf16 v[168:171], v[128:131], v[108:111], v[168:171]
v_mfma_f32_16x16x32_bf16 v[204:207], v[108:111], v[132:135], v[204:207]
s_waitcnt vmcnt(7) lgkmcnt(0)
s_barrier
v_mfma_f32_16x16x32_bf16 v[208:211], v[112:115], v[40:43], v[208:211]
v_mfma_f32_16x16x32_bf16 v[136:139], v[116:119], v[40:43], v[136:139]
ds_read_b128 v[76:79], v22 offset:0
v_mfma_f32_16x16x32_bf16 v[172:175], v[40:43], v[120:123], v[172:175]
ds_read_b64_tr_b16 v[124:125], v26 offset:12288
v_mfma_f32_16x16x32_bf16 v[212:215], v[112:115], v[44:47], v[212:215]
ds_read_b128 v[80:83], v22 offset:2048
v_mfma_f32_16x16x32_bf16 v[140:143], v[116:119], v[44:47], v[140:143]
s_add_u32 m0, s43, 0
s_add_u32 s46, s20, 491520
buffer_load_dwordx4 v27, s[8:11], s46 offen lds
v_mfma_f32_16x16x32_bf16 v[176:179], v[44:47], v[120:123], v[176:179]
ds_read_b64_tr_b16 v[126:127], v26 offset:12800
v_mfma_f32_16x16x32_bf16 v[216:219], v[112:115], v[48:51], v[216:219]
ds_read_b128 v[84:87], v22 offset:4096
v_mfma_f32_16x16x32_bf16 v[144:147], v[116:119], v[48:51], v[144:147]
s_add_u32 m0, s43, 4096
s_add_u32 s46, s20, 492544
buffer_load_dwordx4 v27, s[8:11], s46 offen lds
v_mfma_f32_16x16x32_bf16 v[180:183], v[48:51], v[120:123], v[180:183]
ds_read_b128 v[88:91], v22 offset:6144
v_mfma_f32_16x16x32_bf16 v[220:223], v[112:115], v[52:55], v[220:223]
ds_read_b64_tr_b16 v[128:129], v26 offset:16384
v_mfma_f32_16x16x32_bf16 v[148:151], v[116:119], v[52:55], v[148:151]
ds_read_b128 v[92:95], v22 offset:8192
v_mfma_f32_16x16x32_bf16 v[184:187], v[52:55], v[120:123], v[184:187]
v_mfma_f32_16x16x32_bf16 v[224:227], v[112:115], v[56:59], v[224:227]
s_add_u32 m0, s43, 8192
s_add_u32 s46, s20, 493568
buffer_load_dwordx4 v27, s[8:11], s46 offen lds
v_mfma_f32_16x16x32_bf16 v[152:155], v[116:119], v[56:59], v[152:155]
ds_read_b64_tr_b16 v[130:131], v26 offset:16896
v_mfma_f32_16x16x32_bf16 v[188:191], v[56:59], v[120:123], v[188:191]
ds_read_b128 v[96:99], v22 offset:10240
v_mfma_f32_16x16x32_bf16 v[228:231], v[112:115], v[60:63], v[228:231]
s_cmp_lt_u32 s42, 2
s_cbranch_scc0 L_H_hxr1
s_add_u32 m0, s53, 18432
s_add_u32 s46, s22, 128
buffer_load_dwordx4 v30, s[4:7], s46 offen lds
L_H_hxr1:
v_mfma_f32_16x16x32_bf16 v[156:159], v[116:119], v[60:63], v[156:159]
ds_read_b128 v[100:103], v22 offset:12288
v_mfma_f32_16x16x32_bf16 v[192:195], v[60:63], v[120:123], v[192:195]
ds_read_b64_tr_b16 v[132:133], v26 offset:20480
v_mfma_f32_16x16x32_bf16 v[232:235], v[112:115], v[64:67], v[232:235]
ds_read_b128 v[104:107], v22 offset:14336
v_mfma_f32_16x16x32_bf16 v[160:163], v[116:119], v[64:67], v[160:163]
s_add_u32 m0, s44, 18432
s_add_u32 s46, s22, 128
buffer_load_dwordx4 v28, s[4:7], s46 offen lds
v_mfma_f32_16x16x32_bf16 v[196:199], v[64:67], v[120:123], v[196:199]
ds_read_b64_tr_b16 v[134:135], v26 offset:20992
v_mfma_f32_16x16x32_bf16 v[236:239], v[112:115], v[68:71], v[236:239]
ds_read_b128 v[108:111], v22 offset:16384
v_mfma_f32_16x16x32_bf16 v[164:167], v[116:119], v[68:71], v[164:167]
s_add_u32 m0, s44, 19456
s_add_u32 s46, s22, 128
buffer_load_dwordx4 v29, s[4:7], s46 offen lds
v_mfma_f32_16x16x32_bf16 v[200:203], v[68:71], v[120:123], v[200:203]
v_mfma_f32_16x16x32_bf16 v[168:171], v[116:119], v[72:75], v[168:171]
v_mfma_f32_16x16x32_bf16 v[204:207], v[72:75], v[120:123], v[204:207]
s_waitcnt lgkmcnt(0)
v_mfma_f32_16x16x32_bf16 v[208:211], v[124:127], v[76:79], v[208:211]
v_mfma_f32_16x16x32_bf16 v[136:139], v[128:131], v[76:79], v[136:139]
ds_read_b128 v[40:43], v25 offset:18432
v_mfma_f32_16x16x32_bf16 v[172:175], v[76:79], v[132:135], v[172:175]
ds_read_b64_tr_b16 v[112:113], v26 offset:24576
v_mfma_f32_16x16x32_bf16 v[212:215], v[124:127], v[80:83], v[212:215]
ds_read_b128 v[44:47], v25 offset:20480
v_mfma_f32_16x16x32_bf16 v[140:143], v[128:131], v[80:83], v[140:143]
s_add_u32 m0, s43, 49152
s_add_u32 s46, s20, 393216
buffer_load_dwordx4 v27, s[8:11], s46 offen lds
v_mfma_f32_16x16x32_bf16 v[176:179], v[80:83], v[132:135], v[176:179]
ds_read_b64_tr_b16 v[114:115], v26 offset:25088
v_mfma_f32_16x16x32_bf16 v[216:219], v[124:127], v[84:87], v[216:219]
ds_read_b128 v[48:51], v25 offset:22528
v_mfma_f32_16x16x32_bf16 v[144:147], v[128:131], v[84:87], v[144:147]
v_mfma_f32_16x16x32_bf16 v[180:183], v[84:87], v[132:135], v[180:183]
ds_read_b128 v[52:55], v25 offset:24576
v_mfma_f32_16x16x32_bf16 v[220:223], v[124:127], v[88:91], v[220:223]
s_add_u32 m0, s43, 53248
s_add_u32 s46, s20, 394240
buffer_load_dwordx4 v27, s[8:11], s46 offen lds
v_mfma_f32_16x16x32_bf16 v[148:151], v[128:131], v[88:91], v[148:151]
ds_read_b64_tr_b16 v[116:117], v26 offset:28672
v_mfma_f32_16x16x32_bf16 v[184:187], v[88:91], v[132:135], v[184:187]
ds_read_b128 v[56:59], v25 offset:26624
v_mfma_f32_16x16x32_bf16 v[224:227], v[124:127], v[92:95], v[224:227]
ds_read_b64_tr_b16 v[118:119], v26 offset:29184
v_mfma_f32_16x16x32_bf16 v[152:155], v[128:131], v[92:95], v[152:155]
s_add_u32 m0, s43, 57344
s_add_u32 s46, s20, 395264
buffer_load_dwordx4 v27, s[8:11], s46 offen lds
v_mfma_f32_16x16x32_bf16 v[188:191], v[92:95], v[132:135], v[188:191]
ds_read_b128 v[60:63], v25 offset:28672
v_mfma_f32_16x16x32_bf16 v[228:231], v[124:127], v[96:99], v[228:231]
v_mfma_f32_16x16x32_bf16 v[156:159], v[128:131], v[96:99], v[156:159]
ds_read_b128 v[64:67], v25 offset:30720
v_mfma_f32_16x16x32_bf16 v[192:195], v[96:99], v[132:135], v[192:195]
ds_read_b64_tr_b16 v[120:121], v26 offset:32768
v_mfma_f32_16x16x32_bf16 v[232:235], v[124:127], v[100:103], v[232:235]
s_add_u32 m0, s44, 20480
s_add_u32 s46, s22, 16512
buffer_load_dwordx4 v28, s[4:7], s46 offen lds
v_mfma_f32_16x16x32_bf16 v[160:163], v[128:131], v[100:103], v[160:163]
ds_read_b128 v[68:71], v25 offset:32768
v_mfma_f32_16x16x32_bf16 v[196:199], v[100:103], v[132:135], v[196:199]
ds_read_b64_tr_b16 v[122:123], v26 offset:33280
v_mfma_f32_16x16x32_bf16 v[236:239], v[124:127], v[104:107], v[236:239]
ds_read_b128 v[72:75], v25 offset:34816
v_mfma_f32_16x16x32_bf16 v[164:167], v[128:131], v[104:107], v[164:167]
s_add_u32 m0, s44, 21504
s_add_u32 s46, s22, 16512
buffer_load_dwordx4 v29, s[4:7], s46 offen lds
v_mfma_f32_16x16x32_bf16 v[200:203], v[104:107], v[132:135], v[200:203]
v_mfma_f32_16x16x32_bf16 v[168:171], v[128:131], v[108:111], v[168:171]
v_mfma_f32_16x16x32_bf16 v[204:207], v[108:111], v[132:135], v[204:207]
s_waitcnt vmcnt(7) lgkmcnt(0)
s_barrier
v_mfma_f32_16x16x32_bf16 v[208:211], v[112:115], v[40:43], v[208:211]
v_mfma_f32_16x16x32_bf16 v[136:139], v[116:119], v[40:43], v[136:139]
ds_read_b128 v[76:79], v24 offset:18432
v_mfma_f32_16x16x32_bf16 v[172:175], v[40:43], v[120:123], v[172:175]
ds_read_b64_tr_b16 v[124:125], v26 offset:36864
v_mfma_f32_16x16x32_bf16 v[212:215], v[112:115], v[44:47], v[212:215]
ds_read_b128 v[80:83], v24 offset:20480
v_mfma_f32_16x16x32_bf16 v[140:143], v[116:119], v[44:47], v[140:143]
s_add_u32 m0, s43, 12288
s_add_u32 s46, s20, 294912
buffer_load_dwordx4 v27, s[8:11], s46 offen lds
v_mfma_f32_16x16x32_bf16 v[176:179], v[44:47], v[120:123], v[176:179]
ds_read_b64_tr_b16 v[126:127], v26 offset:37376
v_mfma_f32_16x16x32_bf16 v[216:219], v[112:115], v[48:51], v[216:219]
ds_read_b128 v[84:87], v24 offset:22528
v_mfma_f32_16x16x32_bf16 v[144:147], v[116:119], v[48:51], v[144:147]
s_add_u32 m0, s43, 16384
s_add_u32 s46, s20, 295936
buffer_load_dwordx4 v27, s[8:11], s46 offen lds
v_mfma_f32_16x16x32_bf16 v[180:183], v[48:51], v[120:123], v[180:183]
ds_read_b128 v[88:91], v24 offset:24576
v_mfma_f32_16x16x32_bf16 v[220:223], v[112:115], v[52:55], v[220:223]
ds_read_b64_tr_b16 v[128:129], v26 offset:40960
v_mfma_f32_16x16x32_bf16 v[148:151], v[116:119], v[52:55], v[148:151]
ds_read_b128 v[92:95], v24 offset:26624
v_mfma_f32_16x16x32_bf16 v[184:187], v[52:55], v[120:123], v[184:187]
v_mfma_f32_16x16x32_bf16 v[224:227], v[112:115], v[56:59], v[224:227]
s_add_u32 m0, s43, 20480
s_add_u32 s46, s20, 296960
buffer_load_dwordx4 v27, s[8:11], s46 offen lds
v_mfma_f32_16x16x32_bf16 v[152:155], v[116:119], v[56:59], v[152:155]
ds_read_b64_tr_b16 v[130:131], v26 offset:41472
v_mfma_f32_16x16x32_bf16 v[188:191], v[56:59], v[120:123], v[188:191]
ds_read_b128 v[96:99], v24 offset:28672
v_mfma_f32_16x16x32_bf16 v[228:231], v[112:115], v[60:63], v[228:231]
s_cmp_lt_u32 s42, 2
s_cbranch_scc0 L_H_hxr0
s_add_u32 m0, s53, 0
s_add_u32 s46, s22, 0
buffer_load_dwordx4 v30, s[4:7], s46 offen lds
L_H_hxr0:
v_mfma_f32_16x16x32_bf16 v[156:159], v[116:119], v[60:63], v[156:159]
ds_read_b128 v[100:103], v24 offset:30720
v_mfma_f32_16x16x32_bf16 v[192:195], v[60:63], v[120:123], v[192:195]
ds_read_b64_tr_b16 v[132:133], v26 offset:45056
v_mfma_f32_16x16x32_bf16 v[232:235], v[112:115], v[64:67], v[232:235]
ds_read_b128 v[104:107], v24 offset:32768
v_mfma_f32_16x16x32_bf16 v[160:163], v[116:119], v[64:67], v[160:163]
s_add_u32 m0, s44, 0
s_add_u32 s46, s22, 0
buffer_load_dwordx4 v28, s[4:7], s46 offen lds
v_mfma_f32_16x16x32_bf16 v[196:199], v[64:67], v[120:123], v[196:199]
ds_read_b64_tr_b16 v[134:135], v26 offset:45568
v_mfma_f32_16x16x32_bf16 v[236:239], v[112:115], v[68:71], v[236:239]
ds_read_b128 v[108:111], v24 offset:34816
v_mfma_f32_16x16x32_bf16 v[164:167], v[116:119], v[68:71], v[164:167]
s_add_u32 m0, s44, 1024
s_add_u32 s46, s22, 0
buffer_load_dwordx4 v29, s[4:7], s46 offen lds
v_mfma_f32_16x16x32_bf16 v[200:203], v[68:71], v[120:123], v[200:203]
v_mfma_f32_16x16x32_bf16 v[168:171], v[116:119], v[72:75], v[168:171]
v_mfma_f32_16x16x32_bf16 v[204:207], v[72:75], v[120:123], v[204:207]
s_waitcnt lgkmcnt(0)
v_mfma_f32_16x16x32_bf16 v[208:211], v[124:127], v[76:79], v[208:211]
v_mfma_f32_16x16x32_bf16 v[136:139], v[128:131], v[76:79], v[136:139]
ds_read_b128 v[40:43], v25 offset:0
v_mfma_f32_16x16x32_bf16 v[172:175], v[76:79], v[132:135], v[172:175]
ds_read_b64_tr_b16 v[112:113], v26 offset:0
v_mfma_f32_16x16x32_bf16 v[212:215], v[124:127], v[80:83], v[212:215]
ds_read_b128 v[44:47], v25 offset:2048
v_mfma_f32_16x16x32_bf16 v[140:143], v[128:131], v[80:83], v[140:143]
s_add_u32 m0, s43, 24576
s_add_u32 s46, s20, 196608
buffer_load_dwordx4 v27, s[8:11], s46 offen lds
v_mfma_f32_16x16x32_bf16 v[176:179], v[80:83], v[132:135], v[176:179]
ds_read_b64_tr_b16 v[114:115], v26 offset:512
v_mfma_f32_16x16x32_bf16 v[216:219], v[124:127], v[84:87], v[216:219]
ds_read_b128 v[48:51], v25 offset:4096
v_mfma_f32_16x16x32_bf16 v[144:147], v[128:131], v[84:87], v[144:147]
v_mfma_f32_16x16x32_bf16 v[180:183], v[84:87], v[132:135], v[180:183]
ds_read_b128 v[52:55], v25 offset:6144
v_mfma_f32_16x16x32_bf16 v[220:223], v[124:127], v[88:91], v[220:223]
s_add_u32 m0, s43, 28672
s_add_u32 s46, s20, 197632
buffer_load_dwordx4 v27, s[8:11], s46 offen lds
v_mfma_f32_16x16x32_bf16 v[148:151], v[128:131], v[88:91], v[148:151]
ds_read_b64_tr_b16 v[116:117], v26 offset:4096
v_mfma_f32_16x16x32_bf16 v[184:187], v[88:91], v[132:135], v[184:187]
ds_read_b128 v[56:59], v25 offset:8192
v_mfma_f32_16x16x32_bf16 v[224:227], v[124:127], v[92:95], v[224:227]
ds_read_b64_tr_b16 v[118:119], v26 offset:4608
v_mfma_f32_16x16x32_bf16 v[152:155], v[128:131], v[92:95], v[152:155]
s_add_u32 m0, s43, 32768
s_add_u32 s46, s20, 198656
buffer_load_dwordx4 v27, s[8:11], s46 offen lds
v_mfma_f32_16x16x32_bf16 v[188:191], v[92:95], v[132:135], v[188:191]
ds_read_b128 v[60:63], v25 offset:10240
v_mfma_f32_16x16x32_bf16 v[228:231], v[124:127], v[96:99], v[228:231]
v_mfma_f32_16x16x32_bf16 v[156:159], v[128:131], v[96:99], v[156:159]
ds_read_b128 v[64:67], v25 offset:12288
v_mfma_f32_16x16x32_bf16 v[192:195], v[96:99], v[132:135], v[192:195]
ds_read_b64_tr_b16 v[120:121], v26 offset:8192
v_mfma_f32_16x16x32_bf16 v[232:235], v[124:127], v[100:103], v[232:235]
s_add_u32 m0, s44, 2048
s_add_u32 s46, s22, 16384
buffer_load_dwordx4 v28, s[4:7], s46 offen lds
v_mfma_f32_16x16x32_bf16 v[160:163], v[128:131], v[100:103], v[160:163]
ds_read_b128 v[68:71], v25 offset:14336
v_mfma_f32_16x16x32_bf16 v[196:199], v[100:103], v[132:135], v[196:199]
ds_read_b64_tr_b16 v[122:123], v26 offset:8704
v_mfma_f32_16x16x32_bf16 v[236:239], v[124:127], v[104:107], v[236:239]
ds_read_b128 v[72:75], v25 offset:16384
v_mfma_f32_16x16x32_bf16 v[164:167], v[128:131], v[104:107], v[164:167]
s_add_u32 m0, s44, 3072
s_add_u32 s46, s22, 16384
buffer_load_dwordx4 v29, s[4:7], s46 offen lds
v_mfma_f32_16x16x32_bf16 v[200:203], v[104:107], v[132:135], v[200:203]
v_mfma_f32_16x16x32_bf16 v[168:171], v[128:131], v[108:111], v[168:171]
v_mfma_f32_16x16x32_bf16 v[204:207], v[108:111], v[132:135], v[204:207]
s_waitcnt vmcnt(7) lgkmcnt(0)
s_barrier
v_mfma_f32_16x16x32_bf16 v[208:211], v[112:115], v[40:43], v[208:211]
v_mfma_f32_16x16x32_bf16 v[136:139], v[116:119], v[40:43], v[136:139]
ds_read_b128 v[76:79], v24 offset:0
v_mfma_f32_16x16x32_bf16 v[172:175], v[40:43], v[120:123], v[172:175]
ds_read_b64_tr_b16 v[124:125], v26 offset:49152
v_mfma_f32_16x16x32_bf16 v[212:215], v[112:115], v[44:47], v[212:215]
ds_read_b128 v[80:83], v24 offset:2048
v_mfma_f32_16x16x32_bf16 v[140:143], v[116:119], v[44:47], v[140:143]
v_mfma_f32_16x16x32_bf16 v[176:179], v[44:47], v[120:123], v[176:179]
ds_read_b64_tr_b16 v[126:127], v26 offset:49664
v_mfma_f32_16x16x32_bf16 v[216:219], v[112:115], v[48:51], v[216:219]
ds_read_b128 v[84:87], v24 offset:4096
v_mfma_f32_16x16x32_bf16 v[144:147], v[116:119], v[48:51], v[144:147]
s_add_u32 m0, s43, 36864
s_add_u32 s46, s20, 98304
buffer_load_dwordx4 v27, s[8:11], s46 offen lds
v_mfma_f32_16x16x32_bf16 v[180:183], v[48:51], v[120:123], v[180:183]
ds_read_b128 v[88:91], v24 offset:6144
v_mfma_f32_16x16x32_bf16 v[220:223], v[112:115], v[52:55], v[220:223]
v_mfma_f32_16x16x32_bf16 v[148:151], v[116:119], v[52:55], v[148:151]
ds_read_b64_tr_b16 v[128:129], v26 offset:53248
v_mfma_f32_16x16x32_bf16 v[184:187], v[52:55], v[120:123], v[184:187]
ds_read_b128 v[92:95], v24 offset:8192
v_mfma_f32_16x16x32_bf16 v[224:227], v[112:115], v[56:59], v[224:227]
ds_read_b64_tr_b16 v[130:131], v26 offset:53760
v_mfma_f32_16x16x32_bf16 v[152:155], v[116:119], v[56:59], v[152:155]
v_mfma_f32_16x16x32_bf16 v[188:191], v[56:59], v[120:123], v[188:191]
ds_read_b128 v[96:99], v24 offset:10240
v_mfma_f32_16x16x32_bf16 v[228:231], v[112:115], v[60:63], v[228:231]
s_add_u32 m0, s43, 40960
s_add_u32 s46, s20, 99328
buffer_load_dwordx4 v27, s[8:11], s46 offen lds
v_mfma_f32_16x16x32_bf16 v[156:159], v[116:119], v[60:63], v[156:159]
ds_read_b128 v[100:103], v24 offset:12288
v_mfma_f32_16x16x32_bf16 v[192:195], v[60:63], v[120:123], v[192:195]
ds_read_b64_tr_b16 v[132:133], v26 offset:57344
v_mfma_f32_16x16x32_bf16 v[232:235], v[112:115], v[64:67], v[232:235]
v_mfma_f32_16x16x32_bf16 v[160:163], v[116:119], v[64:67], v[160:163]
ds_read_b128 v[104:107], v24 offset:14336
v_mfma_f32_16x16x32_bf16 v[196:199], v[64:67], v[120:123], v[196:199]
ds_read_b64_tr_b16 v[134:135], v26 offset:57856
v_mfma_f32_16x16x32_bf16 v[236:239], v[112:115], v[68:71], v[236:239]
ds_read_b128 v[108:111], v24 offset:16384
v_mfma_f32_16x16x32_bf16 v[164:167], v[116:119], v[68:71], v[164:167]
s_add_u32 m0, s43, 45056
s_add_u32 s46, s20, 100352
buffer_load_dwordx4 v27, s[8:11], s46 offen lds
v_mfma_f32_16x16x32_bf16 v[200:203], v[68:71], v[120:123], v[200:203]
v_mfma_f32_16x16x32_bf16 v[168:171], v[116:119], v[72:75], v[168:171]
v_mfma_f32_16x16x32_bf16 v[204:207], v[72:75], v[120:123], v[204:207]
s_waitcnt lgkmcnt(0)
v_mfma_f32_16x16x32_bf16 v[208:211], v[124:127], v[76:79], v[208:211]
v_mfma_f32_16x16x32_bf16 v[136:139], v[128:131], v[76:79], v[136:139]
ds_read_b128 v[40:43], v23 offset:18432
v_mfma_f32_16x16x32_bf16 v[172:175], v[76:79], v[132:135], v[172:175]
ds_read_b64_tr_b16 v[112:113], v26 offset:12288
v_mfma_f32_16x16x32_bf16 v[212:215], v[124:127], v[80:83], v[212:215]
ds_read_b128 v[44:47], v23 offset:20480
v_mfma_f32_16x16x32_bf16 v[140:143], v[128:131], v[80:83], v[140:143]
v_mfma_f32_16x16x32_bf16 v[176:179], v[80:83], v[132:135], v[176:179]
ds_read_b64_tr_b16 v[114:115], v26 offset:12800
v_mfma_f32_16x16x32_bf16 v[216:219], v[124:127], v[84:87], v[216:219]
ds_read_b128 v[48:51], v23 offset:22528
v_mfma_f32_16x16x32_bf16 v[144:147], v[128:131], v[84:87], v[144:147]
s_add_u32 m0, s43, 0
s_add_u32 s46, s20, 0
buffer_load_dwordx4 v27, s[8:11], s46 offen lds
v_mfma_f32_16x16x32_bf16 v[180:183], v[84:87], v[132:135], v[180:183]
ds_read_b128 v[52:55], v23 offset:24576
v_mfma_f32_16x16x32_bf16 v[220:223], v[124:127], v[88:91], v[220:223]
v_mfma_f32_16x16x32_bf16 v[148:151], v[128:131], v[88:91], v[148:151]
ds_read_b64_tr_b16 v[116:117], v26 offset:16384
v_mfma_f32_16x16x32_bf16 v[184:187], v[88:91], v[132:135], v[184:187]
ds_read_b128 v[56:59], v23 offset:26624
v_mfma_f32_16x16x32_bf16 v[224:227], v[124:127], v[92:95], v[224:227]
ds_read_b64_tr_b16 v[118:119], v26 offset:16896
v_mfma_f32_16x16x32_bf16 v[152:155], v[128:131], v[92:95], v[152:155]
v_mfma_f32_16x16x32_bf16 v[188:191], v[92:95], v[132:135], v[188:191]
ds_read_b128 v[60:63], v23 offset:28672
v_mfma_f32_16x16x32_bf16 v[228:231], v[124:127], v[96:99], v[228:231]
s_add_u32 m0, s43, 4096
s_add_u32 s46, s20, 1024
buffer_load_dwordx4 v27, s[8:11], s46 offen lds
v_mfma_f32_16x16x32_bf16 v[156:159], v[128:131], v[96:99], v[156:159]
ds_read_b128 v[64:67], v23 offset:30720
v_mfma_f32_16x16x32_bf16 v[192:195], v[96:99], v[132:135], v[192:195]
ds_read_b64_tr_b16 v[120:121], v26 offset:20480
v_mfma_f32_16x16x32_bf16 v[232:235], v[124:127], v[100:103], v[232:235]
v_mfma_f32_16x16x32_bf16 v[160:163], v[128:131], v[100:103], v[160:163]
ds_read_b128 v[68:71], v23 offset:32768
v_mfma_f32_16x16x32_bf16 v[196:199], v[100:103], v[132:135], v[196:199]
ds_read_b64_tr_b16 v[122:123], v26 offset:20992
v_mfma_f32_16x16x32_bf16 v[236:239], v[124:127], v[104:107], v[236:239]
ds_read_b128 v[72:75], v23 offset:34816
v_mfma_f32_16x16x32_bf16 v[164:167], v[128:131], v[104:107], v[164:167]
s_add_u32 m0, s43, 8192
s_add_u32 s46, s20, 2048
buffer_load_dwordx4 v27, s[8:11], s46 offen lds
v_mfma_f32_16x16x32_bf16 v[200:203], v[104:107], v[132:135], v[200:203]
v_mfma_f32_16x16x32_bf16 v[168:171], v[128:131], v[108:111], v[168:171]
v_mfma_f32_16x16x32_bf16 v[204:207], v[108:111], v[132:135], v[204:207]
s_waitcnt vmcnt(3) lgkmcnt(0)
s_barrier
v_mfma_f32_16x16x32_bf16 v[208:211], v[112:115], v[40:43], v[208:211]
v_mfma_f32_16x16x32_bf16 v[136:139], v[116:119], v[40:43], v[136:139]
ds_read_b128 v[76:79], v22 offset:18432
v_mfma_f32_16x16x32_bf16 v[172:175], v[40:43], v[120:123], v[172:175]
v_mfma_f32_16x16x32_bf16 v[212:215], v[112:115], v[44:47], v[212:215]
ds_read_b64_tr_b16 v[124:125], v26 offset:24576
v_mfma_f32_16x16x32_bf16 v[140:143], v[116:119], v[44:47], v[140:143]
ds_read_b128 v[80:83], v22 offset:20480
v_mfma_f32_16x16x32_bf16 v[176:179], v[44:47], v[120:123], v[176:179]
v_mfma_f32_16x16x32_bf16 v[216:219], v[112:115], v[48:51], v[216:219]
ds_read_b64_tr_b16 v[126:127], v26 offset:25088
v_mfma_f32_16x16x32_bf16 v[144:147], v[116:119], v[48:51], v[144:147]
ds_read_b128 v[84:87], v22 offset:22528
v_mfma_f32_16x16x32_bf16 v[180:183], v[48:51], v[120:123], v[180:183]
v_mfma_f32_16x16x32_bf16 v[220:223], v[112:115], v[52:55], v[220:223]
ds_read_b128 v[88:91], v22 offset:24576
v_mfma_f32_16x16x32_bf16 v[148:151], v[116:119], v[52:55], v[148:151]
ds_read_b64_tr_b16 v[128:129], v26 offset:28672
v_mfma_f32_16x16x32_bf16 v[184:187], v[52:55], v[120:123], v[184:187]
v_mfma_f32_16x16x32_bf16 v[224:227], v[112:115], v[56:59], v[224:227]
ds_read_b128 v[92:95], v22 offset:26624
v_mfma_f32_16x16x32_bf16 v[152:155], v[116:119], v[56:59], v[152:155]
ds_read_b64_tr_b16 v[130:131], v26 offset:29184
v_mfma_f32_16x16x32_bf16 v[188:191], v[56:59], v[120:123], v[188:191]
v_mfma_f32_16x16x32_bf16 v[228:231], v[112:115], v[60:63], v[228:231]
ds_read_b128 v[96:99], v22 offset:28672
v_mfma_f32_16x16x32_bf16 v[156:159], v[116:119], v[60:63], v[156:159]
ds_read_b128 v[100:103], v22 offset:30720
v_mfma_f32_16x16x32_bf16 v[192:195], v[60:63], v[120:123], v[192:195]
v_mfma_f32_16x16x32_bf16 v[232:235], v[112:115], v[64:67], v[232:235]
ds_read_b64_tr_b16 v[132:133], v26 offset:32768
v_mfma_f32_16x16x32_bf16 v[160:163], v[116:119], v[64:67], v[160:163]
ds_read_b128 v[104:107], v22 offset:32768
v_mfma_f32_16x16x32_bf16 v[196:199], v[64:67], v[120:123], v[196:199]
v_mfma_f32_16x16x32_bf16 v[236:239], v[112:115], v[68:71], v[236:239]
ds_read_b64_tr_b16 v[134:135], v26 offset:33280
v_mfma_f32_16x16x32_bf16 v[164:167], v[116:119], v[68:71], v[164:167]
ds_read_b128 v[108:111], v22 offset:34816
v_mfma_f32_16x16x32_bf16 v[200:203], v[68:71], v[120:123], v[200:203]
v_mfma_f32_16x16x32_bf16 v[168:171], v[116:119], v[72:75], v[168:171]
v_mfma_f32_16x16x32_bf16 v[204:207], v[72:75], v[120:123], v[204:207]
s_waitcnt lgkmcnt(0)
v_mfma_f32_16x16x32_bf16 v[208:211], v[124:127], v[76:79], v[208:211]
v_mfma_f32_16x16x32_bf16 v[136:139], v[128:131], v[76:79], v[136:139]
ds_read_b128 v[40:43], v23 offset:0
v_mfma_f32_16x16x32_bf16 v[172:175], v[76:79], v[132:135], v[172:175]
v_mfma_f32_16x16x32_bf16 v[212:215], v[124:127], v[80:83], v[212:215]
ds_read_b64_tr_b16 v[112:113], v26 offset:36864
v_mfma_f32_16x16x32_bf16 v[140:143], v[128:131], v[80:83], v[140:143]
ds_read_b128 v[44:47], v23 offset:2048
v_mfma_f32_16x16x32_bf16 v[176:179], v[80:83], v[132:135], v[176:179]
v_mfma_f32_16x16x32_bf16 v[216:219], v[124:127], v[84:87], v[216:219]
ds_read_b64_tr_b16 v[114:115], v26 offset:37376
v_mfma_f32_16x16x32_bf16 v[144:147], v[128:131], v[84:87], v[144:147]
ds_read_b128 v[48:51], v23 offset:4096
v_mfma_f32_16x16x32_bf16 v[180:183], v[84:87], v[132:135], v[180:183]
v_mfma_f32_16x16x32_bf16 v[220:223], v[124:127], v[88:91], v[220:223]
ds_read_b128 v[52:55], v23 offset:6144
v_mfma_f32_16x16x32_bf16 v[148:151], v[128:131], v[88:91], v[148:151]
ds_read_b64_tr_b16 v[116:117], v26 offset:40960
v_mfma_f32_16x16x32_bf16 v[184:187], v[88:91], v[132:135], v[184:187]
v_mfma_f32_16x16x32_bf16 v[224:227], v[124:127], v[92:95], v[224:227]
ds_read_b128 v[56:59], v23 offset:8192
v_mfma_f32_16x16x32_bf16 v[152:155], v[128:131], v[92:95], v[152:155]
ds_read_b64_tr_b16 v[118:119], v26 offset:41472
v_mfma_f32_16x16x32_bf16 v[188:191], v[92:95], v[132:135], v[188:191]
v_mfma_f32_16x16x32_bf16 v[228:231], v[124:127], v[96:99], v[228:231]
ds_read_b128 v[60:63], v23 offset:10240
v_mfma_f32_16x16x32_bf16 v[156:159], v[128:131], v[96:99], v[156:159]
ds_read_b128 v[64:67], v23 offset:12288
v_mfma_f32_16x16x32_bf16 v[192:195], v[96:99], v[132:135], v[192:195]
v_mfma_f32_16x16x32_bf16 v[232:235], v[124:127], v[100:103], v[232:235]
ds_read_b64_tr_b16 v[120:121], v26 offset:45056
v_mfma_f32_16x16x32_bf16 v[160:163], v[128:131], v[100:103], v[160:163]
ds_read_b128 v[68:71], v23 offset:14336
v_mfma_f32_16x16x32_bf16 v[196:199], v[100:103], v[132:135], v[196:199]
v_mfma_f32_16x16x32_bf16 v[236:239], v[124:127], v[104:107], v[236:239]
ds_read_b64_tr_b16 v[122:123], v26 offset:45568
v_mfma_f32_16x16x32_bf16 v[164:167], v[128:131], v[104:107], v[164:167]
ds_read_b128 v[72:75], v23 offset:16384
v_mfma_f32_16x16x32_bf16 v[200:203], v[104:107], v[132:135], v[200:203]
v_mfma_f32_16x16x32_bf16 v[168:171], v[128:131], v[108:111], v[168:171]
v_mfma_f32_16x16x32_bf16 v[204:207], v[108:111], v[132:135], v[204:207]
s_waitcnt vmcnt(0) lgkmcnt(0)
s_barrier
v_mfma_f32_16x16x32_bf16 v[208:211], v[112:115], v[40:43], v[208:211]
ds_read_b128 v[76:79], v22 offset:0
v_mfma_f32_16x16x32_bf16 v[136:139], v[116:119], v[40:43], v[136:139]
ds_read_b64_tr_b16 v[124:125], v26 offset:0
v_mfma_f32_16x16x32_bf16 v[172:175], v[40:43], v[120:123], v[172:175]
s_add_u32 m0, s86, 12288
s_nop 0
buffer_load_dwordx4 v4, s[28:31], s73 offen lds
v_mfma_f32_16x16x32_bf16 v[212:215], v[112:115], v[44:47], v[212:215]
ds_read_b128 v[80:83], v22 offset:2048
v_mfma_f32_16x16x32_bf16 v[140:143], v[116:119], v[44:47], v[140:143]
ds_read_b64_tr_b16 v[126:127], v26 offset:512
v_mfma_f32_16x16x32_bf16 v[176:179], v[44:47], v[120:123], v[176:179]
s_add_u32 m0, s86, 13312
s_add_u32 s46, s73, 8192
buffer_load_dwordx4 v4, s[28:31], s46 offen lds
v_mfma_f32_16x16x32_bf16 v[216:219], v[112:115], v[48:51], v[216:219]
ds_read_b128 v[84:87], v22 offset:4096
v_mfma_f32_16x16x32_bf16 v[144:147], v[116:119], v[48:51], v[144:147]
ds_read_b128 v[88:91], v22 offset:6144
v_mfma_f32_16x16x32_bf16 v[180:183], v[48:51], v[120:123], v[180:183]
s_add_u32 m0, s86, 14336
s_nop 0
buffer_load_dwordx4 v5, s[28:31], s73 offen lds
v_mfma_f32_16x16x32_bf16 v[220:223], v[112:115], v[52:55], v[220:223]
ds_read_b64_tr_b16 v[128:129], v26 offset:4096
v_mfma_f32_16x16x32_bf16 v[148:151], v[116:119], v[52:55], v[148:151]
ds_read_b128 v[92:95], v22 offset:8192
v_mfma_f32_16x16x32_bf16 v[184:187], v[52:55], v[120:123], v[184:187]
s_add_u32 m0, s86, 15360
s_add_u32 s46, s73, 8192
buffer_load_dwordx4 v5, s[28:31], s46 offen lds
v_mfma_f32_16x16x32_bf16 v[224:227], v[112:115], v[56:59], v[224:227]
ds_read_b64_tr_b16 v[130:131], v26 offset:4608
v_mfma_f32_16x16x32_bf16 v[152:155], v[116:119], v[56:59], v[152:155]
ds_read_b128 v[96:99], v22 offset:10240
v_mfma_f32_16x16x32_bf16 v[188:191], v[56:59], v[120:123], v[188:191]
s_add_u32 m0, s86, 28672
s_nop 0
buffer_load_dwordx4 v4, s[28:31], s72 offen lds
v_mfma_f32_16x16x32_bf16 v[228:231], v[112:115], v[60:63], v[228:231]
ds_read_b128 v[100:103], v22 offset:12288
v_mfma_f32_16x16x32_bf16 v[156:159], v[116:119], v[60:63], v[156:159]
ds_read_b64_tr_b16 v[132:133], v26 offset:8192
v_mfma_f32_16x16x32_bf16 v[192:195], v[60:63], v[120:123], v[192:195]
s_add_u32 m0, s86, 29696
s_add_u32 s46, s72, 8192
buffer_load_dwordx4 v4, s[28:31], s46 offen lds
v_mfma_f32_16x16x32_bf16 v[232:235], v[112:115], v[64:67], v[232:235]
ds_read_b128 v[104:107], v22 offset:14336
v_mfma_f32_16x16x32_bf16 v[160:163], v[116:119], v[64:67], v[160:163]
ds_read_b64_tr_b16 v[134:135], v26 offset:8704
v_mfma_f32_16x16x32_bf16 v[196:199], v[64:67], v[120:123], v[196:199]
s_add_u32 m0, s86, 30720
s_nop 0
buffer_load_dwordx4 v5, s[28:31], s72 offen lds
v_mfma_f32_16x16x32_bf16 v[236:239], v[112:115], v[68:71], v[236:239]
ds_read_b128 v[108:111], v22 offset:16384
v_mfma_f32_16x16x32_bf16 v[164:167], v[116:119], v[68:71], v[164:167]
s_add_u32 m0, s86, 31744
s_add_u32 s46, s72, 8192
buffer_load_dwordx4 v5, s[28:31], s46 offen lds
v_mfma_f32_16x16x32_bf16 v[200:203], v[68:71], v[120:123], v[200:203]
v_mfma_f32_16x16x32_bf16 v[168:171], v[116:119], v[72:75], v[168:171]
v_mfma_f32_16x16x32_bf16 v[204:207], v[72:75], v[120:123], v[204:207]
s_waitcnt vmcnt(8) lgkmcnt(0)
s_barrier
v_mfma_f32_16x16x32_bf16 v[208:211], v[124:127], v[76:79], v[208:211]
v_mfma_f32_16x16x32_bf16 v[136:139], v[128:131], v[76:79], v[136:139]
v_mfma_f32_16x16x32_bf16 v[172:175], v[76:79], v[132:135], v[172:175]
s_add_u32 m0, s86, 45056
s_nop 0
buffer_load_dwordx4 v4, s[28:31], s71 offen lds
v_mfma_f32_16x16x32_bf16 v[212:215], v[124:127], v[80:83], v[212:215]
v_mfma_f32_16x16x32_bf16 v[140:143], v[128:131], v[80:83], v[140:143]
v_mfma_f32_16x16x32_bf16 v[176:179], v[80:83], v[132:135], v[176:179]
s_add_u32 m0, s86, 46080
s_add_u32 s46, s71, 8192
buffer_load_dwordx4 v4, s[28:31], s46 offen lds
v_mfma_f32_16x16x32_bf16 v[216:219], v[124:127], v[84:87], v[216:219]
v_mfma_f32_16x16x32_bf16 v[144:147], v[128:131], v[84:87], v[144:147]
v_mfma_f32_16x16x32_bf16 v[180:183], v[84:87], v[132:135], v[180:183]
s_add_u32 m0, s86, 47104
s_nop 0
buffer_load_dwordx4 v5, s[28:31], s71 offen lds
v_mfma_f32_16x16x32_bf16 v[220:223], v[124:127], v[88:91], v[220:223]
v_mfma_f32_16x16x32_bf16 v[148:151], v[128:131], v[88:91], v[148:151]
v_mfma_f32_16x16x32_bf16 v[184:187], v[88:91], v[132:135], v[184:187]
s_add_u32 m0, s86, 48128
s_add_u32 s46, s71, 8192
buffer_load_dwordx4 v5, s[28:31], s46 offen lds
v_mfma_f32_16x16x32_bf16 v[224:227], v[124:127], v[92:95], v[224:227]
v_mfma_f32_16x16x32_bf16 v[152:155], v[128:131], v[92:95], v[152:155]
v_mfma_f32_16x16x32_bf16 v[188:191], v[92:95], v[132:135], v[188:191]
s_add_u32 m0, s86, 102400
s_nop 0
buffer_load_dwordx4 v4, s[28:31], s70 offen lds
v_mfma_f32_16x16x32_bf16 v[228:231], v[124:127], v[96:99], v[228:231]
v_mfma_f32_16x16x32_bf16 v[156:159], v[128:131], v[96:99], v[156:159]
v_mfma_f32_16x16x32_bf16 v[192:195], v[96:99], v[132:135], v[192:195]
s_add_u32 m0, s86, 103424
s_add_u32 s46, s70, 8192
buffer_load_dwordx4 v4, s[28:31], s46 offen lds
v_mfma_f32_16x16x32_bf16 v[232:235], v[124:127], v[100:103], v[232:235]
v_mfma_f32_16x16x32_bf16 v[160:163], v[128:131], v[100:103], v[160:163]
v_mfma_f32_16x16x32_bf16 v[196:199], v[100:103], v[132:135], v[196:199]
s_add_u32 m0, s86, 104448
s_nop 0
buffer_load_dwordx4 v5, s[28:31], s70 offen lds
v_mfma_f32_16x16x32_bf16 v[236:239], v[124:127], v[104:107], v[236:239]
v_mfma_f32_16x16x32_bf16 v[164:167], v[128:131], v[104:107], v[164:167]
s_add_u32 m0, s86, 105472
s_add_u32 s46, s70, 8192
buffer_load_dwordx4 v5, s[28:31], s46 offen lds
v_mfma_f32_16x16x32_bf16 v[200:203], v[104:107], v[132:135], v[200:203]
v_mfma_f32_16x16x32_bf16 v[168:171], v[128:131], v[108:111], v[168:171]
v_mfma_f32_16x16x32_bf16 v[204:207], v[108:111], v[132:135], v[204:207]
v_lshlrev_b32_e64 v10, 4, v3
v_add_u32 v10, 157696, v10
ds_read_b128 v[40:43], v10 offset:256
ds_read_b128 v[44:47], v10 offset:512
ds_read_b128 v[48:51], v10 offset:768
ds_read_b128 v[52:55], v10 offset:1024
ds_read_b128 v[56:59], v10 offset:1280
ds_read_b128 v[60:63], v10 offset:1536
ds_read_b128 v[64:67], v10 offset:1792
ds_read_b128 v[68:71], v10 offset:2048
ds_read_b128 v[72:75], v10 offset:0
s_lshl_b32 s48, s42, 6
s_add_u32 s48, s48, 160768
v_lshl_add_u32 v11, v2, 4, s48
v_lshl_add_u32 v16, v3, 2, s48
ds_read_b128 v[26:29], v11
ds_read_b128 v[22:25], v11 offset:256
ds_read_b32 v110, v16 offset:512
v_lshlrev_b32 v31, 6, v2
v_add_u32 v31, 157696, v31
v_add_u32 v18, 1024, v31
v_add_u32 v19, 2048, v31
v_and_b32 v12, 1, v3
v_cmp_eq_u32 s[54:55], 1, v12
v_lshlrev_b32 v13, 2, v2
v_add_u32 v13, v13, v12
v_cmp_ge_u32 s[56:57], v3, v13
v_add_u32 v13, 2, v13
v_cmp_ge_u32 s[58:59], v3, v13
v_mov_b32 v14, 0xffff
v_mov_b32 v15, 0xffff0000
v_cndmask_b32 v14, v14, v15, s[54:55]
v_cndmask_b32 v112, v14, 0, s[56:57]
v_cndmask_b32 v113, v14, 0, s[58:59]
v_cndmask_b32 v114, 0, v14, s[56:57]
v_cndmask_b32 v115, 0, v14, s[58:59]
s_cmp_eq_u32 s40, 0
s_cselect_b32 s62, 0xf149f2ca, 0
s_waitcnt lgkmcnt(0)
v_pk_mul_f32 v[10:11], v[26:27], v[42:43] op_sel:[0,1] op_sel_hi:[1,1]
v_pk_mul_f32 v[12:13], v[28:29], v[42:43] op_sel:[0,1] op_sel_hi:[1,1]
v_pk_fma_f32 v[208:209], v[208:209], v[40:41], v[10:11] op_sel:[0,0,0] op_sel_hi:[1,0,1]
v_pk_fma_f32 v[210:211], v[210:211], v[40:41], v[12:13] op_sel:[0,0,0] op_sel_hi:[1,0,1]
v_cvt_pk_bf16_f32 v94, v208, v209
v_cvt_pk_bf16_f32 v95, v210, v211
v_pk_mul_f32 v[14:15], v[26:27], v[46:47] op_sel:[0,1] op_sel_hi:[1,1]
v_pk_mul_f32 v[16:17], v[28:29], v[46:47] op_sel:[0,1] op_sel_hi:[1,1]
v_pk_fma_f32 v[212:213], v[212:213], v[44:45], v[14:15] op_sel:[0,0,0] op_sel_hi:[1,0,1]
v_pk_fma_f32 v[214:215], v[214:215], v[44:45], v[16:17] op_sel:[0,0,0] op_sel_hi:[1,0,1]
v_cvt_pk_bf16_f32 v96, v212, v213
v_cvt_pk_bf16_f32 v97, v214, v215
v_pk_mul_f32 v[10:11], v[26:27], v[50:51] op_sel:[0,1] op_sel_hi:[1,1]
v_pk_mul_f32 v[12:13], v[28:29], v[50:51] op_sel:[0,1] op_sel_hi:[1,1]
v_pk_fma_f32 v[216:217], v[216:217], v[48:49], v[10:11] op_sel:[0,0,0] op_sel_hi:[1,0,1]
v_pk_fma_f32 v[218:219], v[218:219], v[48:49], v[12:13] op_sel:[0,0,0] op_sel_hi:[1,0,1]
v_cvt_pk_bf16_f32 v98, v216, v217
v_cvt_pk_bf16_f32 v99, v218, v219
v_pk_mul_f32 v[14:15], v[26:27], v[54:55] op_sel:[0,1] op_sel_hi:[1,1]
v_pk_mul_f32 v[16:17], v[28:29], v[54:55] op_sel:[0,1] op_sel_hi:[1,1]
v_pk_fma_f32 v[220:221], v[220:221], v[52:53], v[14:15] op_sel:[0,0,0] op_sel_hi:[1,0,1]
v_pk_fma_f32 v[222:223], v[222:223], v[52:53], v[16:17] op_sel:[0,0,0] op_sel_hi:[1,0,1]
v_cvt_pk_bf16_f32 v100, v220, v221
v_cvt_pk_bf16_f32 v101, v222, v223
v_pk_mul_f32 v[10:11], v[26:27], v[58:59] op_sel:[0,1] op_sel_hi:[1,1]
v_pk_mul_f32 v[12:13], v[28:29], v[58:59] op_sel:[0,1] op_sel_hi:[1,1]
v_pk_fma_f32 v[224:225], v[224:225], v[56:57], v[10:11] op_sel:[0,0,0] op_sel_hi:[1,0,1]
v_pk_fma_f32 v[226:227], v[226:227], v[56:57], v[12:13] op_sel:[0,0,0] op_sel_hi:[1,0,1]
v_cvt_pk_bf16_f32 v102, v224, v225
v_cvt_pk_bf16_f32 v103, v226, v227
v_pk_mul_f32 v[14:15], v[26:27], v[62:63] op_sel:[0,1] op_sel_hi:[1,1]
v_pk_mul_f32 v[16:17], v[28:29], v[62:63] op_sel:[0,1] op_sel_hi:[1,1]
v_pk_fma_f32 v[228:229], v[228:229], v[60:61], v[14:15] op_sel:[0,0,0] op_sel_hi:[1,0,1]
v_pk_fma_f32 v[230:231], v[230:231], v[60:61], v[16:17] op_sel:[0,0,0] op_sel_hi:[1,0,1]
v_cvt_pk_bf16_f32 v104, v228, v229
v_cvt_pk_bf16_f32 v105, v230, v231
v_pk_mul_f32 v[10:11], v[26:27], v[66:67] op_sel:[0,1] op_sel_hi:[1,1]
v_pk_mul_f32 v[12:13], v[28:29], v[66:67] op_sel:[0,1] op_sel_hi:[1,1]
v_pk_fma_f32 v[232:233], v[232:233], v[64:65], v[10:11] op_sel:[0,0,0] op_sel_hi:[1,0,1]
v_pk_fma_f32 v[234:235], v[234:235], v[64:65], v[12:13] op_sel:[0,0,0] op_sel_hi:[1,0,1]
v_cvt_pk_bf16_f32 v106, v232, v233
v_cvt_pk_bf16_f32 v107, v234, v235
v_pk_mul_f32 v[14:15], v[26:27], v[70:71] op_sel:[0,1] op_sel_hi:[1,1]
v_pk_mul_f32 v[16:17], v[28:29], v[70:71] op_sel:[0,1] op_sel_hi:[1,1]
v_pk_fma_f32 v[236:237], v[236:237], v[68:69], v[14:15] op_sel:[0,0,0] op_sel_hi:[1,0,1]
v_pk_fma_f32 v[238:239], v[238:239], v[68:69], v[16:17] op_sel:[0,0,0] op_sel_hi:[1,0,1]
v_cvt_pk_bf16_f32 v108, v236, v237
v_cvt_pk_bf16_f32 v109, v238, v239
ds_read2_b32 v[208:209], v31 offset0:64 offset1:68
ds_read2_b32 v[210:211], v31 offset0:72 offset1:76
ds_read2_b32 v[212:213], v31 offset0:67 offset1:71
ds_read2_b32 v[214:215], v31 offset0:75 offset1:79
ds_read2_b32 v[216:217], v31 offset0:128 offset1:132
ds_read2_b32 v[218:219], v31 offset0:136 offset1:140
ds_read2_b32 v[220:221], v31 offset0:131 offset1:135
ds_read2_b32 v[222:223], v31 offset0:139 offset1:143
ds_read2_b32 v[224:225], v31 offset0:192 offset1:196
ds_read2_b32 v[226:227], v31 offset0:200 offset1:204
ds_read2_b32 v[228:229], v31 offset0:195 offset1:199
ds_read2_b32 v[230:231], v31 offset0:203 offset1:207
ds_read2_b32 v[232:233], v18 offset0:0 offset1:4
ds_read2_b32 v[234:235], v18 offset0:8 offset1:12
ds_read2_b32 v[236:237], v18 offset0:3 offset1:7
ds_read2_b32 v[238:239], v18 offset0:11 offset1:15
v_pk_mul_f32 v[10:11], v[22:23], v[42:43] op_sel:[0,1] op_sel_hi:[1,1]
v_pk_mul_f32 v[12:13], v[24:25], v[42:43] op_sel:[0,1] op_sel_hi:[1,1]
v_pk_fma_f32 v[136:137], v[136:137], v[40:41], v[10:11] op_sel:[0,0,0] op_sel_hi:[1,0,1]
v_pk_fma_f32 v[138:139], v[138:139], v[40:41], v[12:13] op_sel:[0,0,0] op_sel_hi:[1,0,1]
v_cvt_pk_bf16_f32 v76, v136, v137
v_cvt_pk_bf16_f32 v77, v138, v139
v_pk_mul_f32 v[14:15], v[22:23], v[46:47] op_sel:[0,1] op_sel_hi:[1,1]
v_pk_mul_f32 v[16:17], v[24:25], v[46:47] op_sel:[0,1] op_sel_hi:[1,1]
v_pk_fma_f32 v[140:141], v[140:141], v[44:45], v[14:15] op_sel:[0,0,0] op_sel_hi:[1,0,1]
v_pk_fma_f32 v[142:143], v[142:143], v[44:45], v[16:17] op_sel:[0,0,0] op_sel_hi:[1,0,1]
v_cvt_pk_bf16_f32 v78, v140, v141
v_cvt_pk_bf16_f32 v79, v142, v143
v_pk_mul_f32 v[10:11], v[22:23], v[50:51] op_sel:[0,1] op_sel_hi:[1,1]
v_pk_mul_f32 v[12:13], v[24:25], v[50:51] op_sel:[0,1] op_sel_hi:[1,1]
v_pk_fma_f32 v[144:145], v[144:145], v[48:49], v[10:11] op_sel:[0,0,0] op_sel_hi:[1,0,1]
v_pk_fma_f32 v[146:147], v[146:147], v[48:49], v[12:13] op_sel:[0,0,0] op_sel_hi:[1,0,1]
v_cvt_pk_bf16_f32 v80, v144, v145
v_cvt_pk_bf16_f32 v81, v146, v147
v_pk_mul_f32 v[14:15], v[22:23], v[54:55] op_sel:[0,1] op_sel_hi:[1,1]
v_pk_mul_f32 v[16:17], v[24:25], v[54:55] op_sel:[0,1] op_sel_hi:[1,1]
v_pk_fma_f32 v[148:149], v[148:149], v[52:53], v[14:15] op_sel:[0,0,0] op_sel_hi:[1,0,1]
v_pk_fma_f32 v[150:151], v[150:151], v[52:53], v[16:17] op_sel:[0,0,0] op_sel_hi:[1,0,1]
v_cvt_pk_bf16_f32 v82, v148, v149
v_cvt_pk_bf16_f32 v83, v150, v151
v_pk_mul_f32 v[10:11], v[22:23], v[58:59] op_sel:[0,1] op_sel_hi:[1,1]
v_pk_mul_f32 v[12:13], v[24:25], v[58:59] op_sel:[0,1] op_sel_hi:[1,1]
v_pk_fma_f32 v[152:153], v[152:153], v[56:57], v[10:11] op_sel:[0,0,0] op_sel_hi:[1,0,1]
v_pk_fma_f32 v[154:155], v[154:155], v[56:57], v[12:13] op_sel:[0,0,0] op_sel_hi:[1,0,1]
v_cvt_pk_bf16_f32 v84, v152, v153
v_cvt_pk_bf16_f32 v85, v154, v155
v_pk_mul_f32 v[14:15], v[22:23], v[62:63] op_sel:[0,1] op_sel_hi:[1,1]
v_pk_mul_f32 v[16:17], v[24:25], v[62:63] op_sel:[0,1] op_sel_hi:[1,1]
v_pk_fma_f32 v[156:157], v[156:157], v[60:61], v[14:15] op_sel:[0,0,0] op_sel_hi:[1,0,1]
v_pk_fma_f32 v[158:159], v[158:159], v[60:61], v[16:17] op_sel:[0,0,0] op_sel_hi:[1,0,1]
v_cvt_pk_bf16_f32 v86, v156, v157
v_cvt_pk_bf16_f32 v87, v158, v159
v_pk_mul_f32 v[10:11], v[22:23], v[66:67] op_sel:[0,1] op_sel_hi:[1,1]
v_pk_mul_f32 v[12:13], v[24:25], v[66:67] op_sel:[0,1] op_sel_hi:[1,1]
v_pk_fma_f32 v[160:161], v[160:161], v[64:65], v[10:11] op_sel:[0,0,0] op_sel_hi:[1,0,1]
v_pk_fma_f32 v[162:163], v[162:163], v[64:65], v[12:13] op_sel:[0,0,0] op_sel_hi:[1,0,1]
v_cvt_pk_bf16_f32 v88, v160, v161
v_cvt_pk_bf16_f32 v89, v162, v163
v_pk_mul_f32 v[14:15], v[22:23], v[70:71] op_sel:[0,1] op_sel_hi:[1,1]
v_pk_mul_f32 v[16:17], v[24:25], v[70:71] op_sel:[0,1] op_sel_hi:[1,1]
v_pk_fma_f32 v[164:165], v[164:165], v[68:69], v[14:15] op_sel:[0,0,0] op_sel_hi:[1,0,1]
v_pk_fma_f32 v[166:167], v[166:167], v[68:69], v[16:17] op_sel:[0,0,0] op_sel_hi:[1,0,1]
v_cvt_pk_bf16_f32 v90, v164, v165
v_cvt_pk_bf16_f32 v91, v166, v167
v_pk_mul_f32 v[10:11], v[22:23], v[74:75] op_sel:[0,1] op_sel_hi:[1,1]
v_pk_mul_f32 v[12:13], v[24:25], v[74:75] op_sel:[0,1] op_sel_hi:[1,1]
v_pk_fma_f32 v[168:169], v[168:169], v[72:73], v[10:11] op_sel:[0,0,0] op_sel_hi:[1,0,1]
v_pk_fma_f32 v[170:171], v[170:171], v[72:73], v[12:13] op_sel:[0,0,0] op_sel_hi:[1,0,1]
v_cvt_pk_bf16_f32 v92, v168, v169
v_cvt_pk_bf16_f32 v93, v170, v171
s_waitcnt lgkmcnt(0)
ds_read2_b32 v[136:137], v18 offset0:64 offset1:68
ds_read2_b32 v[138:139], v18 offset0:72 offset1:76
ds_read2_b32 v[140:141], v18 offset0:67 offset1:71
ds_read2_b32 v[142:143], v18 offset0:75 offset1:79
ds_read2_b32 v[144:145], v18 offset0:128 offset1:132
ds_read2_b32 v[146:147], v18 offset0:136 offset1:140
ds_read2_b32 v[148:149], v18 offset0:131 offset1:135
ds_read2_b32 v[150:151], v18 offset0:139 offset1:143
ds_read2_b32 v[152:153], v18 offset0:192 offset1:196
ds_read2_b32 v[154:155], v18 offset0:200 offset1:204
ds_read2_b32 v[156:157], v18 offset0:195 offset1:199
ds_read2_b32 v[158:159], v18 offset0:203 offset1:207
ds_read2_b32 v[160:161], v19 offset0:0 offset1:4
ds_read2_b32 v[162:163], v19 offset0:8 offset1:12
ds_read2_b32 v[164:165], v19 offset0:3 offset1:7
ds_read2_b32 v[166:167], v19 offset0:11 offset1:15
ds_read2_b32 v[40:41], v31 offset0:0 offset1:4
ds_read2_b32 v[42:43], v31 offset0:8 offset1:12
ds_read2_b32 v[44:45], v31 offset0:3 offset1:7
ds_read2_b32 v[46:47], v31 offset0:11 offset1:15
v_pk_mul_f32 v[212:213], v[212:213], v[110:111] op_sel:[0,0] op_sel_hi:[1,0]
v_pk_mul_f32 v[214:215], v[214:215], v[110:111] op_sel:[0,0] op_sel_hi:[1,0]
v_pk_fma_f32 v[172:173], v[172:173], v[208:209], v[212:213]
v_pk_fma_f32 v[174:175], v[174:175], v[210:211], v[214:215]
v_cvt_pk_bf16_f32 v118, v172, v173
v_cvt_pk_bf16_f32 v119, v174, v175
v_pk_mul_f32 v[220:221], v[220:221], v[110:111] op_sel:[0,0] op_sel_hi:[1,0]
v_pk_mul_f32 v[222:223], v[222:223], v[110:111] op_sel:[0,0] op_sel_hi:[1,0]
v_pk_fma_f32 v[176:177], v[176:177], v[216:217], v[220:221]
v_pk_fma_f32 v[178:179], v[178:179], v[218:219], v[222:223]
v_cvt_pk_bf16_f32 v120, v176, v177
v_cvt_pk_bf16_f32 v121, v178, v179
v_pk_mul_f32 v[228:229], v[228:229], v[110:111] op_sel:[0,0] op_sel_hi:[1,0]
v_pk_mul_f32 v[230:231], v[230:231], v[110:111] op_sel:[0,0] op_sel_hi:[1,0]
v_pk_fma_f32 v[180:181], v[180:181], v[224:225], v[228:229]
v_pk_fma_f32 v[182:183], v[182:183], v[226:227], v[230:231]
v_cvt_pk_bf16_f32 v122, v180, v181
v_cvt_pk_bf16_f32 v123, v182, v183
v_pk_mul_f32 v[236:237], v[236:237], v[110:111] op_sel:[0,0] op_sel_hi:[1,0]
v_pk_mul_f32 v[238:239], v[238:239], v[110:111] op_sel:[0,0] op_sel_hi:[1,0]
v_pk_fma_f32 v[184:185], v[184:185], v[232:233], v[236:237]
v_pk_fma_f32 v[186:187], v[186:187], v[234:235], v[238:239]
v_cvt_pk_bf16_f32 v124, v184, v185
v_cvt_pk_bf16_f32 v125, v186, v187
s_waitcnt lgkmcnt(0)
v_pk_mul_f32 v[140:141], v[140:141], v[110:111] op_sel:[0,0] op_sel_hi:[1,0]
v_pk_mul_f32 v[142:143], v[142:143], v[110:111] op_sel:[0,0] op_sel_hi:[1,0]
v_pk_fma_f32 v[188:189], v[188:189], v[136:137], v[140:141]
v_pk_fma_f32 v[190:191], v[190:191], v[138:139], v[142:143]
v_cvt_pk_bf16_f32 v126, v188, v189
v_cvt_pk_bf16_f32 v127, v190, v191
v_pk_mul_f32 v[148:149], v[148:149], v[110:111] op_sel:[0,0] op_sel_hi:[1,0]
v_pk_mul_f32 v[150:151], v[150:151], v[110:111] op_sel:[0,0] op_sel_hi:[1,0]
v_pk_fma_f32 v[192:193], v[192:193], v[144:145], v[148:149]
v_pk_fma_f32 v[194:195], v[194:195], v[146:147], v[150:151]
v_cvt_pk_bf16_f32 v128, v192, v193
v_cvt_pk_bf16_f32 v129, v194, v195
v_pk_mul_f32 v[156:157], v[156:157], v[110:111] op_sel:[0,0] op_sel_hi:[1,0]
v_pk_mul_f32 v[158:159], v[158:159], v[110:111] op_sel:[0,0] op_sel_hi:[1,0]
v_pk_fma_f32 v[196:197], v[196:197], v[152:153], v[156:157]
v_pk_fma_f32 v[198:199], v[198:199], v[154:155], v[158:159]
v_cvt_pk_bf16_f32 v130, v196, v197
v_cvt_pk_bf16_f32 v131, v198, v199
v_pk_mul_f32 v[164:165], v[164:165], v[110:111] op_sel:[0,0] op_sel_hi:[1,0]
v_pk_mul_f32 v[166:167], v[166:167], v[110:111] op_sel:[0,0] op_sel_hi:[1,0]
v_pk_fma_f32 v[200:201], v[200:201], v[160:161], v[164:165]
v_pk_fma_f32 v[202:203], v[202:203], v[162:163], v[166:167]
v_cvt_pk_bf16_f32 v132, v200, v201
v_cvt_pk_bf16_f32 v133, v202, v203
v_pk_mul_f32 v[44:45], v[44:45], v[110:111] op_sel:[0,0] op_sel_hi:[1,0]
v_pk_mul_f32 v[46:47], v[46:47], v[110:111] op_sel:[0,0] op_sel_hi:[1,0]
v_pk_fma_f32 v[204:205], v[204:205], v[40:41], v[44:45]
v_pk_fma_f32 v[206:207], v[206:207], v[42:43], v[46:47]
v_cvt_pk_bf16_f32 v116, v204, v205
v_cvt_pk_bf16_f32 v117, v206, v207
s_nop 1
v_mfma_f32_16x16x16_bf16 v[40:43], v[92:93], v[94:95], 0
v_mfma_f32_16x16x16_bf16 v[44:47], v[76:77], v[94:95], 0
v_mfma_f32_16x16x16_bf16 v[48:51], v[76:77], v[96:97], 0
v_mfma_f32_16x16x16_bf16 v[52:55], v[78:79], v[96:97], 0
v_mfma_f32_16x16x16_bf16 v[56:59], v[78:79], v[98:99], 0
v_mfma_f32_16x16x16_bf16 v[60:63], v[80:81], v[98:99], 0
v_mfma_f32_16x16x16_bf16 v[64:67], v[80:81], v[100:101], 0
v_mfma_f32_16x16x16_bf16 v[68:71], v[82:83], v[100:101], 0
v_mfma_f32_16x16x16_bf16 v[136:139], v[82:83], v[102:103], 0
v_mfma_f32_16x16x16_bf16 v[140:143], v[84:85], v[102:103], 0
v_mfma_f32_16x16x16_bf16 v[144:147], v[84:85], v[104:105], 0
v_mfma_f32_16x16x16_bf16 v[148:151], v[86:87], v[104:105], 0
v_mfma_f32_16x16x16_bf16 v[152:155], v[86:87], v[106:107], 0
v_mfma_f32_16x16x16_bf16 v[156:159], v[88:89], v[106:107], 0
v_mfma_f32_16x16x16_bf16 v[160:163], v[88:89], v[108:109], 0
v_mfma_f32_16x16x16_bf16 v[164:167], v[90:91], v[108:109], 0
s_nop 7
v_cndmask_b32 v40, v40, v41, s[54:55]
v_cndmask_b32 v42, v42, v43, s[54:55]
v_cndmask_b32 v44, v44, v45, s[54:55]
v_cndmask_b32 v46, v46, v47, s[54:55]
v_add_f32 v40, s62, v40
v_add_f32 v42, s62, v42
v_cndmask_b32 v40, v40, v44, s[56:57]
v_cndmask_b32 v41, v42, v46, s[58:59]
v_max_f32 v42, v40, v41
v_max_f32 v43, v40, v41
v_cndmask_b32 v48, v48, v49, s[54:55]
v_cndmask_b32 v50, v50, v51, s[54:55]
v_cndmask_b32 v52, v52, v53, s[54:55]
v_cndmask_b32 v54, v54, v55, s[54:55]
v_cndmask_b32 v48, v48, v52, s[56:57]
v_cndmask_b32 v49, v50, v54, s[58:59]
v_max_f32 v50, v48, v49
v_max_f32 v51, v48, v49
v_cndmask_b32 v56, v56, v57, s[54:55]
v_cndmask_b32 v58, v58, v59, s[54:55]
v_cndmask_b32 v60, v60, v61, s[54:55]
v_cndmask_b32 v62, v62, v63, s[54:55]
v_cndmask_b32 v56, v56, v60, s[56:57]
v_cndmask_b32 v57, v58, v62, s[58:59]
v_max_f32 v58, v56, v57
v_max_f32 v59, v56, v57
v_cndmask_b32 v64, v64, v65, s[54:55]
v_cndmask_b32 v66, v66, v67, s[54:55]
v_cndmask_b32 v68, v68, v69, s[54:55]
v_cndmask_b32 v70, v70, v71, s[54:55]
v_cndmask_b32 v64, v64, v68, s[56:57]
v_cndmask_b32 v65, v66, v70, s[58:59]
v_max_f32 v66, v64, v65
v_max_f32 v67, v64, v65
v_cndmask_b32 v136, v136, v137, s[54:55]
v_cndmask_b32 v138, v138, v139, s[54:55]
v_cndmask_b32 v140, v140, v141, s[54:55]
v_cndmask_b32 v142, v142, v143, s[54:55]
v_cndmask_b32 v136, v136, v140, s[56:57]
v_cndmask_b32 v137, v138, v142, s[58:59]
v_max_f32 v138, v136, v137
v_max_f32 v139, v136, v137
v_cndmask_b32 v144, v144, v145, s[54:55]
v_cndmask_b32 v146, v146, v147, s[54:55]
v_cndmask_b32 v148, v148, v149, s[54:55]
v_cndmask_b32 v150, v150, v151, s[54:55]
v_cndmask_b32 v144, v144, v148, s[56:57]
v_cndmask_b32 v145, v146, v150, s[58:59]
v_max_f32 v146, v144, v145
v_max_f32 v147, v144, v145
v_cndmask_b32 v152, v152, v153, s[54:55]
v_cndmask_b32 v154, v154, v155, s[54:55]
v_cndmask_b32 v156, v156, v157, s[54:55]
v_cndmask_b32 v158, v158, v159, s[54:55]
v_cndmask_b32 v152, v152, v156, s[56:57]
v_cndmask_b32 v153, v154, v158, s[58:59]
v_max_f32 v154, v152, v153
v_max_f32 v155, v152, v153
v_cndmask_b32 v160, v160, v161, s[54:55]
v_cndmask_b32 v162, v162, v163, s[54:55]
v_cndmask_b32 v164, v164, v165, s[54:55]
v_cndmask_b32 v166, v166, v167, s[54:55]
v_cndmask_b32 v160, v160, v164, s[56:57]
v_cndmask_b32 v161, v162, v166, s[58:59]
v_max_f32 v162, v160, v161
v_max_f32 v163, v160, v161
s_nop 1
v_permlane32_swap_b32 v42, v43
v_permlane32_swap_b32 v50, v51
v_permlane32_swap_b32 v58, v59
v_permlane32_swap_b32 v66, v67
v_permlane32_swap_b32 v138, v139
v_permlane32_swap_b32 v146, v147
v_permlane32_swap_b32 v154, v155
v_permlane32_swap_b32 v162, v163
s_nop 1
v_max_f32 v44, v42, v43
v_max_f32 v45, v42, v43
v_max_f32 v52, v50, v51
v_max_f32 v53, v50, v51
v_max_f32 v60, v58, v59
v_max_f32 v61, v58, v59
v_max_f32 v68, v66, v67
v_max_f32 v69, v66, v67
v_max_f32 v140, v138, v139
v_max_f32 v141, v138, v139
v_max_f32 v148, v146, v147
v_max_f32 v149, v146, v147
v_max_f32 v156, v154, v155
v_max_f32 v157, v154, v155
v_max_f32 v164, v162, v163
v_max_f32 v165, v162, v163
s_nop 1
v_permlane16_swap_b32 v44, v45
v_permlane16_swap_b32 v52, v53
v_permlane16_swap_b32 v60, v61
v_permlane16_swap_b32 v68, v69
v_permlane16_swap_b32 v140, v141
v_permlane16_swap_b32 v148, v149
v_permlane16_swap_b32 v156, v157
v_permlane16_swap_b32 v164, v165
s_mov_b32 s48, 0x3eb8aa3b
s_nop 0
v_max_f32 v42, v44, v45
v_mul_f32 v42, s48, v42
v_fma_f32 v40, v40, s48, -v42
v_fma_f32 v41, v41, s48, -v42
v_max_f32 v50, v52, v53
v_mul_f32 v50, s48, v50
v_fma_f32 v48, v48, s48, -v50
v_fma_f32 v49, v49, s48, -v50
v_max_f32 v58, v60, v61
v_mul_f32 v58, s48, v58
v_fma_f32 v56, v56, s48, -v58
v_fma_f32 v57, v57, s48, -v58
v_max_f32 v66, v68, v69
v_mul_f32 v66, s48, v66
v_fma_f32 v64, v64, s48, -v66
v_fma_f32 v65, v65, s48, -v66
v_max_f32 v138, v140, v141
v_mul_f32 v138, s48, v138
v_fma_f32 v136, v136, s48, -v138
v_fma_f32 v137, v137, s48, -v138
v_max_f32 v146, v148, v149
v_mul_f32 v146, s48, v146
v_fma_f32 v144, v144, s48, -v146
v_fma_f32 v145, v145, s48, -v146
v_max_f32 v154, v156, v157
v_mul_f32 v154, s48, v154
v_fma_f32 v152, v152, s48, -v154
v_fma_f32 v153, v153, s48, -v154
v_max_f32 v162, v164, v165
v_mul_f32 v162, s48, v162
v_fma_f32 v160, v160, s48, -v162
v_fma_f32 v161, v161, s48, -v162
v_exp_f32 v40, v40
v_exp_f32 v41, v41
v_exp_f32 v48, v48
v_exp_f32 v49, v49
v_exp_f32 v56, v56
v_exp_f32 v57, v57
v_exp_f32 v64, v64
v_exp_f32 v65, v65
v_exp_f32 v136, v136
v_exp_f32 v137, v137
v_exp_f32 v144, v144
v_exp_f32 v145, v145
v_exp_f32 v152, v152
v_exp_f32 v153, v153
v_exp_f32 v160, v160
v_exp_f32 v161, v161
s_nop 0
v_cvt_pk_bf16_f32 v40, v40, v40
v_cvt_pk_bf16_f32 v41, v41, v41
v_and_b32 v44, v40, v112
v_and_b32 v45, v41, v113
v_and_b32 v46, v40, v114
v_and_b32_e64 v47, v41, v115
v_cvt_pk_bf16_f32 v48, v48, v48
v_cvt_pk_bf16_f32 v49, v49, v49
v_and_b32 v52, v48, v112
v_and_b32 v53, v49, v113
v_and_b32 v54, v48, v114
v_and_b32 v55, v49, v115
v_cvt_pk_bf16_f32 v56, v56, v56
v_cvt_pk_bf16_f32 v57, v57, v57
v_and_b32 v60, v56, v112
v_and_b32 v61, v57, v113
v_and_b32 v62, v56, v114
v_and_b32 v63, v57, v115
v_cvt_pk_bf16_f32 v64, v64, v64
v_cvt_pk_bf16_f32 v65, v65, v65
v_and_b32 v68, v64, v112
v_and_b32 v69, v65, v113
v_and_b32 v70, v64, v114
v_and_b32 v71, v65, v115
v_cvt_pk_bf16_f32 v136, v136, v136
v_cvt_pk_bf16_f32 v137, v137, v137
v_and_b32 v140, v136, v112
v_and_b32 v141, v137, v113
v_and_b32 v142, v136, v114
v_and_b32 v143, v137, v115
v_cvt_pk_bf16_f32 v144, v144, v144
v_cvt_pk_bf16_f32 v145, v145, v145
v_and_b32 v148, v144, v112
v_and_b32 v149, v145, v113
v_and_b32 v150, v144, v114
v_and_b32 v151, v145, v115
v_cvt_pk_bf16_f32 v152, v152, v152
v_cvt_pk_bf16_f32 v153, v153, v153
v_and_b32 v156, v152, v112
v_and_b32 v157, v153, v113
v_and_b32 v158, v152, v114
v_and_b32 v159, v153, v115
v_cvt_pk_bf16_f32 v160, v160, v160
v_cvt_pk_bf16_f32 v161, v161, v161
v_and_b32 v164, v160, v112
v_and_b32 v165, v161, v113
v_and_b32 v166, v160, v114
v_and_b32 v167, v161, v115
s_nop 1
v_mfma_f32_16x16x32_bf16 v[40:43], v[116:119], v[44:47], 0
v_mfma_f32_16x16x32_bf16 v[76:79], v[36:39], v[44:47], 0
v_mfma_f32_16x16x32_bf16 v[48:51], v[118:121], v[52:55], 0
v_mfma_f32_16x16x32_bf16 v[80:83], v[36:39], v[52:55], 0
v_mfma_f32_16x16x32_bf16 v[56:59], v[120:123], v[60:63], 0
v_mfma_f32_16x16x32_bf16 v[84:87], v[36:39], v[60:63], 0
v_mfma_f32_16x16x32_bf16 v[64:67], v[122:125], v[68:71], 0
v_mfma_f32_16x16x32_bf16 v[88:91], v[36:39], v[68:71], 0
v_mfma_f32_16x16x32_bf16 v[136:139], v[124:127], v[140:143], 0
v_mfma_f32_16x16x32_bf16 v[92:95], v[36:39], v[140:143], 0
v_mfma_f32_16x16x32_bf16 v[144:147], v[126:129], v[148:151], 0
v_mfma_f32_16x16x32_bf16 v[96:99], v[36:39], v[148:151], 0
v_mfma_f32_16x16x32_bf16 v[152:155], v[128:131], v[156:159], 0
v_mfma_f32_16x16x32_bf16 v[100:103], v[36:39], v[156:159], 0
v_mfma_f32_16x16x32_bf16 v[160:163], v[130:133], v[164:167], 0
v_mfma_f32_16x16x32_bf16 v[104:107], v[36:39], v[164:167], 0
v_lshrrev_b32 v11, 5, v1
v_lshlrev_b32 v11, 10, v11
v_and_b32 v12, 31, v1
v_lshl_add_u32 v10, v12, 4, v11
s_lshl_b32 s48, s40, 1
s_mul_i32 s60, s48, 294912
s_lshl_b32 s48, s41, 1
s_lshr_b32 s49, s42, 1
s_add_u32 s48, s48, s49
s_lshl_b32 s48, s48, 12
s_and_b32 s49, s42, 1
s_lshl_b32 s49, s49, 9
s_add_u32 s48, s48, s49
s_add_u32 s60, s60, s48
s_add_u32 s61, s60, 294912
v_rcp_f32 v76, v76
v_rcp_f32 v80, v80
v_rcp_f32 v84, v84
v_rcp_f32 v88, v88
v_rcp_f32 v92, v92
v_rcp_f32 v96, v96
v_rcp_f32 v100, v100
v_rcp_f32 v104, v104
s_nop 0
v_pk_mul_f32 v[40:41], v[40:41], v[76:77] op_sel:[0,0] op_sel_hi:[1,0]
v_pk_mul_f32 v[42:43], v[42:43], v[76:77] op_sel:[0,0] op_sel_hi:[1,0]
v_cvt_pk_bf16_f32 v44, v40, v41
v_cvt_pk_bf16_f32 v45, v42, v43
v_pk_mul_f32 v[48:49], v[48:49], v[80:81] op_sel:[0,0] op_sel_hi:[1,0]
v_pk_mul_f32 v[50:51], v[50:51], v[80:81] op_sel:[0,0] op_sel_hi:[1,0]
v_cvt_pk_bf16_f32 v46, v48, v49
v_cvt_pk_bf16_f32 v47, v50, v51
s_nop 1
v_permlane32_swap_b32 v44, v46
v_permlane32_swap_b32 v45, v47
buffer_store_dwordx4 v[44:47], v10, s[24:27], s60 offen sc1
v_pk_mul_f32 v[56:57], v[56:57], v[84:85] op_sel:[0,0] op_sel_hi:[1,0]
v_pk_mul_f32 v[58:59], v[58:59], v[84:85] op_sel:[0,0] op_sel_hi:[1,0]
v_cvt_pk_bf16_f32 v60, v56, v57
v_cvt_pk_bf16_f32 v61, v58, v59
v_pk_mul_f32 v[64:65], v[64:65], v[88:89] op_sel:[0,0] op_sel_hi:[1,0]
v_pk_mul_f32 v[66:67], v[66:67], v[88:89] op_sel:[0,0] op_sel_hi:[1,0]
v_cvt_pk_bf16_f32 v62, v64, v65
v_cvt_pk_bf16_f32 v63, v66, v67
s_nop 1
v_permlane32_swap_b32 v60, v62
v_permlane32_swap_b32 v61, v63
buffer_store_dwordx4 v[60:63], v10, s[24:27], s60 offen offset:2048 sc1
v_pk_mul_f32 v[136:137], v[136:137], v[92:93] op_sel:[0,0] op_sel_hi:[1,0]
v_pk_mul_f32 v[138:139], v[138:139], v[92:93] op_sel:[0,0] op_sel_hi:[1,0]
v_cvt_pk_bf16_f32 v140, v136, v137
v_cvt_pk_bf16_f32 v141, v138, v139
v_pk_mul_f32 v[144:145], v[144:145], v[96:97] op_sel:[0,0] op_sel_hi:[1,0]
v_pk_mul_f32 v[146:147], v[146:147], v[96:97] op_sel:[0,0] op_sel_hi:[1,0]
v_cvt_pk_bf16_f32 v142, v144, v145
v_cvt_pk_bf16_f32 v143, v146, v147
s_nop 1
v_permlane32_swap_b32 v140, v142
v_permlane32_swap_b32 v141, v143
buffer_store_dwordx4 v[140:143], v10, s[24:27], s61 offen sc1
v_pk_mul_f32 v[152:153], v[152:153], v[100:101] op_sel:[0,0] op_sel_hi:[1,0]
v_pk_mul_f32 v[154:155], v[154:155], v[100:101] op_sel:[0,0] op_sel_hi:[1,0]
v_cvt_pk_bf16_f32 v156, v152, v153
v_cvt_pk_bf16_f32 v157, v154, v155
v_pk_mul_f32 v[160:161], v[160:161], v[104:105] op_sel:[0,0] op_sel_hi:[1,0]
v_pk_mul_f32 v[162:163], v[162:163], v[104:105] op_sel:[0,0] op_sel_hi:[1,0]
v_cvt_pk_bf16_f32 v158, v160, v161
v_cvt_pk_bf16_f32 v159, v162, v163
s_nop 1
v_permlane32_swap_b32 v156, v158
v_permlane32_swap_b32 v157, v159
buffer_store_dwordx4 v[156:159], v10, s[24:27], s61 offen offset:2048 sc1
s_waitcnt vmcnt(16)
ds_read_b64_tr_b16 v[240:241], v6 offset:12288
ds_read_b64_tr_b16 v[242:243], v6 offset:13312
ds_read_b64_tr_b16 v[244:245], v7 offset:12288
ds_read_b64_tr_b16 v[246:247], v7 offset:13312
ds_read_b64_tr_b16 v[248:249], v8 offset:12288
ds_read_b64_tr_b16 v[250:251], v8 offset:13312
ds_read_b64_tr_b16 v[252:253], v9 offset:12288
ds_read_b64_tr_b16 v[254:255], v9 offset:13312
s_waitcnt vmcnt(12)
ds_read_b64_tr_b16 v[224:225], v6 offset:28672
ds_read_b64_tr_b16 v[226:227], v6 offset:29696
ds_read_b64_tr_b16 v[228:229], v7 offset:28672
ds_read_b64_tr_b16 v[230:231], v7 offset:29696
ds_read_b64_tr_b16 v[232:233], v8 offset:28672
ds_read_b64_tr_b16 v[234:235], v8 offset:29696
ds_read_b64_tr_b16 v[236:237], v9 offset:28672
ds_read_b64_tr_b16 v[238:239], v9 offset:29696
s_waitcnt vmcnt(8)
ds_read_b64_tr_b16 v[208:209], v6 offset:45056
ds_read_b64_tr_b16 v[210:211], v6 offset:46080
ds_read_b64_tr_b16 v[212:213], v7 offset:45056
ds_read_b64_tr_b16 v[214:215], v7 offset:46080
ds_read_b64_tr_b16 v[216:217], v8 offset:45056
ds_read_b64_tr_b16 v[218:219], v8 offset:46080
ds_read_b64_tr_b16 v[220:221], v9 offset:45056
ds_read_b64_tr_b16 v[222:223], v9 offset:46080
s_waitcnt vmcnt(4)
v_add_u32 v18, 102400, v6
ds_read_b64_tr_b16 v[192:193], v18
ds_read_b64_tr_b16 v[194:195], v18 offset:1024
v_add_u32 v19, 102400, v7
ds_read_b64_tr_b16 v[196:197], v19
ds_read_b64_tr_b16 v[198:199], v19 offset:1024
v_add_u32 v20, 102400, v8
ds_read_b64_tr_b16 v[200:201], v20
ds_read_b64_tr_b16 v[202:203], v20 offset:1024
v_add_u32 v21, 102400, v9
ds_read_b64_tr_b16 v[204:205], v21
ds_read_b64_tr_b16 v[206:207], v21 offset:1024
v_lshlrev_b32 v10, 2, v1
v_add_u32 v10, 162624, v10
v_mov_b32 v14, 1
v_lshlrev_b32_e64 v13, 2, v3
v_add_u32 v13, 162368, v13
ds_read_b32 v11, v13
v_lshlrev_b32 v15, 7, v3
v_lshl_add_u32 v15, v2, 27, v15
s_waitcnt vmcnt(0)
ds_add_rtn_u32 v12, v10, v14
s_waitcnt lgkmcnt(0)
v_readfirstlane_b32 s48, v12
s_nop 3
s_cmp_eq_u32 s48, 3
s_cbranch_scc0 L_H_nosig
buffer_store_dword v11, v15, s[24:27], s87 offen offset:0 sc1
L_H_nosig:
s_setprio 3
s_branch L_P2_0
.p2align 3
L_F24:
v_and_b32 v12, 2, v10
s_and_b32 s48, s42, 1
s_lshl_b32 s48, s48, 2
v_or_b32 v12, s48, v12
v_xor_b32 v12, v12, v11
v_lshlrev_b32 v12, 4, v12
v_lshl_add_u32 v13, s42, 3, v10
v_mul_u32_u24 v92, 3584, v13
v_add_u32 v92, v92, v12
v_add_u32 v27, s45, v92
v_add_u32 v92, s52, v92
v_lshrrev_b32 v14, 2, v1
v_lshrrev_b32 v15, 4, v1
v_and_b32 v15, 2, v15
v_and_b32 v16, 3, v1
v_xor_b32 v15, v15, v16
v_lshlrev_b32 v15, 4, v15
s_and_b32 s48, s42, 1
s_lshl_b32 s48, s48, 4
v_add_u32 v14, s48, v14
v_mul_u32_u24 v30, 3584, v14
v_add3_u32 v30, v30, v15, s53
s_mov_b32 s12, s72
s_and_b32 s13, s73, 0xffff
s_mov_b32 s14, 1835008
s_mov_b32 s15, 0x20000
s_mov_b32 s16, s74
s_and_b32 s17, s75, 0xffff
s_mov_b32 s18, 1835008
s_mov_b32 s19, 0x20000
s_cmp_lt_u32 s42, 2
s_cselect_b64 s[8:9], s[12:13], s[16:17]
s_cselect_b32 s10, s14, s18
s_mov_b32 s11, 0x20000
s_mov_b32 s24, s82
s_and_b32 s25, s83, 0xffff
s_mov_b32 s26, 9838592
s_mov_b32 s27, 0x20000
v_lshrrev_b32 v12, 2, v3
v_lshlrev_b32 v10, 7, v12
v_lshl_add_u32 v10, v2, 10, v10
v_and_b32 v13, 3, v3
v_lshl_add_u32 v10, v13, 3, v10
v_lshrrev_b32 v11, 3, v3
v_and_b32 v13, 1, v2
v_lshl_add_u32 v11, v13, 1, v11
s_and_b32 s50, s42, 1
s_lshl_b32 s48, s50, 1
s_add_u32 s49, s48, 1
v_xor_b32 v26, s48, v11
v_lshl_add_u32 v26, v26, 5, v10
v_xor_b32 v33, s49, v11
v_lshl_add_u32 v33, v33, 5, v10
v_lshrrev_b32 v34, 1, v2
v_lshlrev_b32 v34, 10, v34
v_and_b32_e64 v13, 1, v2
v_lshl_add_u32 v34, v13, 9, v34
v_lshl_add_u32 v34, v12, 6, v34
v_xor_b32 v13, s50, v13
v_lshl_add_u32 v34, v13, 5, v34
v_and_b32 v13, 3, v3
v_lshl_add_u32 v34, v13, 3, v34
v_add_u32 v35, 61440, v26
v_add_u32 v36, 61440, v33
v_add_u32 v37, 61440, v34
v_xor_b32_e64 v100, s42, v11
v_lshl_add_u32 v100, v100, 5, v10
v_add_u32 v100, 61440, v100
s_lshr_b32 s48, s42, 1
s_lshl_b32 s48, s48, 11
s_add_u32 s48, s48, 8192
v_add_u32 v101, s48, v37
v_lshrrev_b32 v14, 1, v3
v_xor_b32 v14, v14, v2
v_lshlrev_b32 v14, 4, v14
v_lshl_add_u32 v14, v3, 7, v14
s_lshr_b32 s63, s42, 1
s_lshl_b32 s48, s63, 13
s_add_u32 s48, s48, 83968
v_add_u32 v22, s48, v14
v_xor_b32 v23, 64, v22
v_add_u32 v24, 36864, v22
v_add_u32 v25, 36864, v23
v_mov_b32 v40, 0x3f803f80
v_mov_b32 v41, 0x3f803f80
v_mov_b32 v42, 0x3f803f80
v_mov_b32 v43, 0x3f803f80
s_mov_b32 s32, s78
s_and_b32 s33, s79, 0xffff
s_mov_b32 s34, 2097152
s_mov_b32 s35, 0x20000
s_mov_b32 s28, s68
s_and_b32 s29, s69, 0xffff
s_mov_b32 s30, 524288
s_mov_b32 s31, 0x20000
s_add_u32 s50, s84, s85
s_lshl_b32 s51, s42, 17
s_add_u32 s55, s50, 0
s_and_b32 s55, s55, 3
s_lshl_b32 s55, s55, 15
s_add_u32 s73, s55, s51
s_add_u32 s55, s50, 1
s_and_b32 s55, s55, 3
s_lshl_b32 s55, s55, 15
s_add_u32 s72, s55, s51
s_add_u32 s55, s50, 2
s_and_b32 s55, s55, 3
s_lshl_b32 s55, s55, 15
s_add_u32 s71, s55, s51
s_add_u32 s55, s50, 3
s_and_b32 s55, s55, 3
s_lshl_b32 s55, s55, 15
s_add_u32 s70, s55, s51
v_lshrrev_b32 v10, 3, v1
v_and_b32 v11, 6, v10
v_and_b32 v12, 7, v1
v_xor_b32 v11, v11, v12
v_lshlrev_b32_e64 v11, 4, v11
v_lshl_add_u32 v4, v10, 10, v11
v_lshl_add_u32 v4, s85, 7, v4
v_add_u32 v5, 16384, v4
v_and_b32 v10, 1, v2
v_lshlrev_b32 v10, 2, v10
v_lshrrev_b32 v11, 2, v3
v_add_u32 v10, v10, v11
v_lshrrev_b32 v11, 1, v2
v_lshlrev_b32 v11, 11, v11
v_lshl_add_u32 v11, v10, 7, v11
v_and_b32 v12, 3, v3
v_lshl_add_u32 v11, v12, 3, v11
v_add_u32 v11, s86, v11
v_lshrrev_b32 v12, 1, v10
v_lshl_add_u32 v6, v12, 5, v11
v_xor_b32 v7, 32, v6
v_xor_b32 v8, 64, v6
v_xor_b32 v9, 96, v6
s_lshl2_add_u32 s48, s2, s42
s_mul_i32 s48, s48, 4
v_add_u32 v31, s48, v1
v_lshlrev_b32 v31, 7, v31
v_cmp_gt_u32 vcc, 4, v1
v_bfrev_b32 v10, 2
s_nop 0
v_cndmask_b32 v31, v10, v31, vcc
s_add_u32 s48, s62, 16
s_max_u32 s49, s40, 1
s_sub_u32 s49, s49, 1
s_lshl_b32 s48, s48, 8
s_mul_i32 s49, s49, 0x01010000
s_or_b32 s48, s48, s40
s_or_b32 s48, s48, s49
v_lshlrev_b32 v11, 3, v2
v_lshrrev_b32 v94, v11, s48
v_and_b32 v94, 0xff, v94
v_lshlrev_b32_e64 v94, 7, v94
v_lshl_add_u32 v94, v3, 2, v94
v_add_u32 v94, 9437184, v94
s_lshl3_add_u32 s48, s84, s85
s_lshl_b32 s48, s48, 7
s_add_u32 s48, s48, 9805696
v_lshl_add_u32 v10, v1, 2, s48
v_lshlrev_b32 v11, 7, v3
v_lshl_add_u32 v11, v2, 6, v11
v_add_u32 v11, s87, v11
v_cmp_gt_u32 vcc, 32, v1
s_nop 1
v_cndmask_b32 v96, v10, v11, vcc
s_lshl_b32 s48, s40, 7
s_lshl_b32 s49, s62, 3
s_add_u32 s48, s48, s49
s_lshl_b32 s49, s42, 1
s_add_u32 s48, s48, s49
v_lshrrev_b32 v95, 5, v1
v_add_u32 v95, s48, v95
v_and_b32 v10, 31, v1
v_lshlrev_b32 v10, 4, v10
v_lshl_add_u32 v97, v95, 10, v10
v_lshlrev_b32 v95, 4, v95
v_add_u32 v95, 9441280, v95
v_and_b32 v11, 31, v1
v_lshl_add_u32 v95, v11, 26, v95
v_lshlrev_b32 v102, 16, v1
v_bfrev_b32 v10, 2
v_cmp_gt_u32 vcc, 11, v1
s_nop 1
v_cndmask_b32 v102, v10, v102, vcc
s_mul_i32 s60, s40, 589824
s_mul_i32 s61, s84, 294912
s_lshl_b32 s56, s84, 16
s_lshl_b32 s58, 1, s62
s_lshl_b32 s48, 0x10000, s40
s_or_b32 s58, s58, s48
s_mov_b32 s59, 0
s_mul_i32 s50, s40, 114688
s_mul_i32 s51, s40, 98304
s_cmp_eq_u32 s3, 3
s_cbranch_scc0 L_F24_nf
buffer_load_dword v93, v94, s[24:27], 0 offen sc1
buffer_load_dword v96, v96, s[24:27], 0 offen sc1
L_F24_nf:
buffer_load_dwordx4 v[84:87], v97, s[4:7], 0 offen
buffer_load_dwordx4 v[88:91], v97, s[4:7], 0 offen offset:512
s_add_u32 m0, s43, 61440
s_add_u32 s46, s50, 0
buffer_load_dwordx4 v27, s[12:15], s46 offen lds
s_add_u32 m0, s43, 65536
s_add_u32 s46, s50, 0
buffer_load_dwordx4 v27, s[16:19], s46 offen lds
s_add_u32 m0, s43, 69632
s_add_u32 s46, s50, 0
buffer_load_dwordx4 v30, s[8:11], s46 offen lds
s_add_u32 m0, s43, 73728
s_add_u32 s46, s50, 0
buffer_load_dwordx4 v92, s[12:15], s46 offen lds
s_add_u32 m0, s43, 77824
s_add_u32 s46, s50, 0
buffer_load_dwordx4 v92, s[16:19], s46 offen lds
s_waitcnt vmcnt(11) lgkmcnt(0)
s_barrier
s_add_u32 m0, s44, 36864
s_add_u32 s46, s22, 256
buffer_load_dwordx4 v28, s[4:7], s46 offen lds
s_add_u32 m0, s44, 37888
s_add_u32 s46, s22, 256
buffer_load_dwordx4 v29, s[4:7], s46 offen lds
s_add_u32 m0, s44, 38912
s_add_u32 s46, s22, 16640
buffer_load_dwordx4 v28, s[4:7], s46 offen lds
s_add_u32 m0, s44, 39936
s_add_u32 s46, s22, 16640
buffer_load_dwordx4 v29, s[4:7], s46 offen lds
s_waitcnt vmcnt(15) lgkmcnt(0)
s_barrier
s_add_u32 m0, s44, 55296
s_add_u32 s46, s22, 384
buffer_load_dwordx4 v28, s[4:7], s46 offen lds
s_add_u32 m0, s44, 56320
s_add_u32 s46, s22, 384
buffer_load_dwordx4 v29, s[4:7], s46 offen lds
s_waitcnt vmcnt(13) lgkmcnt(0)
s_barrier
s_waitcnt vmcnt(11)
v_lshlrev_b32 v10, 16, v84
v_and_b32 v11, 0xffff0000, v84
v_mov_b32 v14, v10
v_mov_b32 v15, v11
v_mul_f32 v16, v10, v10
v_mul_f32 v17, v11, v11
v_lshlrev_b32 v12, 16, v85
v_and_b32 v13, 0xffff0000, v85
v_add_f32 v14, v14, v12
v_add_f32 v15, v15, v13
v_fmac_f32 v16, v12, v12
v_fmac_f32 v17, v13, v13
v_lshlrev_b32 v10, 16, v86
v_and_b32 v11, 0xffff0000, v86
s_add_u32 m0, s44, 57344
s_add_u32 s46, s22, 16768
buffer_load_dwordx4 v28, s[4:7], s46 offen lds
v_add_f32 v14, v14, v10
v_add_f32 v15, v15, v11
v_fmac_f32 v16, v10, v10
v_fmac_f32 v17, v11, v11
v_lshlrev_b32 v12, 16, v87
v_and_b32 v13, 0xffff0000, v87
v_add_f32 v14, v14, v12
v_add_f32 v15, v15, v13
v_fmac_f32 v16, v12, v12
v_fmac_f32 v17, v13, v13
v_lshlrev_b32 v10, 16, v88
v_and_b32 v11, 0xffff0000, v88
v_add_f32 v14, v14, v10
v_add_f32 v15, v15, v11
v_fmac_f32 v16, v10, v10
v_fmac_f32 v17, v11, v11
v_lshlrev_b32_e64 v12, 16, v89
v_and_b32 v13, 0xffff0000, v89
s_add_u32 m0, s44, 58368
s_add_u32 s46, s22, 16768
buffer_load_dwordx4 v29, s[4:7], s46 offen lds
v_add_f32 v14, v14, v12
v_add_f32 v15, v15, v13
v_fmac_f32 v16, v12, v12
v_fmac_f32 v17, v13, v13
s_waitcnt vmcnt(15) lgkmcnt(0)
s_barrier
v_lshlrev_b32 v10, 16, v90
v_and_b32 v11, 0xffff0000, v90
v_add_f32 v14, v14, v10
v_add_f32 v15, v15, v11
v_fmac_f32 v16, v10, v10
v_fmac_f32 v17, v11, v11
v_lshlrev_b32 v12, 16, v91
v_and_b32 v13, 0xffff0000, v91
v_add_f32 v14, v14, v12
v_add_f32 v15, v15, v13
v_fmac_f32 v16, v12, v12
v_fmac_f32 v17, v13, v13
v_add_f32 v14, v14, v15
v_add_f32 v16, v16, v17
s_nop 0
s_add_u32 m0, s44, 0
s_sub_u32 s46, 512, s22
buffer_load_dwordx4 v28, s[4:7], s46 offen lds
v_add_f32_dpp v14, v14, v14 row_ror:8 row_mask:0xf bank_mask:0xf
v_add_f32_dpp v16, v16, v16 row_ror:8 row_mask:0xf bank_mask:0xf
s_nop 0
v_add_f32_dpp v14, v14, v14 row_ror:4 row_mask:0xf bank_mask:0xf
v_add_f32_dpp v16, v16, v16 row_ror:4 row_mask:0xf bank_mask:0xf
s_nop 0
v_add_f32_dpp v14, v14, v14 row_ror:2 row_mask:0xf bank_mask:0xf
v_add_f32_dpp v16, v16, v16 row_ror:2 row_mask:0xf bank_mask:0xf
s_nop 0
v_add_f32_dpp v14, v14, v14 row_ror:1 row_mask:0xf bank_mask:0xf
v_add_f32_dpp v16, v16, v16 row_ror:1 row_mask:0xf bank_mask:0xf
s_nop 0
v_mov_b32 v15, v14
v_mov_b32 v17, v16
s_nop 1
v_permlane16_swap_b32 v14, v15
v_permlane16_swap_b32 v16, v17
s_nop 0
v_add_f32 v14, v14, v15
v_add_f32 v16, v16, v17
s_add_u32 m0, s44, 1024
s_sub_u32 s46, 512, s22
buffer_load_dwordx4 v29, s[4:7], s46 offen lds
v_mul_f32 v14, 0x3b000000, v14
s_waitcnt vmcnt(6) lgkmcnt(0)
s_barrier
v_mul_f32 v16, 0x3b000000, v16
v_fma_f32 v16, -v14, v14, v16
v_max_f32 v16, 0, v16
v_cvt_pk_bf16_f32 v16, v16, v16
v_lshlrev_b32 v16, 16, v16
s_add_u32 m0, s44, 2048
s_sub_u32 s46, 16896, s22
buffer_load_dwordx4 v28, s[4:7], s46 offen lds
v_add_f32 v16, 0x3727c5ac, v16
v_cvt_pk_bf16_f32 v16, v16, v16
v_lshlrev_b32 v16, 16, v16
v_sqrt_f32 v16, v16
v_cvt_pk_bf16_f32 v14, v14, v14
v_lshlrev_b32_e64 v14, 16, v14
s_add_u32 m0, s44, 3072
s_sub_u32 s46, 16896, s22
buffer_load_dwordx4 v29, s[4:7], s46 offen lds
v_cvt_pk_bf16_f32 v86, v16, v16
v_lshlrev_b32 v86, 16, v86
v_rcp_f32 v84, v86
v_sub_f32 v85, 0, v14
v_mul_f32 v87, v84, v85
buffer_load_dword v32, v31, s[28:31], 0 offen
buffer_store_dwordx4 v[84:87], v95, s[24:27], 0 offen sc1
s_waitcnt vmcnt(10) lgkmcnt(0)
s_barrier
ds_read_b64_tr_b16 v[44:45], v100 offset:0
ds_read_b64_tr_b16 v[46:47], v100 offset:512
ds_read_b64_tr_b16 v[48:49], v100 offset:4096
ds_read_b64_tr_b16 v[50:51], v100 offset:4608
ds_read_b64_tr_b16 v[52:53], v101
ds_read_b64_tr_b16 v[54:55], v101 offset:256
ds_read_b64_tr_b16 v[56:57], v100 offset:12288
ds_read_b64_tr_b16 v[58:59], v100 offset:12800
s_add_u32 m0, s44, 18432
s_sub_u32 s46, 640, s22
buffer_load_dwordx4 v28, s[4:7], s46 offen lds
ds_read_b64_tr_b16 v[60:61], v100 offset:16384
ds_read_b64_tr_b16 v[62:63], v100 offset:16896
s_mul_i32 s23, s62, 20480
s_mul_i32 s48, s40, 1280
s_add_u32 s23, s23, s48
s_add_u32 s23, s23, 9478144
s_lshl_b32 s48, s42, 6
s_add_u32 s48, s48, s23
s_mov_b32 s50, 0x100c0600
v_lshlrev_b32 v10, 3, v2
v_lshrrev_b32 v10, v10, s50
v_and_b32 v10, 0xff, v10
v_lshlrev_b32 v10, 6, v10
v_lshl_add_u32 v97, v3, 2, v10
v_lshlrev_b32 v11, 2, v3
v_lshl_add_u32 v11, v2, 27, v11
s_add_u32 m0, s44, 19456
s_sub_u32 s46, 640, s22
buffer_load_dwordx4 v29, s[4:7], s46 offen lds
s_lshr_b32 s49, s42, 1
s_lshl_b32 s49, s49, 8
s_add_u32 s49, s49, s48
s_add_u32 s49, s49, 256
s_waitcnt vmcnt(8) lgkmcnt(0)
s_barrier
s_add_u32 m0, s44, 20480
s_sub_u32 s46, 17024, s22
buffer_load_dwordx4 v28, s[4:7], s46 offen lds
s_add_u32 m0, s44, 21504
s_sub_u32 s46, 17024, s22
buffer_load_dwordx4 v29, s[4:7], s46 offen lds
s_waitcnt vmcnt(10) lgkmcnt(0)
s_barrier
s_add_u32 m0, s44, 36864
s_sub_u32 s46, 768, s22
buffer_load_dwordx4 v28, s[4:7], s46 offen lds
s_add_u32 m0, s44, 37888
s_sub_u32 s46, 768, s22
buffer_load_dwordx4 v29, s[4:7], s46 offen lds
s_waitcnt vmcnt(8) lgkmcnt(0)
s_barrier
s_waitcnt lgkmcnt(0)
v_mfma_f32_16x16x32_bf16 v[64:67], v[40:43], v[44:47], 0
v_mfma_f32_16x16x32_bf16 v[68:71], v[40:43], v[48:51], 0
v_mfma_f32_16x16x32_bf16 v[76:79], v[40:43], v[56:59], 0
v_mfma_f32_16x16x32_bf16 v[80:83], v[40:43], v[60:63], 0
v_mfma_f32_16x16x32_bf16 v[72:75], v[40:43], v[52:55], 0
s_mov_b32 vcc_lo, 0xffff0000
s_mov_b32 vcc_hi, 0xffff0000
s_nop 5
v_cndmask_b32 v64, v64, v68, vcc
v_cndmask_b32 v76, v76, v80, vcc
s_mov_b32 vcc_lo, 0
s_mov_b32 vcc_hi, -1
s_nop 1
v_cndmask_b32 v64, v64, v76, vcc
s_add_u32 m0, s44, 38912
s_sub_u32 s46, 17152, s22
buffer_load_dwordx4 v28, s[4:7], s46 offen lds
buffer_store_dword v64, v97, s[24:27], s48 offen sc1
s_add_u32 m0, s44, 39936
s_sub_u32 s46, 17152, s22
buffer_load_dwordx4 v29, s[4:7], s46 offen lds
buffer_store_dword v72, v11, s[24:27], s49 offen sc1
s_waitcnt vmcnt(12) lgkmcnt(0)
s_barrier
s_add_u32 m0, s44, 55296
s_sub_u32 s46, 896, s22
buffer_load_dwordx4 v28, s[4:7], s46 offen lds
s_cmp_eq_u32 s3, 3
s_cbranch_scc0 L_F24_ns
v_lshlrev_b32 v11, 2, v1
v_add_u32 v11, 162112, v11
v_add_u32 v93, 1, v93
v_add_u32 v96, 1, v96
ds_write_b32 v11, v96 offset:256
L_F24_ns:
s_add_u32 m0, s44, 56320
s_sub_u32 s46, 896, s22
buffer_load_dwordx4 v29, s[4:7], s46 offen lds
v_bfrev_b32 v10, 2
v_cndmask_b32 v96, v10, v94, s[58:59]
s_waitcnt vmcnt(8) lgkmcnt(0)
s_barrier
s_add_u32 m0, s44, 57344
s_sub_u32 s46, 17280, s22
buffer_load_dwordx4 v28, s[4:7], s46 offen lds
s_add_u32 m0, s44, 58368
s_sub_u32 s46, 17280, s22
buffer_load_dwordx4 v29, s[4:7], s46 offen lds
s_waitcnt vmcnt(4) lgkmcnt(0)
s_barrier
s_cmp_eq_u32 s3, 3
s_cbranch_scc0 L_F24_np
buffer_store_dword v93, v96, s[24:27], 0 offen sc1
L_F24_np:
s_add_u32 m0, s43, 49152
s_sub_u32 s46, 1720320, s21
buffer_load_dwordx4 v27, s[12:15], s46 offen lds
s_add_u32 m0, s43, 53248
s_sub_u32 s46, 1720320, s21
buffer_load_dwordx4 v27, s[16:19], s46 offen lds
s_add_u32 m0, s43, 57344
s_sub_u32 s46, 1720320, s21
buffer_load_dwordx4 v30, s[8:11], s46 offen lds
s_waitcnt vmcnt(7) lgkmcnt(0)
s_barrier
s_add_u32 m0, s43, 61440
s_sub_u32 s46, 1605632, s21
buffer_load_dwordx4 v27, s[12:15], s46 offen lds
s_add_u32 m0, s43, 65536
s_sub_u32 s46, 1605632, s21
buffer_load_dwordx4 v27, s[16:19], s46 offen lds
s_add_u32 m0, s43, 69632
s_sub_u32 s46, 1605632, s21
buffer_load_dwordx4 v30, s[8:11], s46 offen lds
s_waitcnt vmcnt(10) lgkmcnt(0)
s_barrier
s_add_u32 m0, s43, 12288
s_sub_u32 s46, 1490944, s21
buffer_load_dwordx4 v27, s[12:15], s46 offen lds
s_add_u32 m0, s43, 16384
s_sub_u32 s46, 1490944, s21
buffer_load_dwordx4 v27, s[16:19], s46 offen lds
s_add_u32 m0, s43, 20480
s_sub_u32 s46, 1490944, s21
buffer_load_dwordx4 v30, s[8:11], s46 offen lds
s_waitcnt vmcnt(9) lgkmcnt(0)
s_barrier
s_waitcnt vmcnt(9) lgkmcnt(0)
s_barrier
s_add_u32 m0, s43, 24576
s_sub_u32 s46, 1376256, s21
buffer_load_dwordx4 v27, s[12:15], s46 offen lds
s_add_u32 m0, s43, 28672
s_sub_u32 s46, 1376256, s21
buffer_load_dwordx4 v27, s[16:19], s46 offen lds
s_add_u32 m0, s43, 32768
s_sub_u32 s46, 1376256, s21
buffer_load_dwordx4 v30, s[8:11], s46 offen lds
s_add_u32 m0, s43, 36864
s_sub_u32 s46, 1261568, s21
buffer_load_dwordx4 v27, s[12:15], s46 offen lds
s_add_u32 m0, s43, 40960
s_sub_u32 s46, 1261568, s21
buffer_load_dwordx4 v27, s[16:19], s46 offen lds
s_add_u32 m0, s43, 45056
s_sub_u32 s46, 1261568, s21
buffer_load_dwordx4 v30, s[8:11], s46 offen lds
s_waitcnt vmcnt(12) lgkmcnt(0)
s_barrier
ds_read_b64_tr_b16 v[172:173], v26 offset:49152
ds_read_b64_tr_b16 v[174:175], v26 offset:49664
ds_read_b64_tr_b16 v[176:177], v26 offset:53248
ds_read_b128 v[140:143], v25 offset:18432
ds_read_b64_tr_b16 v[178:179], v26 offset:53760
s_add_u32 m0, s43, 0
s_sub_u32 s46, 1146880, s21
buffer_load_dwordx4 v27, s[12:15], s46 offen lds
ds_read_b64_tr_b16 v[180:181], v33 offset:49152
ds_read_b64_tr_b16 v[182:183], v33 offset:49664
ds_read_b128 v[144:147], v25 offset:20480
ds_read_b64_tr_b16 v[184:185], v33 offset:53248
ds_read_b64_tr_b16 v[186:187], v33 offset:53760
s_add_u32 m0, s43, 4096
s_sub_u32 s46, 1146880, s21
buffer_load_dwordx4 v27, s[16:19], s46 offen lds
ds_read_b64_tr_b16 v[188:189], v34 offset:57344
ds_read_b128 v[148:151], v25 offset:22528
ds_read_b64_tr_b16 v[190:191], v34 offset:57600
ds_read_b64_tr_b16 v[192:193], v34 offset:59392
ds_read_b64_tr_b16 v[194:195], v34 offset:59648
s_add_u32 m0, s43, 8192
s_sub_u32 s46, 1146880, s21
buffer_load_dwordx4 v30, s[8:11], s46 offen lds
ds_read_b128 v[152:155], v25 offset:24576
s_setprio 1
s_waitcnt vmcnt(9) lgkmcnt(0)
s_barrier
v_mfma_f32_16x16x32_bf16 v[44:47], v[172:175], v[140:143], 0
v_mfma_f32_16x16x32_bf16 v[48:51], v[176:179], v[140:143], 0
ds_read_b64_tr_b16 v[196:197], v35 offset:0
v_mfma_f32_16x16x32_bf16 v[76:79], v[180:183], v[140:143], 0
ds_read_b64_tr_b16 v[198:199], v35 offset:512
v_mfma_f32_16x16x32_bf16 v[80:83], v[184:187], v[140:143], 0
ds_read_b64_tr_b16 v[200:201], v35 offset:4096
v_mfma_f32_16x16x32_bf16 v[108:111], v[188:191], v[140:143], 0
ds_read_b128 v[156:159], v24 offset:18432
v_mfma_f32_16x16x32_bf16 v[112:115], v[192:195], v[140:143], 0
ds_read_b64_tr_b16 v[202:203], v35 offset:4608
v_mfma_f32_16x16x32_bf16 v[52:55], v[172:175], v[144:147], 0
ds_read_b64_tr_b16 v[204:205], v36 offset:0
v_mfma_f32_16x16x32_bf16 v[56:59], v[176:179], v[144:147], 0
s_add_u32 m0, s43, 49152
s_sub_u32 s46, 1032192, s21
buffer_load_dwordx4 v27, s[12:15], s46 offen lds
v_mfma_f32_16x16x32_bf16 v[84:87], v[180:183], v[144:147], 0
ds_read_b64_tr_b16 v[206:207], v36 offset:512
v_mfma_f32_16x16x32_bf16 v[88:91], v[184:187], v[144:147], 0
ds_read_b128 v[160:163], v24 offset:20480
v_mfma_f32_16x16x32_bf16 v[116:119], v[188:191], v[144:147], 0
v_mfma_f32_16x16x32_bf16 v[120:123], v[192:195], v[144:147], 0
ds_read_b64_tr_b16 v[208:209], v36 offset:4096
v_mfma_f32_16x16x32_bf16 v[60:63], v[172:175], v[148:151], 0
ds_read_b64_tr_b16 v[210:211], v36 offset:4608
v_mfma_f32_16x16x32_bf16 v[64:67], v[176:179], v[148:151], 0
ds_read_b64_tr_b16 v[212:213], v37 offset:8192
v_mfma_f32_16x16x32_bf16 v[92:95], v[180:183], v[148:151], 0
s_add_u32 m0, s43, 53248
s_sub_u32 s46, 1032192, s21
buffer_load_dwordx4 v27, s[16:19], s46 offen lds
v_mfma_f32_16x16x32_bf16 v[96:99], v[184:187], v[148:151], 0
ds_read_b128 v[164:167], v24 offset:22528
v_mfma_f32_16x16x32_bf16 v[124:127], v[188:191], v[148:151], 0
ds_read_b64_tr_b16 v[214:215], v37 offset:8448
v_mfma_f32_16x16x32_bf16 v[128:131], v[192:195], v[148:151], 0
ds_read_b64_tr_b16 v[216:217], v37 offset:10240
v_mfma_f32_16x16x32_bf16 v[68:71], v[172:175], v[152:155], 0
ds_read_b64_tr_b16 v[218:219], v37 offset:10496
v_mfma_f32_16x16x32_bf16 v[72:75], v[176:179], v[152:155], 0
ds_read_b128 v[168:171], v24 offset:24576
v_mfma_f32_16x16x32_bf16 v[100:103], v[180:183], v[152:155], 0
s_add_u32 m0, s43, 57344
s_sub_u32 s46, 1032192, s21
buffer_load_dwordx4 v30, s[8:11], s46 offen lds
v_mfma_f32_16x16x32_bf16 v[104:107], v[184:187], v[152:155], 0
v_mfma_f32_16x16x32_bf16 v[132:135], v[188:191], v[152:155], 0
v_mfma_f32_16x16x32_bf16 v[136:139], v[192:195], v[152:155], 0
s_waitcnt lgkmcnt(0)
v_mfma_f32_16x16x32_bf16 v[44:47], v[196:199], v[156:159], v[44:47]
v_mfma_f32_16x16x32_bf16 v[48:51], v[200:203], v[156:159], v[48:51]
ds_read_b64_tr_b16 v[172:173], v26 offset:12288
v_mfma_f32_16x16x32_bf16 v[76:79], v[204:207], v[156:159], v[76:79]
ds_read_b64_tr_b16 v[174:175], v26 offset:12800
v_mfma_f32_16x16x32_bf16 v[80:83], v[208:211], v[156:159], v[80:83]
ds_read_b64_tr_b16 v[176:177], v26 offset:16384
v_mfma_f32_16x16x32_bf16 v[108:111], v[212:215], v[156:159], v[108:111]
v_mfma_f32_16x16x32_bf16 v[112:115], v[216:219], v[156:159], v[112:115]
ds_read_b128 v[140:143], v25 offset:0
v_mfma_f32_16x16x32_bf16 v[52:55], v[196:199], v[160:163], v[52:55]
ds_read_b64_tr_b16 v[178:179], v26 offset:16896
v_mfma_f32_16x16x32_bf16 v[56:59], v[200:203], v[160:163], v[56:59]
ds_read_b64_tr_b16 v[180:181], v33 offset:12288
v_mfma_f32_16x16x32_bf16 v[84:87], v[204:207], v[160:163], v[84:87]
v_mfma_f32_16x16x32_bf16 v[88:91], v[208:211], v[160:163], v[88:91]
ds_read_b64_tr_b16 v[182:183], v33 offset:12800
v_mfma_f32_16x16x32_bf16 v[116:119], v[212:215], v[160:163], v[116:119]
ds_read_b128 v[144:147], v25 offset:2048
v_mfma_f32_16x16x32_bf16 v[120:123], v[216:219], v[160:163], v[120:123]
ds_read_b64_tr_b16 v[184:185], v33 offset:16384
v_mfma_f32_16x16x32_bf16 v[60:63], v[196:199], v[164:167], v[60:63]
v_mfma_f32_16x16x32_bf16 v[64:67], v[200:203], v[164:167], v[64:67]
ds_read_b64_tr_b16 v[186:187], v33 offset:16896
v_mfma_f32_16x16x32_bf16 v[92:95], v[204:207], v[164:167], v[92:95]
ds_read_b64_tr_b16 v[188:189], v34 offset:20480
v_mfma_f32_16x16x32_bf16 v[96:99], v[208:211], v[164:167], v[96:99]
ds_read_b128 v[148:151], v25 offset:4096
v_mfma_f32_16x16x32_bf16 v[124:127], v[212:215], v[164:167], v[124:127]
v_mfma_f32_16x16x32_bf16 v[128:131], v[216:219], v[164:167], v[128:131]
ds_read_b64_tr_b16 v[190:191], v34 offset:20736
v_mfma_f32_16x16x32_bf16 v[68:71], v[196:199], v[168:171], v[68:71]
ds_read_b64_tr_b16 v[192:193], v34 offset:22528
v_mfma_f32_16x16x32_bf16 v[72:75], v[200:203], v[168:171], v[72:75]
ds_read_b64_tr_b16 v[194:195], v34 offset:22784
v_mfma_f32_16x16x32_bf16 v[100:103], v[204:207], v[168:171], v[100:103]
ds_read_b128 v[152:155], v25 offset:6144
v_mfma_f32_16x16x32_bf16 v[104:107], v[208:211], v[168:171], v[104:107]
v_mfma_f32_16x16x32_bf16 v[132:135], v[212:215], v[168:171], v[132:135]
v_mfma_f32_16x16x32_bf16 v[136:139], v[216:219], v[168:171], v[136:139]
s_waitcnt vmcnt(6) lgkmcnt(0)
s_barrier
v_mfma_f32_16x16x32_bf16 v[44:47], v[172:175], v[140:143], v[44:47]
ds_read_b64_tr_b16 v[196:197], v26 offset:24576
v_mfma_f32_16x16x32_bf16 v[48:51], v[176:179], v[140:143], v[48:51]
ds_read_b64_tr_b16 v[198:199], v26 offset:25088
v_mfma_f32_16x16x32_bf16 v[76:79], v[180:183], v[140:143], v[76:79]
ds_read_b64_tr_b16 v[200:201], v26 offset:28672
v_mfma_f32_16x16x32_bf16 v[80:83], v[184:187], v[140:143], v[80:83]
ds_read_b128 v[156:159], v24 offset:0
v_mfma_f32_16x16x32_bf16 v[108:111], v[188:191], v[140:143], v[108:111]
s_add_u32 m0, s43, 12288
s_sub_u32 s46, 917504, s21
buffer_load_dwordx4 v27, s[12:15], s46 offen lds
v_mfma_f32_16x16x32_bf16 v[112:115], v[192:195], v[140:143], v[112:115]
ds_read_b64_tr_b16 v[202:203], v26 offset:29184
v_mfma_f32_16x16x32_bf16 v[52:55], v[172:175], v[144:147], v[52:55]
ds_read_b64_tr_b16 v[204:205], v33 offset:24576
v_mfma_f32_16x16x32_bf16 v[56:59], v[176:179], v[144:147], v[56:59]
ds_read_b64_tr_b16 v[206:207], v33 offset:25088
v_mfma_f32_16x16x32_bf16 v[84:87], v[180:183], v[144:147], v[84:87]
s_add_u32 m0, s43, 16384
s_sub_u32 s46, 917504, s21
buffer_load_dwordx4 v27, s[16:19], s46 offen lds
v_mfma_f32_16x16x32_bf16 v[88:91], v[184:187], v[144:147], v[88:91]
ds_read_b128 v[160:163], v24 offset:2048
v_mfma_f32_16x16x32_bf16 v[116:119], v[188:191], v[144:147], v[116:119]
ds_read_b64_tr_b16 v[208:209], v33 offset:28672
v_mfma_f32_16x16x32_bf16 v[120:123], v[192:195], v[144:147], v[120:123]
ds_read_b64_tr_b16 v[210:211], v33 offset:29184
v_mfma_f32_16x16x32_bf16 v[60:63], v[172:175], v[148:151], v[60:63]
s_add_u32 m0, s43, 20480
s_sub_u32 s46, 917504, s21
buffer_load_dwordx4 v30, s[8:11], s46 offen lds
v_mfma_f32_16x16x32_bf16 v[64:67], v[176:179], v[148:151], v[64:67]
ds_read_b64_tr_b16 v[212:213], v34 offset:32768
v_mfma_f32_16x16x32_bf16 v[92:95], v[180:183], v[148:151], v[92:95]
ds_read_b128 v[164:167], v24 offset:4096
v_mfma_f32_16x16x32_bf16 v[96:99], v[184:187], v[148:151], v[96:99]
ds_read_b64_tr_b16 v[214:215], v34 offset:33024
v_mfma_f32_16x16x32_bf16 v[124:127], v[188:191], v[148:151], v[124:127]
s_add_u32 m0, s44, 55296
s_add_u32 s46, s22, 384
buffer_load_dwordx4 v28, s[4:7], s46 offen lds
v_mfma_f32_16x16x32_bf16 v[128:131], v[192:195], v[148:151], v[128:131]
ds_read_b64_tr_b16 v[216:217], v34 offset:34816
v_mfma_f32_16x16x32_bf16 v[68:71], v[172:175], v[152:155], v[68:71]
ds_read_b64_tr_b16 v[218:219], v34 offset:35072
v_mfma_f32_16x16x32_bf16 v[72:75], v[176:179], v[152:155], v[72:75]
ds_read_b128 v[168:171], v24 offset:6144
v_mfma_f32_16x16x32_bf16 v[100:103], v[180:183], v[152:155], v[100:103]
s_add_u32 m0, s44, 56320
s_add_u32 s46, s22, 384
buffer_load_dwordx4 v29, s[4:7], s46 offen lds
v_mfma_f32_16x16x32_bf16 v[104:107], v[184:187], v[152:155], v[104:107]
v_mfma_f32_16x16x32_bf16 v[132:135], v[188:191], v[152:155], v[132:135]
v_mfma_f32_16x16x32_bf16 v[136:139], v[192:195], v[152:155], v[136:139]
s_waitcnt lgkmcnt(0)
v_mfma_f32_16x16x32_bf16 v[44:47], v[196:199], v[156:159], v[44:47]
v_mfma_f32_16x16x32_bf16 v[48:51], v[200:203], v[156:159], v[48:51]
ds_read_b64_tr_b16 v[172:173], v26 offset:36864
v_mfma_f32_16x16x32_bf16 v[76:79], v[204:207], v[156:159], v[76:79]
ds_read_b64_tr_b16 v[174:175], v26 offset:37376
v_mfma_f32_16x16x32_bf16 v[80:83], v[208:211], v[156:159], v[80:83]
ds_read_b64_tr_b16 v[176:177], v26 offset:40960
v_mfma_f32_16x16x32_bf16 v[108:111], v[212:215], v[156:159], v[108:111]
ds_read_b128 v[140:143], v23 offset:18432
v_mfma_f32_16x16x32_bf16 v[112:115], v[216:219], v[156:159], v[112:115]
ds_read_b64_tr_b16 v[178:179], v26 offset:41472
v_mfma_f32_16x16x32_bf16 v[52:55], v[196:199], v[160:163], v[52:55]
ds_read_b64_tr_b16 v[180:181], v33 offset:36864
v_mfma_f32_16x16x32_bf16 v[56:59], v[200:203], v[160:163], v[56:59]
v_mfma_f32_16x16x32_bf16 v[84:87], v[204:207], v[160:163], v[84:87]
ds_read_b64_tr_b16 v[182:183], v33 offset:37376
v_mfma_f32_16x16x32_bf16 v[88:91], v[208:211], v[160:163], v[88:91]
ds_read_b128 v[144:147], v23 offset:20480
v_mfma_f32_16x16x32_bf16 v[116:119], v[212:215], v[160:163], v[116:119]
s_add_u32 m0, s44, 57344
s_add_u32 s46, s22, 16768
buffer_load_dwordx4 v28, s[4:7], s46 offen lds
v_mfma_f32_16x16x32_bf16 v[120:123], v[216:219], v[160:163], v[120:123]
ds_read_b64_tr_b16 v[184:185], v33 offset:40960
v_mfma_f32_16x16x32_bf16 v[60:63], v[196:199], v[164:167], v[60:63]
ds_read_b64_tr_b16 v[186:187], v33 offset:41472
v_mfma_f32_16x16x32_bf16 v[64:67], v[200:203], v[164:167], v[64:67]
ds_read_b64_tr_b16 v[188:189], v34 offset:45056
v_mfma_f32_16x16x32_bf16 v[92:95], v[204:207], v[164:167], v[92:95]
v_mfma_f32_16x16x32_bf16 v[96:99], v[208:211], v[164:167], v[96:99]
ds_read_b128 v[148:151], v23 offset:22528
v_mfma_f32_16x16x32_bf16 v[124:127], v[212:215], v[164:167], v[124:127]
ds_read_b64_tr_b16 v[190:191], v34 offset:45312
v_mfma_f32_16x16x32_bf16 v[128:131], v[216:219], v[164:167], v[128:131]
ds_read_b64_tr_b16 v[192:193], v34 offset:47104
v_mfma_f32_16x16x32_bf16 v[68:71], v[196:199], v[168:171], v[68:71]
ds_read_b64_tr_b16 v[194:195], v34 offset:47360
v_mfma_f32_16x16x32_bf16 v[72:75], v[200:203], v[168:171], v[72:75]
ds_read_b128 v[152:155], v23 offset:24576
v_mfma_f32_16x16x32_bf16 v[100:103], v[204:207], v[168:171], v[100:103]
s_add_u32 m0, s44, 58368
s_add_u32 s46, s22, 16768
buffer_load_dwordx4 v29, s[4:7], s46 offen lds
v_mfma_f32_16x16x32_bf16 v[104:107], v[208:211], v[168:171], v[104:107]
v_mfma_f32_16x16x32_bf16 v[132:135], v[212:215], v[168:171], v[132:135]
v_mfma_f32_16x16x32_bf16 v[136:139], v[216:219], v[168:171], v[136:139]
s_waitcnt vmcnt(7) lgkmcnt(0)
s_barrier
v_mfma_f32_16x16x32_bf16 v[44:47], v[172:175], v[140:143], v[44:47]
ds_read_b64_tr_b16 v[196:197], v26 offset:0
v_mfma_f32_16x16x32_bf16 v[48:51], v[176:179], v[140:143], v[48:51]
ds_read_b64_tr_b16 v[198:199], v26 offset:512
v_mfma_f32_16x16x32_bf16 v[76:79], v[180:183], v[140:143], v[76:79]
ds_read_b64_tr_b16 v[200:201], v26 offset:4096
v_mfma_f32_16x16x32_bf16 v[80:83], v[184:187], v[140:143], v[80:83]
ds_read_b128 v[156:159], v22 offset:18432
v_mfma_f32_16x16x32_bf16 v[108:111], v[188:191], v[140:143], v[108:111]
s_add_u32 m0, s43, 24576
s_add_u32 s46, s21, 802816
buffer_load_dwordx4 v27, s[12:15], s46 offen lds
v_mfma_f32_16x16x32_bf16 v[112:115], v[192:195], v[140:143], v[112:115]
ds_read_b64_tr_b16 v[202:203], v26 offset:4608
v_mfma_f32_16x16x32_bf16 v[52:55], v[172:175], v[144:147], v[52:55]
ds_read_b64_tr_b16 v[204:205], v33 offset:0
v_mfma_f32_16x16x32_bf16 v[56:59], v[176:179], v[144:147], v[56:59]
ds_read_b64_tr_b16 v[206:207], v33 offset:512
v_mfma_f32_16x16x32_bf16 v[84:87], v[180:183], v[144:147], v[84:87]
s_add_u32 m0, s43, 28672
s_add_u32 s46, s21, 802816
buffer_load_dwordx4 v27, s[16:19], s46 offen lds
v_mfma_f32_16x16x32_bf16 v[88:91], v[184:187], v[144:147], v[88:91]
ds_read_b128 v[160:163], v22 offset:20480
v_mfma_f32_16x16x32_bf16 v[116:119], v[188:191], v[144:147], v[116:119]
ds_read_b64_tr_b16 v[208:209], v33 offset:4096
v_mfma_f32_16x16x32_bf16 v[120:123], v[192:195], v[144:147], v[120:123]
ds_read_b64_tr_b16 v[210:211], v33 offset:4608
v_mfma_f32_16x16x32_bf16 v[60:63], v[172:175], v[148:151], v[60:63]
s_add_u32 m0, s43, 32768
s_add_u32 s46, s21, 802816
buffer_load_dwordx4 v30, s[8:11], s46 offen lds
v_mfma_f32_16x16x32_bf16 v[64:67], v[176:179], v[148:151], v[64:67]
ds_read_b64_tr_b16 v[212:213], v34 offset:8192
v_mfma_f32_16x16x32_bf16 v[92:95], v[180:183], v[148:151], v[92:95]
ds_read_b128 v[164:167], v22 offset:22528
v_mfma_f32_16x16x32_bf16 v[96:99], v[184:187], v[148:151], v[96:99]
ds_read_b64_tr_b16 v[214:215], v34 offset:8448
v_mfma_f32_16x16x32_bf16 v[124:127], v[188:191], v[148:151], v[124:127]
s_add_u32 m0, s44, 36864
s_add_u32 s46, s22, 256
buffer_load_dwordx4 v28, s[4:7], s46 offen lds
v_mfma_f32_16x16x32_bf16 v[128:131], v[192:195], v[148:151], v[128:131]
ds_read_b64_tr_b16 v[216:217], v34 offset:10240
v_mfma_f32_16x16x32_bf16 v[68:71], v[172:175], v[152:155], v[68:71]
ds_read_b64_tr_b16 v[218:219], v34 offset:10496
v_mfma_f32_16x16x32_bf16 v[72:75], v[176:179], v[152:155], v[72:75]
ds_read_b128 v[168:171], v22 offset:24576
v_mfma_f32_16x16x32_bf16 v[100:103], v[180:183], v[152:155], v[100:103]
s_add_u32 m0, s44, 37888
s_add_u32 s46, s22, 256
buffer_load_dwordx4 v29, s[4:7], s46 offen lds
v_mfma_f32_16x16x32_bf16 v[104:107], v[184:187], v[152:155], v[104:107]
v_mfma_f32_16x16x32_bf16 v[132:135], v[188:191], v[152:155], v[132:135]
v_mfma_f32_16x16x32_bf16 v[136:139], v[192:195], v[152:155], v[136:139]
s_waitcnt lgkmcnt(0)
v_mfma_f32_16x16x32_bf16 v[44:47], v[196:199], v[156:159], v[44:47]
ds_read_b64_tr_b16 v[172:173], v26 offset:49152
v_mfma_f32_16x16x32_bf16 v[48:51], v[200:203], v[156:159], v[48:51]
ds_read_b64_tr_b16 v[174:175], v26 offset:49664
v_mfma_f32_16x16x32_bf16 v[76:79], v[204:207], v[156:159], v[76:79]
ds_read_b64_tr_b16 v[176:177], v26 offset:53248
v_mfma_f32_16x16x32_bf16 v[80:83], v[208:211], v[156:159], v[80:83]
ds_read_b128 v[140:143], v23 offset:0
v_mfma_f32_16x16x32_bf16 v[108:111], v[212:215], v[156:159], v[108:111]
s_add_u32 m0, s43, 36864
s_add_u32 s46, s21, 688128
buffer_load_dwordx4 v27, s[12:15], s46 offen lds
v_mfma_f32_16x16x32_bf16 v[112:115], v[216:219], v[156:159], v[112:115]
ds_read_b64_tr_b16 v[178:179], v26 offset:53760
v_mfma_f32_16x16x32_bf16 v[52:55], v[196:199], v[160:163], v[52:55]
ds_read_b64_tr_b16 v[180:181], v33 offset:49152
v_mfma_f32_16x16x32_bf16 v[56:59], v[200:203], v[160:163], v[56:59]
ds_read_b64_tr_b16 v[182:183], v33 offset:49664
v_mfma_f32_16x16x32_bf16 v[84:87], v[204:207], v[160:163], v[84:87]
s_add_u32 m0, s43, 40960
s_add_u32 s46, s21, 688128
buffer_load_dwordx4 v27, s[16:19], s46 offen lds
v_mfma_f32_16x16x32_bf16 v[88:91], v[208:211], v[160:163], v[88:91]
ds_read_b128 v[144:147], v23 offset:2048
v_mfma_f32_16x16x32_bf16 v[116:119], v[212:215], v[160:163], v[116:119]
ds_read_b64_tr_b16 v[184:185], v33 offset:53248
v_mfma_f32_16x16x32_bf16 v[120:123], v[216:219], v[160:163], v[120:123]
ds_read_b64_tr_b16 v[186:187], v33 offset:53760
v_mfma_f32_16x16x32_bf16 v[60:63], v[196:199], v[164:167], v[60:63]
s_add_u32 m0, s43, 45056
s_add_u32 s46, s21, 688128
buffer_load_dwordx4 v30, s[8:11], s46 offen lds
v_mfma_f32_16x16x32_bf16 v[64:67], v[200:203], v[164:167], v[64:67]
ds_read_b64_tr_b16 v[188:189], v34 offset:57344
v_mfma_f32_16x16x32_bf16 v[92:95], v[204:207], v[164:167], v[92:95]
ds_read_b128 v[148:151], v23 offset:4096
v_mfma_f32_16x16x32_bf16 v[96:99], v[208:211], v[164:167], v[96:99]
ds_read_b64_tr_b16 v[190:191], v34 offset:57600
v_mfma_f32_16x16x32_bf16 v[124:127], v[212:215], v[164:167], v[124:127]
s_add_u32 m0, s44, 38912
s_add_u32 s46, s22, 16640
buffer_load_dwordx4 v28, s[4:7], s46 offen lds
v_mfma_f32_16x16x32_bf16 v[128:131], v[216:219], v[164:167], v[128:131]
ds_read_b64_tr_b16 v[192:193], v34 offset:59392
v_mfma_f32_16x16x32_bf16 v[68:71], v[196:199], v[168:171], v[68:71]
ds_read_b64_tr_b16 v[194:195], v34 offset:59648
v_mfma_f32_16x16x32_bf16 v[72:75], v[200:203], v[168:171], v[72:75]
ds_read_b128 v[152:155], v23 offset:6144
v_mfma_f32_16x16x32_bf16 v[100:103], v[204:207], v[168:171], v[100:103]
s_add_u32 m0, s44, 39936
s_add_u32 s46, s22, 16640
buffer_load_dwordx4 v29, s[4:7], s46 offen lds
v_mfma_f32_16x16x32_bf16 v[104:107], v[208:211], v[168:171], v[104:107]
v_mfma_f32_16x16x32_bf16 v[132:135], v[212:215], v[168:171], v[132:135]
v_mfma_f32_16x16x32_bf16 v[136:139], v[216:219], v[168:171], v[136:139]
s_waitcnt vmcnt(7) lgkmcnt(0)
s_barrier
v_mfma_f32_16x16x32_bf16 v[44:47], v[172:175], v[140:143], v[44:47]
ds_read_b64_tr_b16 v[196:197], v26 offset:12288
v_mfma_f32_16x16x32_bf16 v[48:51], v[176:179], v[140:143], v[48:51]
ds_read_b64_tr_b16 v[198:199], v26 offset:12800
v_mfma_f32_16x16x32_bf16 v[76:79], v[180:183], v[140:143], v[76:79]
ds_read_b64_tr_b16 v[200:201], v26 offset:16384
v_mfma_f32_16x16x32_bf16 v[80:83], v[184:187], v[140:143], v[80:83]
ds_read_b128 v[156:159], v22 offset:0
v_mfma_f32_16x16x32_bf16 v[108:111], v[188:191], v[140:143], v[108:111]
s_add_u32 m0, s43, 0
s_add_u32 s46, s21, 573440
buffer_load_dwordx4 v27, s[12:15], s46 offen lds
v_mfma_f32_16x16x32_bf16 v[112:115], v[192:195], v[140:143], v[112:115]
ds_read_b64_tr_b16 v[202:203], v26 offset:16896
v_mfma_f32_16x16x32_bf16 v[52:55], v[172:175], v[144:147], v[52:55]
ds_read_b64_tr_b16 v[204:205], v33 offset:12288
v_mfma_f32_16x16x32_bf16 v[56:59], v[176:179], v[144:147], v[56:59]
ds_read_b64_tr_b16 v[206:207], v33 offset:12800
v_mfma_f32_16x16x32_bf16 v[84:87], v[180:183], v[144:147], v[84:87]
s_add_u32 m0, s43, 4096
s_add_u32 s46, s21, 573440
buffer_load_dwordx4 v27, s[16:19], s46 offen lds
v_mfma_f32_16x16x32_bf16 v[88:91], v[184:187], v[144:147], v[88:91]
ds_read_b128 v[160:163], v22 offset:2048
v_mfma_f32_16x16x32_bf16 v[116:119], v[188:191], v[144:147], v[116:119]
ds_read_b64_tr_b16 v[208:209], v33 offset:16384
v_mfma_f32_16x16x32_bf16 v[120:123], v[192:195], v[144:147], v[120:123]
ds_read_b64_tr_b16 v[210:211], v33 offset:16896
v_mfma_f32_16x16x32_bf16 v[60:63], v[172:175], v[148:151], v[60:63]
s_add_u32 m0, s43, 8192
s_add_u32 s46, s21, 573440
buffer_load_dwordx4 v30, s[8:11], s46 offen lds
v_mfma_f32_16x16x32_bf16 v[64:67], v[176:179], v[148:151], v[64:67]
ds_read_b64_tr_b16 v[212:213], v34 offset:20480
v_mfma_f32_16x16x32_bf16 v[92:95], v[180:183], v[148:151], v[92:95]
ds_read_b128 v[164:167], v22 offset:4096
v_mfma_f32_16x16x32_bf16 v[96:99], v[184:187], v[148:151], v[96:99]
ds_read_b64_tr_b16 v[214:215], v34 offset:20736
v_mfma_f32_16x16x32_bf16 v[124:127], v[188:191], v[148:151], v[124:127]
s_add_u32 m0, s44, 18432
s_add_u32 s46, s22, 128
buffer_load_dwordx4 v28, s[4:7], s46 offen lds
v_mfma_f32_16x16x32_bf16 v[128:131], v[192:195], v[148:151], v[128:131]
ds_read_b64_tr_b16 v[216:217], v34 offset:22528
v_mfma_f32_16x16x32_bf16 v[68:71], v[172:175], v[152:155], v[68:71]
ds_read_b64_tr_b16 v[218:219], v34 offset:22784
v_mfma_f32_16x16x32_bf16 v[72:75], v[176:179], v[152:155], v[72:75]
ds_read_b128 v[168:171], v22 offset:6144
v_mfma_f32_16x16x32_bf16 v[100:103], v[180:183], v[152:155], v[100:103]
s_add_u32 m0, s44, 19456
s_add_u32 s46, s22, 128
buffer_load_dwordx4 v29, s[4:7], s46 offen lds
v_mfma_f32_16x16x32_bf16 v[104:107], v[184:187], v[152:155], v[104:107]
v_mfma_f32_16x16x32_bf16 v[132:135], v[188:191], v[152:155], v[132:135]
v_mfma_f32_16x16x32_bf16 v[136:139], v[192:195], v[152:155], v[136:139]
s_waitcnt lgkmcnt(0)
v_mfma_f32_16x16x32_bf16 v[44:47], v[196:199], v[156:159], v[44:47]
ds_read_b64_tr_b16 v[172:173], v26 offset:24576
v_mfma_f32_16x16x32_bf16 v[48:51], v[200:203], v[156:159], v[48:51]
ds_read_b64_tr_b16 v[174:175], v26 offset:25088
v_mfma_f32_16x16x32_bf16 v[76:79], v[204:207], v[156:159], v[76:79]
ds_read_b64_tr_b16 v[176:177], v26 offset:28672
v_mfma_f32_16x16x32_bf16 v[80:83], v[208:211], v[156:159], v[80:83]
ds_read_b128 v[140:143], v25 offset:18432
v_mfma_f32_16x16x32_bf16 v[108:111], v[212:215], v[156:159], v[108:111]
s_add_u32 m0, s43, 49152
s_add_u32 s46, s21, 458752
buffer_load_dwordx4 v27, s[12:15], s46 offen lds
v_mfma_f32_16x16x32_bf16 v[112:115], v[216:219], v[156:159], v[112:115]
ds_read_b64_tr_b16 v[178:179], v26 offset:29184
v_mfma_f32_16x16x32_bf16 v[52:55], v[196:199], v[160:163], v[52:55]
ds_read_b64_tr_b16 v[180:181], v33 offset:24576
v_mfma_f32_16x16x32_bf16 v[56:59], v[200:203], v[160:163], v[56:59]
ds_read_b64_tr_b16 v[182:183], v33 offset:25088
v_mfma_f32_16x16x32_bf16 v[84:87], v[204:207], v[160:163], v[84:87]
s_add_u32 m0, s43, 53248
s_add_u32 s46, s21, 458752
buffer_load_dwordx4 v27, s[16:19], s46 offen lds
v_mfma_f32_16x16x32_bf16 v[88:91], v[208:211], v[160:163], v[88:91]
ds_read_b128 v[144:147], v25 offset:20480
v_mfma_f32_16x16x32_bf16 v[116:119], v[212:215], v[160:163], v[116:119]
ds_read_b64_tr_b16 v[184:185], v33 offset:28672
v_mfma_f32_16x16x32_bf16 v[120:123], v[216:219], v[160:163], v[120:123]
ds_read_b64_tr_b16 v[186:187], v33 offset:29184
v_mfma_f32_16x16x32_bf16 v[60:63], v[196:199], v[164:167], v[60:63]
s_add_u32 m0, s43, 57344
s_add_u32 s46, s21, 458752
buffer_load_dwordx4 v30, s[8:11], s46 offen lds
v_mfma_f32_16x16x32_bf16 v[64:67], v[200:203], v[164:167], v[64:67]
ds_read_b64_tr_b16 v[188:189], v34 offset:32768
v_mfma_f32_16x16x32_bf16 v[92:95], v[204:207], v[164:167], v[92:95]
ds_read_b128 v[148:151], v25 offset:22528
v_mfma_f32_16x16x32_bf16 v[96:99], v[208:211], v[164:167], v[96:99]
ds_read_b64_tr_b16 v[190:191], v34 offset:33024
v_mfma_f32_16x16x32_bf16 v[124:127], v[212:215], v[164:167], v[124:127]
s_add_u32 m0, s44, 20480
s_add_u32 s46, s22, 16512
buffer_load_dwordx4 v28, s[4:7], s46 offen lds
v_mfma_f32_16x16x32_bf16 v[128:131], v[216:219], v[164:167], v[128:131]
ds_read_b64_tr_b16 v[192:193], v34 offset:34816
v_mfma_f32_16x16x32_bf16 v[68:71], v[196:199], v[168:171], v[68:71]
ds_read_b64_tr_b16 v[194:195], v34 offset:35072
v_mfma_f32_16x16x32_bf16 v[72:75], v[200:203], v[168:171], v[72:75]
ds_read_b128 v[152:155], v25 offset:24576
v_mfma_f32_16x16x32_bf16 v[100:103], v[204:207], v[168:171], v[100:103]
s_add_u32 m0, s44, 21504
s_add_u32 s46, s22, 16512
buffer_load_dwordx4 v29, s[4:7], s46 offen lds
v_mfma_f32_16x16x32_bf16 v[104:107], v[208:211], v[168:171], v[104:107]
v_mfma_f32_16x16x32_bf16 v[132:135], v[212:215], v[168:171], v[132:135]
v_mfma_f32_16x16x32_bf16 v[136:139], v[216:219], v[168:171], v[136:139]
s_waitcnt vmcnt(7) lgkmcnt(0)
s_barrier
v_mfma_f32_16x16x32_bf16 v[44:47], v[172:175], v[140:143], v[44:47]
ds_read_b64_tr_b16 v[196:197], v26 offset:36864
v_mfma_f32_16x16x32_bf16 v[48:51], v[176:179], v[140:143], v[48:51]
ds_read_b64_tr_b16 v[198:199], v26 offset:37376
v_mfma_f32_16x16x32_bf16 v[76:79], v[180:183], v[140:143], v[76:79]
ds_read_b64_tr_b16 v[200:201], v26 offset:40960
v_mfma_f32_16x16x32_bf16 v[80:83], v[184:187], v[140:143], v[80:83]
ds_read_b128 v[156:159], v24 offset:18432
v_mfma_f32_16x16x32_bf16 v[108:111], v[188:191], v[140:143], v[108:111]
s_add_u32 m0, s43, 12288
s_add_u32 s46, s21, 344064
buffer_load_dwordx4 v27, s[12:15], s46 offen lds
v_mfma_f32_16x16x32_bf16 v[112:115], v[192:195], v[140:143], v[112:115]
ds_read_b64_tr_b16 v[202:203], v26 offset:41472
v_mfma_f32_16x16x32_bf16 v[52:55], v[172:175], v[144:147], v[52:55]
ds_read_b64_tr_b16 v[204:205], v33 offset:36864
v_mfma_f32_16x16x32_bf16 v[56:59], v[176:179], v[144:147], v[56:59]
ds_read_b64_tr_b16 v[206:207], v33 offset:37376
v_mfma_f32_16x16x32_bf16 v[84:87], v[180:183], v[144:147], v[84:87]
s_add_u32 m0, s43, 16384
s_add_u32 s46, s21, 344064
buffer_load_dwordx4 v27, s[16:19], s46 offen lds
v_mfma_f32_16x16x32_bf16 v[88:91], v[184:187], v[144:147], v[88:91]
ds_read_b128 v[160:163], v24 offset:20480
v_mfma_f32_16x16x32_bf16 v[116:119], v[188:191], v[144:147], v[116:119]
ds_read_b64_tr_b16 v[208:209], v33 offset:40960
v_mfma_f32_16x16x32_bf16 v[120:123], v[192:195], v[144:147], v[120:123]
ds_read_b64_tr_b16 v[210:211], v33 offset:41472
v_mfma_f32_16x16x32_bf16 v[60:63], v[172:175], v[148:151], v[60:63]
s_add_u32 m0, s43, 20480
s_add_u32 s46, s21, 344064
buffer_load_dwordx4 v30, s[8:11], s46 offen lds
v_mfma_f32_16x16x32_bf16 v[64:67], v[176:179], v[148:151], v[64:67]
ds_read_b64_tr_b16 v[212:213], v34 offset:45056
v_mfma_f32_16x16x32_bf16 v[92:95], v[180:183], v[148:151], v[92:95]
ds_read_b128 v[164:167], v24 offset:22528
v_mfma_f32_16x16x32_bf16 v[96:99], v[184:187], v[148:151], v[96:99]
ds_read_b64_tr_b16 v[214:215], v34 offset:45312
v_mfma_f32_16x16x32_bf16 v[124:127], v[188:191], v[148:151], v[124:127]
s_add_u32 m0, s44, 0
s_add_u32 s46, s22, 0
buffer_load_dwordx4 v28, s[4:7], s46 offen lds
v_mfma_f32_16x16x32_bf16 v[128:131], v[192:195], v[148:151], v[128:131]
ds_read_b64_tr_b16 v[216:217], v34 offset:47104
v_mfma_f32_16x16x32_bf16 v[68:71], v[172:175], v[152:155], v[68:71]
ds_read_b64_tr_b16 v[218:219], v34 offset:47360
v_mfma_f32_16x16x32_bf16 v[72:75], v[176:179], v[152:155], v[72:75]
ds_read_b128 v[168:171], v24 offset:24576
v_mfma_f32_16x16x32_bf16 v[100:103], v[180:183], v[152:155], v[100:103]
s_add_u32 m0, s44, 1024
s_add_u32 s46, s22, 0
buffer_load_dwordx4 v29, s[4:7], s46 offen lds
v_mfma_f32_16x16x32_bf16 v[104:107], v[184:187], v[152:155], v[104:107]
v_mfma_f32_16x16x32_bf16 v[132:135], v[188:191], v[152:155], v[132:135]
v_mfma_f32_16x16x32_bf16 v[136:139], v[192:195], v[152:155], v[136:139]
s_waitcnt lgkmcnt(0)
v_mfma_f32_16x16x32_bf16 v[44:47], v[196:199], v[156:159], v[44:47]
ds_read_b64_tr_b16 v[172:173], v26 offset:0
v_mfma_f32_16x16x32_bf16 v[48:51], v[200:203], v[156:159], v[48:51]
ds_read_b64_tr_b16 v[174:175], v26 offset:512
v_mfma_f32_16x16x32_bf16 v[76:79], v[204:207], v[156:159], v[76:79]
ds_read_b64_tr_b16 v[176:177], v26 offset:4096
v_mfma_f32_16x16x32_bf16 v[80:83], v[208:211], v[156:159], v[80:83]
ds_read_b128 v[140:143], v25 offset:0
v_mfma_f32_16x16x32_bf16 v[108:111], v[212:215], v[156:159], v[108:111]
s_add_u32 m0, s43, 24576
s_add_u32 s46, s21, 229376
buffer_load_dwordx4 v27, s[12:15], s46 offen lds
v_mfma_f32_16x16x32_bf16 v[112:115], v[216:219], v[156:159], v[112:115]
ds_read_b64_tr_b16 v[178:179], v26 offset:4608
v_mfma_f32_16x16x32_bf16 v[52:55], v[196:199], v[160:163], v[52:55]
ds_read_b64_tr_b16 v[180:181], v33 offset:0
v_mfma_f32_16x16x32_bf16 v[56:59], v[200:203], v[160:163], v[56:59]
ds_read_b64_tr_b16 v[182:183], v33 offset:512
v_mfma_f32_16x16x32_bf16 v[84:87], v[204:207], v[160:163], v[84:87]
s_add_u32 m0, s43, 28672
s_add_u32 s46, s21, 229376
buffer_load_dwordx4 v27, s[16:19], s46 offen lds
v_mfma_f32_16x16x32_bf16 v[88:91], v[208:211], v[160:163], v[88:91]
ds_read_b128 v[144:147], v25 offset:2048
v_mfma_f32_16x16x32_bf16 v[116:119], v[212:215], v[160:163], v[116:119]
ds_read_b64_tr_b16 v[184:185], v33 offset:4096
v_mfma_f32_16x16x32_bf16 v[120:123], v[216:219], v[160:163], v[120:123]
ds_read_b64_tr_b16 v[186:187], v33 offset:4608
v_mfma_f32_16x16x32_bf16 v[60:63], v[196:199], v[164:167], v[60:63]
s_add_u32 m0, s43, 32768
s_add_u32 s46, s21, 229376
buffer_load_dwordx4 v30, s[8:11], s46 offen lds
v_mfma_f32_16x16x32_bf16 v[64:67], v[200:203], v[164:167], v[64:67]
ds_read_b64_tr_b16 v[188:189], v34 offset:8192
v_mfma_f32_16x16x32_bf16 v[92:95], v[204:207], v[164:167], v[92:95]
ds_read_b128 v[148:151], v25 offset:4096
v_mfma_f32_16x16x32_bf16 v[96:99], v[208:211], v[164:167], v[96:99]
ds_read_b64_tr_b16 v[190:191], v34 offset:8448
v_mfma_f32_16x16x32_bf16 v[124:127], v[212:215], v[164:167], v[124:127]
s_add_u32 m0, s44, 2048
s_add_u32 s46, s22, 16384
buffer_load_dwordx4 v28, s[4:7], s46 offen lds
v_mfma_f32_16x16x32_bf16 v[128:131], v[216:219], v[164:167], v[128:131]
ds_read_b64_tr_b16 v[192:193], v34 offset:10240
v_mfma_f32_16x16x32_bf16 v[68:71], v[196:199], v[168:171], v[68:71]
ds_read_b64_tr_b16 v[194:195], v34 offset:10496
v_mfma_f32_16x16x32_bf16 v[72:75], v[200:203], v[168:171], v[72:75]
ds_read_b128 v[152:155], v25 offset:6144
v_mfma_f32_16x16x32_bf16 v[100:103], v[204:207], v[168:171], v[100:103]
s_add_u32 m0, s44, 3072
s_add_u32 s46, s22, 16384
buffer_load_dwordx4 v29, s[4:7], s46 offen lds
v_mfma_f32_16x16x32_bf16 v[104:107], v[208:211], v[168:171], v[104:107]
v_mfma_f32_16x16x32_bf16 v[132:135], v[212:215], v[168:171], v[132:135]
v_mfma_f32_16x16x32_bf16 v[136:139], v[216:219], v[168:171], v[136:139]
s_waitcnt vmcnt(7) lgkmcnt(0)
s_barrier
v_mfma_f32_16x16x32_bf16 v[44:47], v[172:175], v[140:143], v[44:47]
v_mfma_f32_16x16x32_bf16 v[48:51], v[176:179], v[140:143], v[48:51]
ds_read_b64_tr_b16 v[196:197], v26 offset:49152
v_mfma_f32_16x16x32_bf16 v[76:79], v[180:183], v[140:143], v[76:79]
ds_read_b64_tr_b16 v[198:199], v26 offset:49664
v_mfma_f32_16x16x32_bf16 v[80:83], v[184:187], v[140:143], v[80:83]
ds_read_b64_tr_b16 v[200:201], v26 offset:53248
v_mfma_f32_16x16x32_bf16 v[108:111], v[188:191], v[140:143], v[108:111]
ds_read_b128 v[156:159], v24 offset:0
v_mfma_f32_16x16x32_bf16 v[112:115], v[192:195], v[140:143], v[112:115]
ds_read_b64_tr_b16 v[202:203], v26 offset:53760
v_mfma_f32_16x16x32_bf16 v[52:55], v[172:175], v[144:147], v[52:55]
ds_read_b64_tr_b16 v[204:205], v33 offset:49152
v_mfma_f32_16x16x32_bf16 v[56:59], v[176:179], v[144:147], v[56:59]
s_add_u32 m0, s43, 36864
s_add_u32 s46, s21, 114688
buffer_load_dwordx4 v27, s[12:15], s46 offen lds
v_mfma_f32_16x16x32_bf16 v[84:87], v[180:183], v[144:147], v[84:87]
ds_read_b64_tr_b16 v[206:207], v33 offset:49664
v_mfma_f32_16x16x32_bf16 v[88:91], v[184:187], v[144:147], v[88:91]
ds_read_b128 v[160:163], v24 offset:2048
v_mfma_f32_16x16x32_bf16 v[116:119], v[188:191], v[144:147], v[116:119]
v_mfma_f32_16x16x32_bf16 v[120:123], v[192:195], v[144:147], v[120:123]
ds_read_b64_tr_b16 v[208:209], v33 offset:53248
v_mfma_f32_16x16x32_bf16 v[60:63], v[172:175], v[148:151], v[60:63]
ds_read_b64_tr_b16 v[210:211], v33 offset:53760
v_mfma_f32_16x16x32_bf16 v[64:67], v[176:179], v[148:151], v[64:67]
ds_read_b64_tr_b16 v[212:213], v34 offset:57344
v_mfma_f32_16x16x32_bf16 v[92:95], v[180:183], v[148:151], v[92:95]
s_add_u32 m0, s43, 40960
s_add_u32 s46, s21, 114688
buffer_load_dwordx4 v27, s[16:19], s46 offen lds
v_mfma_f32_16x16x32_bf16 v[96:99], v[184:187], v[148:151], v[96:99]
ds_read_b128 v[164:167], v24 offset:4096
v_mfma_f32_16x16x32_bf16 v[124:127], v[188:191], v[148:151], v[124:127]
ds_read_b64_tr_b16 v[214:215], v34 offset:57600
v_mfma_f32_16x16x32_bf16 v[128:131], v[192:195], v[148:151], v[128:131]
ds_read_b64_tr_b16 v[216:217], v34 offset:59392
v_mfma_f32_16x16x32_bf16 v[68:71], v[172:175], v[152:155], v[68:71]
ds_read_b64_tr_b16 v[218:219], v34 offset:59648
v_mfma_f32_16x16x32_bf16 v[72:75], v[176:179], v[152:155], v[72:75]
ds_read_b128 v[168:171], v24 offset:6144
v_mfma_f32_16x16x32_bf16 v[100:103], v[180:183], v[152:155], v[100:103]
s_add_u32 m0, s43, 45056
s_add_u32 s46, s21, 114688
buffer_load_dwordx4 v30, s[8:11], s46 offen lds
v_mfma_f32_16x16x32_bf16 v[104:107], v[184:187], v[152:155], v[104:107]
v_mfma_f32_16x16x32_bf16 v[132:135], v[188:191], v[152:155], v[132:135]
v_mfma_f32_16x16x32_bf16 v[136:139], v[192:195], v[152:155], v[136:139]
s_waitcnt lgkmcnt(0)
v_mfma_f32_16x16x32_bf16 v[44:47], v[196:199], v[156:159], v[44:47]
v_mfma_f32_16x16x32_bf16 v[48:51], v[200:203], v[156:159], v[48:51]
ds_read_b64_tr_b16 v[172:173], v26 offset:12288
v_mfma_f32_16x16x32_bf16 v[76:79], v[204:207], v[156:159], v[76:79]
ds_read_b64_tr_b16 v[174:175], v26 offset:12800
v_mfma_f32_16x16x32_bf16 v[80:83], v[208:211], v[156:159], v[80:83]
ds_read_b64_tr_b16 v[176:177], v26 offset:16384
v_mfma_f32_16x16x32_bf16 v[108:111], v[212:215], v[156:159], v[108:111]
ds_read_b128 v[140:143], v23 offset:18432
v_mfma_f32_16x16x32_bf16 v[112:115], v[216:219], v[156:159], v[112:115]
ds_read_b64_tr_b16 v[178:179], v26 offset:16896
v_mfma_f32_16x16x32_bf16 v[52:55], v[196:199], v[160:163], v[52:55]
ds_read_b64_tr_b16 v[180:181], v33 offset:12288
v_mfma_f32_16x16x32_bf16 v[56:59], v[200:203], v[160:163], v[56:59]
s_add_u32 m0, s43, 0
s_add_u32 s46, s21, 0
buffer_load_dwordx4 v27, s[12:15], s46 offen lds
v_mfma_f32_16x16x32_bf16 v[84:87], v[204:207], v[160:163], v[84:87]
ds_read_b64_tr_b16 v[182:183], v33 offset:12800
v_mfma_f32_16x16x32_bf16 v[88:91], v[208:211], v[160:163], v[88:91]
ds_read_b128 v[144:147], v23 offset:20480
v_mfma_f32_16x16x32_bf16 v[116:119], v[212:215], v[160:163], v[116:119]
v_mfma_f32_16x16x32_bf16 v[120:123], v[216:219], v[160:163], v[120:123]
ds_read_b64_tr_b16 v[184:185], v33 offset:16384
v_mfma_f32_16x16x32_bf16 v[60:63], v[196:199], v[164:167], v[60:63]
ds_read_b64_tr_b16 v[186:187], v33 offset:16896
v_mfma_f32_16x16x32_bf16 v[64:67], v[200:203], v[164:167], v[64:67]
ds_read_b64_tr_b16 v[188:189], v34 offset:20480
v_mfma_f32_16x16x32_bf16 v[92:95], v[204:207], v[164:167], v[92:95]
s_add_u32 m0, s43, 4096
s_add_u32 s46, s21, 0
buffer_load_dwordx4 v27, s[16:19], s46 offen lds
v_mfma_f32_16x16x32_bf16 v[96:99], v[208:211], v[164:167], v[96:99]
ds_read_b128 v[148:151], v23 offset:22528
v_mfma_f32_16x16x32_bf16 v[124:127], v[212:215], v[164:167], v[124:127]
ds_read_b64_tr_b16 v[190:191], v34 offset:20736
v_mfma_f32_16x16x32_bf16 v[128:131], v[216:219], v[164:167], v[128:131]
ds_read_b64_tr_b16 v[192:193], v34 offset:22528
v_mfma_f32_16x16x32_bf16 v[68:71], v[196:199], v[168:171], v[68:71]
ds_read_b64_tr_b16 v[194:195], v34 offset:22784
v_mfma_f32_16x16x32_bf16 v[72:75], v[200:203], v[168:171], v[72:75]
ds_read_b128 v[152:155], v23 offset:24576
v_mfma_f32_16x16x32_bf16 v[100:103], v[204:207], v[168:171], v[100:103]
s_add_u32 m0, s43, 8192
s_add_u32 s46, s21, 0
buffer_load_dwordx4 v30, s[8:11], s46 offen lds
v_mfma_f32_16x16x32_bf16 v[104:107], v[208:211], v[168:171], v[104:107]
v_mfma_f32_16x16x32_bf16 v[132:135], v[212:215], v[168:171], v[132:135]
v_mfma_f32_16x16x32_bf16 v[136:139], v[216:219], v[168:171], v[136:139]
s_waitcnt vmcnt(3) lgkmcnt(0)
s_barrier
v_mfma_f32_16x16x32_bf16 v[44:47], v[172:175], v[140:143], v[44:47]
v_mfma_f32_16x16x32_bf16 v[48:51], v[176:179], v[140:143], v[48:51]
ds_read_b64_tr_b16 v[196:197], v26 offset:24576
v_mfma_f32_16x16x32_bf16 v[76:79], v[180:183], v[140:143], v[76:79]
ds_read_b64_tr_b16 v[198:199], v26 offset:25088
v_mfma_f32_16x16x32_bf16 v[80:83], v[184:187], v[140:143], v[80:83]
ds_read_b64_tr_b16 v[200:201], v26 offset:28672
v_mfma_f32_16x16x32_bf16 v[108:111], v[188:191], v[140:143], v[108:111]
v_mfma_f32_16x16x32_bf16 v[112:115], v[192:195], v[140:143], v[112:115]
ds_read_b128 v[156:159], v22 offset:18432
v_mfma_f32_16x16x32_bf16 v[52:55], v[172:175], v[144:147], v[52:55]
ds_read_b64_tr_b16 v[202:203], v26 offset:29184
v_mfma_f32_16x16x32_bf16 v[56:59], v[176:179], v[144:147], v[56:59]
ds_read_b64_tr_b16 v[204:205], v33 offset:24576
v_mfma_f32_16x16x32_bf16 v[84:87], v[180:183], v[144:147], v[84:87]
v_mfma_f32_16x16x32_bf16 v[88:91], v[184:187], v[144:147], v[88:91]
ds_read_b64_tr_b16 v[206:207], v33 offset:25088
v_mfma_f32_16x16x32_bf16 v[116:119], v[188:191], v[144:147], v[116:119]
ds_read_b128 v[160:163], v22 offset:20480
v_mfma_f32_16x16x32_bf16 v[120:123], v[192:195], v[144:147], v[120:123]
ds_read_b64_tr_b16 v[208:209], v33 offset:28672
v_mfma_f32_16x16x32_bf16 v[60:63], v[172:175], v[148:151], v[60:63]
v_mfma_f32_16x16x32_bf16 v[64:67], v[176:179], v[148:151], v[64:67]
ds_read_b64_tr_b16 v[210:211], v33 offset:29184
v_mfma_f32_16x16x32_bf16 v[92:95], v[180:183], v[148:151], v[92:95]
ds_read_b64_tr_b16 v[212:213], v34 offset:32768
v_mfma_f32_16x16x32_bf16 v[96:99], v[184:187], v[148:151], v[96:99]
ds_read_b128 v[164:167], v22 offset:22528
v_mfma_f32_16x16x32_bf16 v[124:127], v[188:191], v[148:151], v[124:127]
v_mfma_f32_16x16x32_bf16 v[128:131], v[192:195], v[148:151], v[128:131]
ds_read_b64_tr_b16 v[214:215], v34 offset:33024
v_mfma_f32_16x16x32_bf16 v[68:71], v[172:175], v[152:155], v[68:71]
ds_read_b64_tr_b16 v[216:217], v34 offset:34816
v_mfma_f32_16x16x32_bf16 v[72:75], v[176:179], v[152:155], v[72:75]
ds_read_b64_tr_b16 v[218:219], v34 offset:35072
v_mfma_f32_16x16x32_bf16 v[100:103], v[180:183], v[152:155], v[100:103]
ds_read_b128 v[168:171], v22 offset:24576
v_mfma_f32_16x16x32_bf16 v[104:107], v[184:187], v[152:155], v[104:107]
v_mfma_f32_16x16x32_bf16 v[132:135], v[188:191], v[152:155], v[132:135]
v_mfma_f32_16x16x32_bf16 v[136:139], v[192:195], v[152:155], v[136:139]
s_waitcnt lgkmcnt(0)
v_mfma_f32_16x16x32_bf16 v[44:47], v[196:199], v[156:159], v[44:47]
v_mfma_f32_16x16x32_bf16 v[48:51], v[200:203], v[156:159], v[48:51]
ds_read_b64_tr_b16 v[172:173], v26 offset:36864
v_mfma_f32_16x16x32_bf16 v[76:79], v[204:207], v[156:159], v[76:79]
ds_read_b64_tr_b16 v[174:175], v26 offset:37376
v_mfma_f32_16x16x32_bf16 v[80:83], v[208:211], v[156:159], v[80:83]
ds_read_b64_tr_b16 v[176:177], v26 offset:40960
v_mfma_f32_16x16x32_bf16 v[108:111], v[212:215], v[156:159], v[108:111]
v_mfma_f32_16x16x32_bf16 v[112:115], v[216:219], v[156:159], v[112:115]
ds_read_b128 v[140:143], v23 offset:0
v_mfma_f32_16x16x32_bf16 v[52:55], v[196:199], v[160:163], v[52:55]
ds_read_b64_tr_b16 v[178:179], v26 offset:41472
v_mfma_f32_16x16x32_bf16 v[56:59], v[200:203], v[160:163], v[56:59]
ds_read_b64_tr_b16 v[180:181], v33 offset:36864
v_mfma_f32_16x16x32_bf16 v[84:87], v[204:207], v[160:163], v[84:87]
v_mfma_f32_16x16x32_bf16 v[88:91], v[208:211], v[160:163], v[88:91]
ds_read_b64_tr_b16 v[182:183], v33 offset:37376
v_mfma_f32_16x16x32_bf16 v[116:119], v[212:215], v[160:163], v[116:119]
ds_read_b128 v[144:147], v23 offset:2048
v_mfma_f32_16x16x32_bf16 v[120:123], v[216:219], v[160:163], v[120:123]
ds_read_b64_tr_b16 v[184:185], v33 offset:40960
v_mfma_f32_16x16x32_bf16 v[60:63], v[196:199], v[164:167], v[60:63]
v_mfma_f32_16x16x32_bf16 v[64:67], v[200:203], v[164:167], v[64:67]
ds_read_b64_tr_b16 v[186:187], v33 offset:41472
v_mfma_f32_16x16x32_bf16 v[92:95], v[204:207], v[164:167], v[92:95]
ds_read_b64_tr_b16 v[188:189], v34 offset:45056
v_mfma_f32_16x16x32_bf16 v[96:99], v[208:211], v[164:167], v[96:99]
ds_read_b128 v[148:151], v23 offset:4096
v_mfma_f32_16x16x32_bf16 v[124:127], v[212:215], v[164:167], v[124:127]
v_mfma_f32_16x16x32_bf16 v[128:131], v[216:219], v[164:167], v[128:131]
ds_read_b64_tr_b16 v[190:191], v34 offset:45312
v_mfma_f32_16x16x32_bf16 v[68:71], v[196:199], v[168:171], v[68:71]
ds_read_b64_tr_b16 v[192:193], v34 offset:47104
v_mfma_f32_16x16x32_bf16 v[72:75], v[200:203], v[168:171], v[72:75]
ds_read_b64_tr_b16 v[194:195], v34 offset:47360
v_mfma_f32_16x16x32_bf16 v[100:103], v[204:207], v[168:171], v[100:103]
ds_read_b128 v[152:155], v23 offset:6144
v_mfma_f32_16x16x32_bf16 v[104:107], v[208:211], v[168:171], v[104:107]
v_mfma_f32_16x16x32_bf16 v[132:135], v[212:215], v[168:171], v[132:135]
v_mfma_f32_16x16x32_bf16 v[136:139], v[216:219], v[168:171], v[136:139]
s_waitcnt vmcnt(0) lgkmcnt(0)
s_barrier
ds_read_b64_tr_b16 v[196:197], v26 offset:0
v_mfma_f32_16x16x32_bf16 v[44:47], v[172:175], v[140:143], v[44:47]
ds_read_b64_tr_b16 v[198:199], v26 offset:512
v_mfma_f32_16x16x32_bf16 v[48:51], v[176:179], v[140:143], v[48:51]
s_add_u32 m0, s86, 12288
s_nop 0
buffer_load_dwordx4 v4, s[28:31], s73 offen lds
v_mfma_f32_16x16x32_bf16 v[76:79], v[180:183], v[140:143], v[76:79]
ds_read_b64_tr_b16 v[200:201], v26 offset:4096
v_mfma_f32_16x16x32_bf16 v[80:83], v[184:187], v[140:143], v[80:83]
ds_read_b128 v[156:159], v22 offset:0
v_mfma_f32_16x16x32_bf16 v[108:111], v[188:191], v[140:143], v[108:111]
s_add_u32 m0, s86, 13312
s_add_u32 s46, s73, 8192
buffer_load_dwordx4 v4, s[28:31], s46 offen lds
v_mfma_f32_16x16x32_bf16 v[112:115], v[192:195], v[140:143], v[112:115]
ds_read_b64_tr_b16 v[202:203], v26 offset:4608
v_mfma_f32_16x16x32_bf16 v[52:55], v[172:175], v[144:147], v[52:55]
ds_read_b64_tr_b16 v[204:205], v33 offset:0
s_add_u32 m0, s86, 14336
s_nop 0
buffer_load_dwordx4 v5, s[28:31], s73 offen lds
v_mfma_f32_16x16x32_bf16 v[56:59], v[176:179], v[144:147], v[56:59]
ds_read_b64_tr_b16 v[206:207], v33 offset:512
v_mfma_f32_16x16x32_bf16 v[84:87], v[180:183], v[144:147], v[84:87]
ds_read_b128 v[160:163], v22 offset:2048
v_mfma_f32_16x16x32_bf16 v[88:91], v[184:187], v[144:147], v[88:91]
s_add_u32 m0, s86, 15360
s_add_u32 s46, s73, 8192
buffer_load_dwordx4 v5, s[28:31], s46 offen lds
v_mfma_f32_16x16x32_bf16 v[116:119], v[188:191], v[144:147], v[116:119]
ds_read_b64_tr_b16 v[208:209], v33 offset:4096
v_mfma_f32_16x16x32_bf16 v[120:123], v[192:195], v[144:147], v[120:123]
ds_read_b64_tr_b16 v[210:211], v33 offset:4608
v_mfma_f32_16x16x32_bf16 v[60:63], v[172:175], v[148:151], v[60:63]
s_add_u32 m0, s86, 28672
s_nop 0
buffer_load_dwordx4 v4, s[28:31], s72 offen lds
v_mfma_f32_16x16x32_bf16 v[64:67], v[176:179], v[148:151], v[64:67]
ds_read_b64_tr_b16 v[212:213], v34 offset:8192
ds_read_b128 v[164:167], v22 offset:4096
v_mfma_f32_16x16x32_bf16 v[92:95], v[180:183], v[148:151], v[92:95]
s_add_u32 m0, s86, 29696
s_add_u32 s46, s72, 8192
buffer_load_dwordx4 v4, s[28:31], s46 offen lds
v_mfma_f32_16x16x32_bf16 v[96:99], v[184:187], v[148:151], v[96:99]
ds_read_b64_tr_b16 v[214:215], v34 offset:8448
v_mfma_f32_16x16x32_bf16 v[124:127], v[188:191], v[148:151], v[124:127]
ds_read_b64_tr_b16 v[216:217], v34 offset:10240
v_mfma_f32_16x16x32_bf16 v[128:131], v[192:195], v[148:151], v[128:131]
s_add_u32 m0, s86, 30720
s_nop 0
buffer_load_dwordx4 v5, s[28:31], s72 offen lds
v_mfma_f32_16x16x32_bf16 v[68:71], v[172:175], v[152:155], v[68:71]
ds_read_b64_tr_b16 v[218:219], v34 offset:10496
v_mfma_f32_16x16x32_bf16 v[72:75], v[176:179], v[152:155], v[72:75]
ds_read_b128 v[168:171], v22 offset:6144
v_mfma_f32_16x16x32_bf16 v[100:103], v[180:183], v[152:155], v[100:103]
s_add_u32 m0, s86, 31744
s_add_u32 s46, s72, 8192
buffer_load_dwordx4 v5, s[28:31], s46 offen lds
v_mfma_f32_16x16x32_bf16 v[104:107], v[184:187], v[152:155], v[104:107]
v_mfma_f32_16x16x32_bf16 v[132:135], v[188:191], v[152:155], v[132:135]
v_mfma_f32_16x16x32_bf16 v[136:139], v[192:195], v[152:155], v[136:139]
s_waitcnt vmcnt(8) lgkmcnt(0)
s_barrier
v_mfma_f32_16x16x32_bf16 v[44:47], v[196:199], v[156:159], v[44:47]
v_mfma_f32_16x16x32_bf16 v[48:51], v[200:203], v[156:159], v[48:51]
v_mfma_f32_16x16x32_bf16 v[76:79], v[204:207], v[156:159], v[76:79]
s_add_u32 m0, s86, 45056
s_nop 0
buffer_load_dwordx4 v4, s[28:31], s71 offen lds
v_mfma_f32_16x16x32_bf16 v[80:83], v[208:211], v[156:159], v[80:83]
v_mfma_f32_16x16x32_bf16 v[108:111], v[212:215], v[156:159], v[108:111]
v_mfma_f32_16x16x32_bf16 v[112:115], v[216:219], v[156:159], v[112:115]
s_add_u32 m0, s86, 46080
s_add_u32 s46, s71, 8192
buffer_load_dwordx4 v4, s[28:31], s46 offen lds
v_mfma_f32_16x16x32_bf16 v[52:55], v[196:199], v[160:163], v[52:55]
v_mfma_f32_16x16x32_bf16 v[56:59], v[200:203], v[160:163], v[56:59]
s_add_u32 m0, s86, 47104
s_nop 0
buffer_load_dwordx4 v5, s[28:31], s71 offen lds
v_mfma_f32_16x16x32_bf16 v[84:87], v[204:207], v[160:163], v[84:87]
v_mfma_f32_16x16x32_bf16 v[88:91], v[208:211], v[160:163], v[88:91]
v_mfma_f32_16x16x32_bf16 v[116:119], v[212:215], v[160:163], v[116:119]
s_add_u32 m0, s86, 48128
s_add_u32 s46, s71, 8192
buffer_load_dwordx4 v5, s[28:31], s46 offen lds
v_mfma_f32_16x16x32_bf16 v[120:123], v[216:219], v[160:163], v[120:123]
v_mfma_f32_16x16x32_bf16 v[60:63], v[196:199], v[164:167], v[60:63]
v_mfma_f32_16x16x32_bf16 v[64:67], v[200:203], v[164:167], v[64:67]
s_add_u32 m0, s86, 102400
s_nop 0
buffer_load_dwordx4 v4, s[28:31], s70 offen lds
v_mfma_f32_16x16x32_bf16 v[92:95], v[204:207], v[164:167], v[92:95]
v_mfma_f32_16x16x32_bf16 v[96:99], v[208:211], v[164:167], v[96:99]
s_add_u32 m0, s86, 103424
s_add_u32 s46, s70, 8192
buffer_load_dwordx4 v4, s[28:31], s46 offen lds
v_mfma_f32_16x16x32_bf16 v[124:127], v[212:215], v[164:167], v[124:127]
v_mfma_f32_16x16x32_bf16 v[128:131], v[216:219], v[164:167], v[128:131]
v_mfma_f32_16x16x32_bf16 v[68:71], v[196:199], v[168:171], v[68:71]
s_add_u32 m0, s86, 104448
s_nop 0
buffer_load_dwordx4 v5, s[28:31], s70 offen lds
v_mfma_f32_16x16x32_bf16 v[72:75], v[200:203], v[168:171], v[72:75]
v_mfma_f32_16x16x32_bf16 v[100:103], v[204:207], v[168:171], v[100:103]
s_add_u32 m0, s86, 105472
s_add_u32 s46, s70, 8192
buffer_load_dwordx4 v5, s[28:31], s46 offen lds
v_mfma_f32_16x16x32_bf16 v[104:107], v[208:211], v[168:171], v[104:107]
v_mfma_f32_16x16x32_bf16 v[132:135], v[212:215], v[168:171], v[132:135]
v_mfma_f32_16x16x32_bf16 v[136:139], v[216:219], v[168:171], v[136:139]
s_and_b32 s50, s42, 1
s_lshl_b32 s48, s50, 7
s_add_u32 s48, s48, 160768
v_lshl_add_u32 v14, v2, 4, s48
ds_read_b128 v[156:159], v14 offset:0
ds_read_b128 v[180:183], v14 offset:384
ds_read_b128 v[160:163], v14 offset:64
ds_read_b128 v[184:187], v14 offset:448
s_lshl_b32 s48, s50, 6
s_add_u32 s48, s48, 160768
v_lshl_add_u32 v17, v2, 4, s48
ds_read_b128 v[164:167], v17 offset:256
ds_read_b128 v[188:191], v17 offset:640
s_lshl_b32 s49, s63, 10
s_add_u32 s49, s49, 157952
v_lshl_add_u32 v10, v3, 4, s49
ds_read_b128 v[140:143], v10 offset:0
ds_read_b128 v[144:147], v10 offset:256
ds_read_b128 v[148:151], v10 offset:512
ds_read_b128 v[152:155], v10 offset:768
v_lshrrev_b32 v15, 5, v1
v_lshlrev_b32 v15, 10, v15
v_and_b32 v16, 31, v1
v_lshl_add_u32 v168, v16, 4, v15
s_lshl1_add_u32 s48, s40, s63
s_mul_i32 s60, s48, 294912
s_add_u32 s60, s60, 65536
s_lshr_b32 s48, s53, 6
s_lshl_b32 s48, s48, 12
s_lshl_b32 s49, s50, 9
s_add_u32 s48, s48, s49
s_add_u32 s61, s60, s48
s_lshr_b32 s48, s45, 6
s_add_u32 s48, s48, s50
s_lshl_b32 s48, s48, 12
s_add_u32 s60, s60, s48
s_waitcnt lgkmcnt(0)
v_mul_f32 v140, 0xbfb8aa3b, v140
v_mul_f32 v143, 0xbfb8aa3b, v143
v_mul_f32 v144, 0xbfb8aa3b, v144
v_mul_f32 v147, 0xbfb8aa3b, v147
v_mul_f32 v148, 0xbfb8aa3b, v148
v_mul_f32 v151, 0xbfb8aa3b, v151
v_mul_f32 v152, 0xbfb8aa3b, v152
v_mul_f32 v155, 0xbfb8aa3b, v155
v_pk_mul_f32 v[10:11], v[164:165], v[150:151] op_sel:[0,1] op_sel_hi:[1,1]
v_pk_mul_f32 v[12:13], v[166:167], v[150:151] op_sel:[0,1] op_sel_hi:[1,1]
v_pk_mul_f32 v[14:15], v[164:165], v[154:155] op_sel:[0,1] op_sel_hi:[1,1]
v_pk_mul_f32 v[16:17], v[166:167], v[154:155] op_sel:[0,1] op_sel_hi:[1,1]
v_pk_fma_f32 v[124:125], v[124:125], v[148:149], v[10:11] op_sel:[0,0,0] op_sel_hi:[1,0,1]
v_pk_fma_f32 v[126:127], v[126:127], v[148:149], v[12:13] op_sel:[0,0,0] op_sel_hi:[1,0,1]
v_pk_fma_f32 v[132:133], v[132:133], v[152:153], v[14:15] op_sel:[0,0,0] op_sel_hi:[1,0,1]
v_pk_fma_f32 v[134:135], v[134:135], v[152:153], v[16:17] op_sel:[0,0,0] op_sel_hi:[1,0,1]
v_exp_f32 v124, v124
v_exp_f32 v125, v125
v_exp_f32 v126, v126
v_exp_f32 v127, v127
v_exp_f32 v132, v132
v_exp_f32 v133, v133
v_exp_f32 v134, v134
v_exp_f32 v135, v135
v_pk_fma_f32 v[128:129], v[188:189], v[148:149], v[128:129] op_sel:[0,1,0] op_sel_hi:[1,1,1]
v_pk_fma_f32 v[130:131], v[190:191], v[148:149], v[130:131] op_sel:[0,1,0] op_sel_hi:[1,1,1]
v_pk_fma_f32 v[136:137], v[188:189], v[152:153], v[136:137] op_sel:[0,1,0] op_sel_hi:[1,1,1]
v_pk_fma_f32 v[138:139], v[190:191], v[152:153], v[138:139] op_sel:[0,1,0] op_sel_hi:[1,1,1]
v_pk_fma_f32 v[124:125], v[124:125], v[150:151], v[150:151] op_sel:[0,0,0] op_sel_hi:[1,0,0]
v_pk_fma_f32 v[126:127], v[126:127], v[150:151], v[150:151] op_sel:[0,0,0] op_sel_hi:[1,0,0]
v_pk_fma_f32 v[132:133], v[132:133], v[154:155], v[154:155] op_sel:[0,0,0] op_sel_hi:[1,0,0]
v_pk_fma_f32 v[134:135], v[134:135], v[154:155], v[154:155] op_sel:[0,0,0] op_sel_hi:[1,0,0]
v_rcp_f32 v124, v124
v_rcp_f32 v125, v125
v_rcp_f32 v126, v126
v_rcp_f32 v127, v127
v_rcp_f32 v132, v132
v_rcp_f32 v133, v133
v_rcp_f32 v134, v134
v_rcp_f32 v135, v135
s_nop 0
v_pk_mul_f32 v[128:129], v[128:129], v[124:125]
v_pk_mul_f32 v[130:131], v[130:131], v[126:127]
v_pk_mul_f32 v[136:137], v[136:137], v[132:133]
v_pk_mul_f32 v[138:139], v[138:139], v[134:135]
v_cvt_pk_bf16_f32 v172, v128, v129
v_cvt_pk_bf16_f32 v173, v130, v131
v_cvt_pk_bf16_f32 v174, v136, v137
v_cvt_pk_bf16_f32 v175, v138, v139
s_nop 1
v_permlane32_swap_b32 v172, v174
v_permlane32_swap_b32 v173, v175
buffer_store_dwordx4 v[172:175], v168, s[24:27], s61 offen offset:2048 sc1
v_pk_mul_f32 v[10:11], v[164:165], v[142:143] op_sel:[0,1] op_sel_hi:[1,1]
v_pk_mul_f32 v[12:13], v[166:167], v[142:143] op_sel:[0,1] op_sel_hi:[1,1]
v_pk_mul_f32 v[14:15], v[164:165], v[146:147] op_sel:[0,1] op_sel_hi:[1,1]
v_pk_mul_f32 v[16:17], v[166:167], v[146:147] op_sel:[0,1] op_sel_hi:[1,1]
v_pk_fma_f32 v[108:109], v[108:109], v[140:141], v[10:11] op_sel:[0,0,0] op_sel_hi:[1,0,1]
v_pk_fma_f32 v[110:111], v[110:111], v[140:141], v[12:13] op_sel:[0,0,0] op_sel_hi:[1,0,1]
v_pk_fma_f32 v[116:117], v[116:117], v[144:145], v[14:15] op_sel:[0,0,0] op_sel_hi:[1,0,1]
v_pk_fma_f32 v[118:119], v[118:119], v[144:145], v[16:17] op_sel:[0,0,0] op_sel_hi:[1,0,1]
v_exp_f32 v108, v108
v_exp_f32 v109, v109
v_exp_f32 v110, v110
v_exp_f32 v111, v111
v_exp_f32 v116, v116
v_exp_f32 v117, v117
v_exp_f32 v118, v118
v_exp_f32 v119, v119
v_pk_fma_f32 v[112:113], v[188:189], v[140:141], v[112:113] op_sel:[0,1,0] op_sel_hi:[1,1,1]
v_pk_fma_f32 v[114:115], v[190:191], v[140:141], v[114:115] op_sel:[0,1,0] op_sel_hi:[1,1,1]
v_pk_fma_f32 v[120:121], v[188:189], v[144:145], v[120:121] op_sel:[0,1,0] op_sel_hi:[1,1,1]
v_pk_fma_f32 v[122:123], v[190:191], v[144:145], v[122:123] op_sel:[0,1,0] op_sel_hi:[1,1,1]
v_pk_fma_f32 v[108:109], v[108:109], v[142:143], v[142:143] op_sel:[0,0,0] op_sel_hi:[1,0,0]
v_pk_fma_f32 v[110:111], v[110:111], v[142:143], v[142:143] op_sel:[0,0,0] op_sel_hi:[1,0,0]
v_pk_fma_f32 v[116:117], v[116:117], v[146:147], v[146:147] op_sel:[0,0,0] op_sel_hi:[1,0,0]
v_pk_fma_f32 v[118:119], v[118:119], v[146:147], v[146:147] op_sel:[0,0,0] op_sel_hi:[1,0,0]
v_rcp_f32 v108, v108
v_rcp_f32 v109, v109
v_rcp_f32 v110, v110
v_rcp_f32 v111, v111
v_rcp_f32 v116, v116
v_rcp_f32 v117, v117
v_rcp_f32 v118, v118
v_rcp_f32 v119, v119
s_nop 0
v_pk_mul_f32 v[112:113], v[112:113], v[108:109]
v_pk_mul_f32 v[114:115], v[114:115], v[110:111]
v_pk_mul_f32 v[120:121], v[120:121], v[116:117]
v_pk_mul_f32 v[122:123], v[122:123], v[118:119]
v_cvt_pk_bf16_f32 v176, v112, v113
v_cvt_pk_bf16_f32 v177, v114, v115
v_cvt_pk_bf16_f32 v178, v120, v121
v_cvt_pk_bf16_f32 v179, v122, v123
s_nop 1
v_permlane32_swap_b32 v176, v178
v_permlane32_swap_b32 v177, v179
buffer_store_dwordx4 v[176:179], v168, s[24:27], s61 offen offset:0 sc1
v_pk_mul_f32 v[10:11], v[160:161], v[150:151] op_sel:[0,1] op_sel_hi:[1,1]
v_pk_mul_f32 v[12:13], v[162:163], v[150:151] op_sel:[0,1] op_sel_hi:[1,1]
v_pk_mul_f32 v[14:15], v[160:161], v[154:155] op_sel:[0,1] op_sel_hi:[1,1]
v_pk_mul_f32 v[16:17], v[162:163], v[154:155] op_sel:[0,1] op_sel_hi:[1,1]
v_pk_fma_f32 v[92:93], v[92:93], v[148:149], v[10:11] op_sel:[0,0,0] op_sel_hi:[1,0,1]
v_pk_fma_f32 v[94:95], v[94:95], v[148:149], v[12:13] op_sel:[0,0,0] op_sel_hi:[1,0,1]
v_pk_fma_f32 v[100:101], v[100:101], v[152:153], v[14:15] op_sel:[0,0,0] op_sel_hi:[1,0,1]
v_pk_fma_f32 v[102:103], v[102:103], v[152:153], v[16:17] op_sel:[0,0,0] op_sel_hi:[1,0,1]
v_exp_f32 v92, v92
v_exp_f32 v93, v93
v_exp_f32 v94, v94
v_exp_f32 v95, v95
v_exp_f32 v100, v100
v_exp_f32 v101, v101
v_exp_f32 v102, v102
v_exp_f32 v103, v103
v_pk_fma_f32 v[96:97], v[184:185], v[148:149], v[96:97] op_sel:[0,1,0] op_sel_hi:[1,1,1]
v_pk_fma_f32 v[98:99], v[186:187], v[148:149], v[98:99] op_sel:[0,1,0] op_sel_hi:[1,1,1]
v_pk_fma_f32 v[104:105], v[184:185], v[152:153], v[104:105] op_sel:[0,1,0] op_sel_hi:[1,1,1]
v_pk_fma_f32 v[106:107], v[186:187], v[152:153], v[106:107] op_sel:[0,1,0] op_sel_hi:[1,1,1]
v_pk_fma_f32 v[92:93], v[92:93], v[150:151], v[150:151] op_sel:[0,0,0] op_sel_hi:[1,0,0]
v_pk_fma_f32 v[94:95], v[94:95], v[150:151], v[150:151] op_sel:[0,0,0] op_sel_hi:[1,0,0]
v_pk_fma_f32 v[100:101], v[100:101], v[154:155], v[154:155] op_sel:[0,0,0] op_sel_hi:[1,0,0]
v_pk_fma_f32 v[102:103], v[102:103], v[154:155], v[154:155] op_sel:[0,0,0] op_sel_hi:[1,0,0]
v_rcp_f32 v92, v92
v_rcp_f32 v93, v93
v_rcp_f32 v94, v94
v_rcp_f32 v95, v95
v_rcp_f32 v100, v100
v_rcp_f32 v101, v101
v_rcp_f32 v102, v102
v_rcp_f32 v103, v103
s_nop 0
v_pk_mul_f32 v[96:97], v[96:97], v[92:93]
v_pk_mul_f32 v[98:99], v[98:99], v[94:95]
v_pk_mul_f32 v[104:105], v[104:105], v[100:101]
v_pk_mul_f32 v[106:107], v[106:107], v[102:103]
v_cvt_pk_bf16_f32 v172, v96, v97
v_cvt_pk_bf16_f32 v173, v98, v99
v_cvt_pk_bf16_f32 v174, v104, v105
v_cvt_pk_bf16_f32 v175, v106, v107
s_nop 1
v_permlane32_swap_b32 v172, v174
v_permlane32_swap_b32 v173, v175
buffer_store_dwordx4 v[172:175], v168, s[24:27], s60 offen offset:2560 sc1
v_pk_mul_f32 v[10:11], v[160:161], v[142:143] op_sel:[0,1] op_sel_hi:[1,1]
v_pk_mul_f32 v[12:13], v[162:163], v[142:143] op_sel:[0,1] op_sel_hi:[1,1]
v_pk_mul_f32 v[14:15], v[160:161], v[146:147] op_sel:[0,1] op_sel_hi:[1,1]
v_pk_mul_f32 v[16:17], v[162:163], v[146:147] op_sel:[0,1] op_sel_hi:[1,1]
v_pk_fma_f32 v[76:77], v[76:77], v[140:141], v[10:11] op_sel:[0,0,0] op_sel_hi:[1,0,1]
v_pk_fma_f32 v[78:79], v[78:79], v[140:141], v[12:13] op_sel:[0,0,0] op_sel_hi:[1,0,1]
v_pk_fma_f32 v[84:85], v[84:85], v[144:145], v[14:15] op_sel:[0,0,0] op_sel_hi:[1,0,1]
v_pk_fma_f32 v[86:87], v[86:87], v[144:145], v[16:17] op_sel:[0,0,0] op_sel_hi:[1,0,1]
v_exp_f32 v76, v76
v_exp_f32 v77, v77
v_exp_f32 v78, v78
v_exp_f32 v79, v79
v_exp_f32 v84, v84
v_exp_f32 v85, v85
v_exp_f32 v86, v86
v_exp_f32 v87, v87
v_pk_fma_f32 v[80:81], v[184:185], v[140:141], v[80:81] op_sel:[0,1,0] op_sel_hi:[1,1,1]
v_pk_fma_f32 v[82:83], v[186:187], v[140:141], v[82:83] op_sel:[0,1,0] op_sel_hi:[1,1,1]
v_pk_fma_f32 v[88:89], v[184:185], v[144:145], v[88:89] op_sel:[0,1,0] op_sel_hi:[1,1,1]
v_pk_fma_f32 v[90:91], v[186:187], v[144:145], v[90:91] op_sel:[0,1,0] op_sel_hi:[1,1,1]
v_pk_fma_f32 v[76:77], v[76:77], v[142:143], v[142:143] op_sel:[0,0,0] op_sel_hi:[1,0,0]
v_pk_fma_f32 v[78:79], v[78:79], v[142:143], v[142:143] op_sel:[0,0,0] op_sel_hi:[1,0,0]
v_pk_fma_f32 v[84:85], v[84:85], v[146:147], v[146:147] op_sel:[0,0,0] op_sel_hi:[1,0,0]
v_pk_fma_f32 v[86:87], v[86:87], v[146:147], v[146:147] op_sel:[0,0,0] op_sel_hi:[1,0,0]
v_rcp_f32 v76, v76
v_rcp_f32 v77, v77
v_rcp_f32 v78, v78
v_rcp_f32 v79, v79
v_rcp_f32 v84, v84
v_rcp_f32 v85, v85
v_rcp_f32 v86, v86
v_rcp_f32 v87, v87
s_nop 0
v_pk_mul_f32 v[80:81], v[80:81], v[76:77]
v_pk_mul_f32 v[82:83], v[82:83], v[78:79]
v_pk_mul_f32 v[88:89], v[88:89], v[84:85]
v_pk_mul_f32 v[90:91], v[90:91], v[86:87]
v_cvt_pk_bf16_f32 v176, v80, v81
v_cvt_pk_bf16_f32 v177, v82, v83
v_cvt_pk_bf16_f32 v178, v88, v89
v_cvt_pk_bf16_f32 v179, v90, v91
s_nop 1
v_permlane32_swap_b32 v176, v178
v_permlane32_swap_b32 v177, v179
buffer_store_dwordx4 v[176:179], v168, s[24:27], s60 offen offset:512 sc1
v_pk_mul_f32 v[10:11], v[156:157], v[150:151] op_sel:[0,1] op_sel_hi:[1,1]
v_pk_mul_f32 v[12:13], v[158:159], v[150:151] op_sel:[0,1] op_sel_hi:[1,1]
v_pk_mul_f32 v[14:15], v[156:157], v[154:155] op_sel:[0,1] op_sel_hi:[1,1]
v_pk_mul_f32 v[16:17], v[158:159], v[154:155] op_sel:[0,1] op_sel_hi:[1,1]
v_pk_fma_f32 v[60:61], v[60:61], v[148:149], v[10:11] op_sel:[0,0,0] op_sel_hi:[1,0,1]
v_pk_fma_f32 v[62:63], v[62:63], v[148:149], v[12:13] op_sel:[0,0,0] op_sel_hi:[1,0,1]
v_pk_fma_f32 v[68:69], v[68:69], v[152:153], v[14:15] op_sel:[0,0,0] op_sel_hi:[1,0,1]
v_pk_fma_f32 v[70:71], v[70:71], v[152:153], v[16:17] op_sel:[0,0,0] op_sel_hi:[1,0,1]
v_exp_f32 v60, v60
v_exp_f32 v61, v61
v_exp_f32 v62, v62
v_exp_f32 v63, v63
v_exp_f32 v68, v68
v_exp_f32 v69, v69
v_exp_f32 v70, v70
v_exp_f32 v71, v71
v_pk_fma_f32 v[64:65], v[180:181], v[148:149], v[64:65] op_sel:[0,1,0] op_sel_hi:[1,1,1]
v_pk_fma_f32 v[66:67], v[182:183], v[148:149], v[66:67] op_sel:[0,1,0] op_sel_hi:[1,1,1]
v_pk_fma_f32 v[72:73], v[180:181], v[152:153], v[72:73] op_sel:[0,1,0] op_sel_hi:[1,1,1]
v_pk_fma_f32 v[74:75], v[182:183], v[152:153], v[74:75] op_sel:[0,1,0] op_sel_hi:[1,1,1]
v_pk_fma_f32 v[60:61], v[60:61], v[150:151], v[150:151] op_sel:[0,0,0] op_sel_hi:[1,0,0]
v_pk_fma_f32 v[62:63], v[62:63], v[150:151], v[150:151] op_sel:[0,0,0] op_sel_hi:[1,0,0]
v_pk_fma_f32 v[68:69], v[68:69], v[154:155], v[154:155] op_sel:[0,0,0] op_sel_hi:[1,0,0]
v_pk_fma_f32 v[70:71], v[70:71], v[154:155], v[154:155] op_sel:[0,0,0] op_sel_hi:[1,0,0]
v_rcp_f32 v60, v60
v_rcp_f32 v61, v61
v_rcp_f32 v62, v62
v_rcp_f32 v63, v63
v_rcp_f32 v68, v68
v_rcp_f32 v69, v69
v_rcp_f32 v70, v70
v_rcp_f32 v71, v71
s_nop 0
v_pk_mul_f32 v[64:65], v[64:65], v[60:61]
v_pk_mul_f32 v[66:67], v[66:67], v[62:63]
v_pk_mul_f32 v[72:73], v[72:73], v[68:69]
v_pk_mul_f32 v[74:75], v[74:75], v[70:71]
v_cvt_pk_bf16_f32 v172, v64, v65
v_cvt_pk_bf16_f32 v173, v66, v67
v_cvt_pk_bf16_f32 v174, v72, v73
v_cvt_pk_bf16_f32 v175, v74, v75
s_nop 1
v_permlane32_swap_b32 v172, v174
v_permlane32_swap_b32 v173, v175
buffer_store_dwordx4 v[172:175], v168, s[24:27], s60 offen offset:2048 sc1
v_pk_mul_f32 v[10:11], v[156:157], v[142:143] op_sel:[0,1] op_sel_hi:[1,1]
v_pk_mul_f32 v[12:13], v[158:159], v[142:143] op_sel:[0,1] op_sel_hi:[1,1]
v_pk_mul_f32 v[14:15], v[156:157], v[146:147] op_sel:[0,1] op_sel_hi:[1,1]
v_pk_mul_f32 v[16:17], v[158:159], v[146:147] op_sel:[0,1] op_sel_hi:[1,1]
v_pk_fma_f32 v[44:45], v[44:45], v[140:141], v[10:11] op_sel:[0,0,0] op_sel_hi:[1,0,1]
v_pk_fma_f32 v[46:47], v[46:47], v[140:141], v[12:13] op_sel:[0,0,0] op_sel_hi:[1,0,1]
v_pk_fma_f32 v[52:53], v[52:53], v[144:145], v[14:15] op_sel:[0,0,0] op_sel_hi:[1,0,1]
v_pk_fma_f32 v[54:55], v[54:55], v[144:145], v[16:17] op_sel:[0,0,0] op_sel_hi:[1,0,1]
v_exp_f32 v44, v44
v_exp_f32 v45, v45
v_exp_f32 v46, v46
v_exp_f32 v47, v47
v_exp_f32 v52, v52
v_exp_f32 v53, v53
v_exp_f32 v54, v54
v_exp_f32 v55, v55
v_pk_fma_f32 v[48:49], v[180:181], v[140:141], v[48:49] op_sel:[0,1,0] op_sel_hi:[1,1,1]
v_pk_fma_f32 v[50:51], v[182:183], v[140:141], v[50:51] op_sel:[0,1,0] op_sel_hi:[1,1,1]
v_pk_fma_f32 v[56:57], v[180:181], v[144:145], v[56:57] op_sel:[0,1,0] op_sel_hi:[1,1,1]
v_pk_fma_f32 v[58:59], v[182:183], v[144:145], v[58:59] op_sel:[0,1,0] op_sel_hi:[1,1,1]
v_pk_fma_f32 v[44:45], v[44:45], v[142:143], v[142:143] op_sel:[0,0,0] op_sel_hi:[1,0,0]
v_pk_fma_f32 v[46:47], v[46:47], v[142:143], v[142:143] op_sel:[0,0,0] op_sel_hi:[1,0,0]
v_pk_fma_f32 v[52:53], v[52:53], v[146:147], v[146:147] op_sel:[0,0,0] op_sel_hi:[1,0,0]
v_pk_fma_f32 v[54:55], v[54:55], v[146:147], v[146:147] op_sel:[0,0,0] op_sel_hi:[1,0,0]
v_rcp_f32 v44, v44
v_rcp_f32 v45, v45
v_rcp_f32 v46, v46
v_rcp_f32 v47, v47
v_rcp_f32 v52, v52
v_rcp_f32 v53, v53
v_rcp_f32 v54, v54
v_rcp_f32 v55, v55
s_nop 0
v_pk_mul_f32 v[48:49], v[48:49], v[44:45]
v_pk_mul_f32 v[50:51], v[50:51], v[46:47]
v_pk_mul_f32 v[56:57], v[56:57], v[52:53]
v_pk_mul_f32 v[58:59], v[58:59], v[54:55]
v_cvt_pk_bf16_f32 v176, v48, v49
v_cvt_pk_bf16_f32 v177, v50, v51
v_cvt_pk_bf16_f32 v178, v56, v57
v_cvt_pk_bf16_f32 v179, v58, v59
s_nop 1
v_permlane32_swap_b32 v176, v178
v_permlane32_swap_b32 v177, v179
buffer_store_dwordx4 v[176:179], v168, s[24:27], s60 offen offset:0 sc1
s_waitcnt vmcnt(18)
ds_read_b64_tr_b16 v[240:241], v6 offset:12288
ds_read_b64_tr_b16 v[242:243], v6 offset:13312
ds_read_b64_tr_b16 v[244:245], v7 offset:12288
ds_read_b64_tr_b16 v[246:247], v7 offset:13312
ds_read_b64_tr_b16 v[248:249], v8 offset:12288
ds_read_b64_tr_b16 v[250:251], v8 offset:13312
ds_read_b64_tr_b16 v[252:253], v9 offset:12288
ds_read_b64_tr_b16 v[254:255], v9 offset:13312
s_waitcnt vmcnt(14)
ds_read_b64_tr_b16 v[224:225], v6 offset:28672
ds_read_b64_tr_b16 v[226:227], v6 offset:29696
ds_read_b64_tr_b16 v[228:229], v7 offset:28672
ds_read_b64_tr_b16 v[230:231], v7 offset:29696
ds_read_b64_tr_b16 v[232:233], v8 offset:28672
ds_read_b64_tr_b16 v[234:235], v8 offset:29696
ds_read_b64_tr_b16 v[236:237], v9 offset:28672
ds_read_b64_tr_b16 v[238:239], v9 offset:29696
s_waitcnt vmcnt(10)
ds_read_b64_tr_b16 v[208:209], v6 offset:45056
ds_read_b64_tr_b16 v[210:211], v6 offset:46080
ds_read_b64_tr_b16 v[212:213], v7 offset:45056
ds_read_b64_tr_b16 v[214:215], v7 offset:46080
ds_read_b64_tr_b16 v[216:217], v8 offset:45056
ds_read_b64_tr_b16 v[218:219], v8 offset:46080
ds_read_b64_tr_b16 v[220:221], v9 offset:45056
ds_read_b64_tr_b16 v[222:223], v9 offset:46080
s_waitcnt vmcnt(6)
v_add_u32 v18, 102400, v6
ds_read_b64_tr_b16 v[192:193], v18
ds_read_b64_tr_b16 v[194:195], v18 offset:1024
v_add_u32 v19, 102400, v7
ds_read_b64_tr_b16 v[196:197], v19
ds_read_b64_tr_b16 v[198:199], v19 offset:1024
v_add_u32 v20, 102400, v8
ds_read_b64_tr_b16 v[200:201], v20
ds_read_b64_tr_b16 v[202:203], v20 offset:1024
v_add_u32 v21, 102400, v9
ds_read_b64_tr_b16 v[204:205], v21
ds_read_b64_tr_b16 v[206:207], v21 offset:1024
v_lshlrev_b32 v10, 2, v1
v_add_u32 v10, 162624, v10
v_mov_b32 v14, 1
v_lshlrev_b32_e64 v13, 2, v3
v_add_u32 v13, 162368, v13
ds_read_b32 v11, v13
v_lshlrev_b32 v15, 7, v3
v_lshl_add_u32 v15, v2, 27, v15
s_waitcnt vmcnt(0)
ds_add_rtn_u32 v12, v10, v14
s_waitcnt lgkmcnt(0)
v_readfirstlane_b32 s48, v12
s_nop 3
s_cmp_eq_u32 s48, 3
s_cbranch_scc0 L_F24_nosig
buffer_store_dword v11, v15, s[24:27], s87 offen offset:0 sc1
L_F24_nosig:
s_setprio 3
s_branch L_P2_0
.p2align 3
L_P2_1:
s_lshl3_add_u32 s48, s84, s85
s_lshl_b32 s48, s48, 7
s_add_u32 s48, s48, 9805824
s_lshl_b32 s50, s42, 1
s_lshl_b32 s56, 0x300, s50
s_lshl_b32 s50, 0x03030000, s50
s_mul_i32 s51, s84, 294912
s_add_u32 s51, s51, 65536
s_mov_b32 s60, s51
s_lshr_b32 s73, s73, 3
s_add_u32 s73, s73, s51
s_lshr_b32 s72, s72, 3
s_add_u32 s72, s72, s51
s_lshr_b32 s71, s71, 3
s_add_u32 s71, s71, s51
s_lshr_b32 s70, s70, 3
s_add_u32 s70, s70, s51
s_lshr_b32 s69, s69, 3
s_add_u32 s69, s69, s51
s_lshr_b32 s68, s68, 3
s_add_u32 s68, s68, s51
s_lshr_b32 s67, s67, 3
s_add_u32 s67, s67, s51
s_lshr_b32 s66, s66, 3
s_add_u32 s66, s66, s51
v_lshlrev_b32 v92, 4, v1
v_lshlrev_b32 v93, 2, v1
v_add_u32 v93, 162092, v93
v_mov_b32 v12, 162064
v_cmp_eq_u32 vcc, 0, v1
s_nop 1
v_cndmask_b32 v93, v93, v12, vcc
v_and_b32 v12, 7, v3
v_xor_b32 v12, v12, v2
v_lshlrev_b32 v12, 4, v12
v_lshl_add_u32 v94, v3, 8, v12
v_add_u32 v94, s86, v94
v_xor_b32 v95, 64, v94
s_waitcnt lgkmcnt(0)
s_add_u32 m0, s86, 61440
s_nop 0
buffer_load_dwordx4 v4, s[28:31], s65 offen lds
s_add_u32 m0, s86, 62464
s_add_u32 s46, s65, 8192
buffer_load_dwordx4 v4, s[28:31], s46 offen lds
s_add_u32 m0, s86, 63488
s_nop 0
buffer_load_dwordx4 v5, s[28:31], s65 offen lds
s_add_u32 m0, s86, 64512
s_add_u32 s46, s65, 8192
buffer_load_dwordx4 v5, s[28:31], s46 offen lds
s_lshr_b32 s65, s65, 3
s_add_u32 s65, s65, s60
s_add_u32 m0, s86, 139264
s_nop 0
buffer_load_dwordx4 v4, s[28:31], s64 offen lds
s_add_u32 m0, s86, 140288
s_add_u32 s46, s64, 8192
buffer_load_dwordx4 v4, s[28:31], s46 offen lds
s_add_u32 m0, s86, 141312
s_nop 0
buffer_load_dwordx4 v5, s[28:31], s64 offen lds
s_add_u32 m0, s86, 142336
s_add_u32 s46, s64, 8192
buffer_load_dwordx4 v5, s[28:31], s46 offen lds
s_lshr_b32 s64, s64, 3
s_add_u32 s64, s64, s60
s_add_u32 m0, s86, 120832
s_nop 0
buffer_load_dwordx4 v4, s[28:31], s74 offen lds
s_add_u32 m0, s86, 121856
s_add_u32 s46, s74, 8192
buffer_load_dwordx4 v4, s[28:31], s46 offen lds
s_add_u32 m0, s86, 122880
s_nop 0
buffer_load_dwordx4 v5, s[28:31], s74 offen lds
s_add_u32 m0, s86, 123904
s_add_u32 s46, s74, 8192
buffer_load_dwordx4 v5, s[28:31], s46 offen lds
s_lshr_b32 s74, s74, 3
s_add_u32 s74, s74, s60
s_add_u32 m0, s86, 83968
s_nop 0
buffer_load_dwordx4 v4, s[28:31], s75 offen lds
s_add_u32 m0, s86, 84992
s_add_u32 s46, s75, 8192
buffer_load_dwordx4 v4, s[28:31], s46 offen lds
s_add_u32 m0, s86, 86016
s_nop 0
buffer_load_dwordx4 v5, s[28:31], s75 offen lds
s_add_u32 m0, s86, 87040
s_add_u32 s46, s75, 8192
buffer_load_dwordx4 v5, s[28:31], s46 offen lds
s_lshr_b32 s75, s75, 3
s_add_u32 s75, s75, s60
v_and_b32 v10, 31, v1
v_lshlrev_b32_e64 v10, 2, v10
v_add_u32 v11, 162496, v10
ds_read_b32 v16, v11
s_mov_b32 s49, 0
v_mov_b32 v17, 162048
v_mov_b32 v18, 1
v_lshlrev_b32_e64 v19, 2, v1
v_add_u32 v19, 163136, v19
L_P2_1a_poll:
ds_read_b32 v11, v17 offset:8
s_add_u32 s49, s49, 1
s_waitcnt lgkmcnt(0)
v_readfirstlane_b32 s51, v11
s_cmp_gt_u32 s49, 40000
s_cbranch_scc1 L_P2_1a_go
s_andn2_b32 s51, s50, s51
s_cbranch_scc0 L_P2_1a_go
ds_wrxchg_rtn_b32 v11, v19, v18
s_waitcnt lgkmcnt(0)
v_readfirstlane_b32 s51, v11
s_nop 2
s_cmp_eq_u32 s51, 0
s_cbranch_scc1 L_P2_1a_pl
s_sleep 2
s_branch L_P2_1a_poll
L_P2_1a_pl:
buffer_load_dword v21, v10, s[24:27], s48 offen sc1
s_waitcnt vmcnt(0)
v_cmp_eq_u32 vcc, v16, v21
s_add_u32 s49, s49, 1
s_nop 0
v_mov_b32 v20, vcc_lo
ds_write_b32 v17, v20 offset:8
s_andn2_b32 s51, s50, vcc_lo
s_cbranch_scc0 L_P2_1a_rel
s_sleep 10
s_cmp_gt_u32 s49, 40000
s_cbranch_scc0 L_P2_1a_pl
L_P2_1a_rel:
v_mov_b32 v20, 0
ds_write_b32 v19, v20
L_P2_1a_go:
s_waitcnt vmcnt(0) lgkmcnt(0)
buffer_load_dwordx4 v[80:83], v92, s[24:27], s73 offen sc1
buffer_load_dwordx4 v[84:87], v92, s[24:27], s73 offen offset:1024 sc1
buffer_load_dwordx4 v[88:91], v92, s[24:27], s73 offen offset:2048 sc1
buffer_load_dwordx4 v[96:99], v92, s[24:27], s73 offen offset:3072 sc1
buffer_load_dwordx4 v[100:103], v92, s[24:27], s72 offen sc1
buffer_load_dwordx4 v[104:107], v92, s[24:27], s72 offen offset:1024 sc1
buffer_load_dwordx4 v[108:111], v92, s[24:27], s72 offen offset:2048 sc1
buffer_load_dwordx4 v[112:115], v92, s[24:27], s72 offen offset:3072 sc1
buffer_load_dwordx4 v[116:119], v92, s[24:27], s71 offen sc1
buffer_load_dwordx4 v[120:123], v92, s[24:27], s71 offen offset:1024 sc1
buffer_load_dwordx4 v[124:127], v92, s[24:27], s71 offen offset:2048 sc1
s_waitcnt vmcnt(10)
v_mfma_f32_16x16x32_bf16 v[16:19], v[240:243], v[80:83], 0
v_mfma_f32_16x16x32_bf16 v[20:23], v[244:247], v[80:83], 0
v_mfma_f32_16x16x32_bf16 v[24:27], v[248:251], v[80:83], 0
v_mfma_f32_16x16x32_bf16 v[28:31], v[252:255], v[80:83], 0
buffer_load_dwordx4 v[80:83], v92, s[24:27], s71 offen offset:3072 sc1
s_waitcnt vmcnt(10)
v_mfma_f32_16x16x32_bf16 v[32:35], v[240:243], v[84:87], 0
v_mfma_f32_16x16x32_bf16 v[36:39], v[244:247], v[84:87], 0
v_mfma_f32_16x16x32_bf16 v[40:43], v[248:251], v[84:87], 0
v_mfma_f32_16x16x32_bf16 v[44:47], v[252:255], v[84:87], 0
buffer_load_dwordx4 v[84:87], v92, s[24:27], s70 offen sc1
s_waitcnt vmcnt(10)
v_mfma_f32_16x16x32_bf16 v[48:51], v[240:243], v[88:91], 0
v_mfma_f32_16x16x32_bf16 v[52:55], v[244:247], v[88:91], 0
v_mfma_f32_16x16x32_bf16 v[56:59], v[248:251], v[88:91], 0
v_mfma_f32_16x16x32_bf16 v[60:63], v[252:255], v[88:91], 0
buffer_load_dwordx4 v[88:91], v92, s[24:27], s70 offen offset:1024 sc1
s_waitcnt vmcnt(10)
v_mfma_f32_16x16x32_bf16 v[64:67], v[240:243], v[96:99], 0
v_mfma_f32_16x16x32_bf16 v[68:71], v[244:247], v[96:99], 0
v_mfma_f32_16x16x32_bf16 v[72:75], v[248:251], v[96:99], 0
v_mfma_f32_16x16x32_bf16 v[76:79], v[252:255], v[96:99], 0
buffer_load_dwordx4 v[96:99], v92, s[24:27], s70 offen offset:2048 sc1
s_waitcnt vmcnt(10)
v_mfma_f32_16x16x32_bf16 v[16:19], v[224:227], v[100:103], v[16:19]
v_mfma_f32_16x16x32_bf16 v[20:23], v[228:231], v[100:103], v[20:23]
v_mfma_f32_16x16x32_bf16 v[24:27], v[232:235], v[100:103], v[24:27]
v_mfma_f32_16x16x32_bf16 v[28:31], v[236:239], v[100:103], v[28:31]
buffer_load_dwordx4 v[100:103], v92, s[24:27], s70 offen offset:3072 sc1
ds_read_b64_tr_b16 v[240:241], v6 offset:61440
ds_read_b64_tr_b16 v[242:243], v6 offset:62464
ds_read_b64_tr_b16 v[244:245], v7 offset:61440
ds_read_b64_tr_b16 v[246:247], v7 offset:62464
ds_read_b64_tr_b16 v[248:249], v8 offset:61440
ds_read_b64_tr_b16 v[250:251], v8 offset:62464
ds_read_b64_tr_b16 v[252:253], v9 offset:61440
ds_read_b64_tr_b16 v[254:255], v9 offset:62464
s_waitcnt vmcnt(10)
v_mfma_f32_16x16x32_bf16 v[32:35], v[224:227], v[104:107], v[32:35]
v_mfma_f32_16x16x32_bf16 v[36:39], v[228:231], v[104:107], v[36:39]
v_mfma_f32_16x16x32_bf16 v[40:43], v[232:235], v[104:107], v[40:43]
v_mfma_f32_16x16x32_bf16 v[44:47], v[236:239], v[104:107], v[44:47]
buffer_load_dwordx4 v[104:107], v92, s[24:27], s69 offen sc1
s_waitcnt vmcnt(10)
v_mfma_f32_16x16x32_bf16 v[48:51], v[224:227], v[108:111], v[48:51]
v_mfma_f32_16x16x32_bf16 v[52:55], v[228:231], v[108:111], v[52:55]
v_mfma_f32_16x16x32_bf16 v[56:59], v[232:235], v[108:111], v[56:59]
v_mfma_f32_16x16x32_bf16 v[60:63], v[236:239], v[108:111], v[60:63]
buffer_load_dwordx4 v[108:111], v92, s[24:27], s69 offen offset:1024 sc1
s_waitcnt lgkmcnt(0)
s_add_u32 m0, s86, 61440
s_nop 0
buffer_load_dwordx4 v4, s[28:31], s76 offen lds
s_add_u32 m0, s86, 62464
s_add_u32 s46, s76, 8192
buffer_load_dwordx4 v4, s[28:31], s46 offen lds
s_add_u32 m0, s86, 63488
s_nop 0
buffer_load_dwordx4 v5, s[28:31], s76 offen lds
s_add_u32 m0, s86, 64512
s_add_u32 s46, s76, 8192
buffer_load_dwordx4 v5, s[28:31], s46 offen lds
s_lshr_b32 s76, s76, 3
s_add_u32 s76, s76, s60
s_waitcnt vmcnt(14)
v_mfma_f32_16x16x32_bf16 v[64:67], v[224:227], v[112:115], v[64:67]
v_mfma_f32_16x16x32_bf16 v[68:71], v[228:231], v[112:115], v[68:71]
v_mfma_f32_16x16x32_bf16 v[72:75], v[232:235], v[112:115], v[72:75]
v_mfma_f32_16x16x32_bf16 v[76:79], v[236:239], v[112:115], v[76:79]
buffer_load_dwordx4 v[112:115], v92, s[24:27], s69 offen offset:2048 sc1
s_waitcnt vmcnt(14)
v_mfma_f32_16x16x32_bf16 v[16:19], v[208:211], v[116:119], v[16:19]
v_mfma_f32_16x16x32_bf16 v[20:23], v[212:215], v[116:119], v[20:23]
v_mfma_f32_16x16x32_bf16 v[24:27], v[216:219], v[116:119], v[24:27]
v_mfma_f32_16x16x32_bf16 v[28:31], v[220:223], v[116:119], v[28:31]
buffer_load_dwordx4 v[116:119], v92, s[24:27], s69 offen offset:3072 sc1
v_add_u32 v12, 139264, v6
ds_read_b64_tr_b16 v[224:225], v12
ds_read_b64_tr_b16 v[226:227], v12 offset:1024
v_add_u32 v13, 139264, v7
ds_read_b64_tr_b16 v[228:229], v13
ds_read_b64_tr_b16 v[230:231], v13 offset:1024
v_add_u32 v14, 139264, v8
ds_read_b64_tr_b16 v[232:233], v14
ds_read_b64_tr_b16 v[234:235], v14 offset:1024
v_add_u32 v15, 139264, v9
ds_read_b64_tr_b16 v[236:237], v15
ds_read_b64_tr_b16 v[238:239], v15 offset:1024
s_waitcnt vmcnt(14)
v_mfma_f32_16x16x32_bf16 v[32:35], v[208:211], v[120:123], v[32:35]
v_mfma_f32_16x16x32_bf16 v[36:39], v[212:215], v[120:123], v[36:39]
v_mfma_f32_16x16x32_bf16 v[40:43], v[216:219], v[120:123], v[40:43]
v_mfma_f32_16x16x32_bf16 v[44:47], v[220:223], v[120:123], v[44:47]
buffer_load_dwordx4 v[120:123], v92, s[24:27], s68 offen sc1
s_waitcnt vmcnt(14)
v_mfma_f32_16x16x32_bf16 v[48:51], v[208:211], v[124:127], v[48:51]
v_mfma_f32_16x16x32_bf16 v[52:55], v[212:215], v[124:127], v[52:55]
v_mfma_f32_16x16x32_bf16 v[56:59], v[216:219], v[124:127], v[56:59]
v_mfma_f32_16x16x32_bf16 v[60:63], v[220:223], v[124:127], v[60:63]
buffer_load_dwordx4 v[124:127], v92, s[24:27], s68 offen offset:1024 sc1
s_waitcnt lgkmcnt(0)
s_add_u32 m0, s86, 139264
s_nop 0
buffer_load_dwordx4 v4, s[28:31], s77 offen lds
s_add_u32 m0, s86, 140288
s_add_u32 s46, s77, 8192
buffer_load_dwordx4 v4, s[28:31], s46 offen lds
s_add_u32 m0, s86, 141312
s_nop 0
buffer_load_dwordx4 v5, s[28:31], s77 offen lds
s_add_u32 m0, s86, 142336
s_add_u32 s46, s77, 8192
buffer_load_dwordx4 v5, s[28:31], s46 offen lds
s_lshr_b32 s77, s77, 3
s_add_u32 s77, s77, s60
s_waitcnt vmcnt(18)
v_mfma_f32_16x16x32_bf16 v[64:67], v[208:211], v[80:83], v[64:67]
v_mfma_f32_16x16x32_bf16 v[68:71], v[212:215], v[80:83], v[68:71]
v_mfma_f32_16x16x32_bf16 v[72:75], v[216:219], v[80:83], v[72:75]
v_mfma_f32_16x16x32_bf16 v[76:79], v[220:223], v[80:83], v[76:79]
buffer_load_dwordx4 v[80:83], v92, s[24:27], s68 offen offset:2048 sc1
s_waitcnt vmcnt(18)
v_mfma_f32_16x16x32_bf16 v[16:19], v[192:195], v[84:87], v[16:19]
v_mfma_f32_16x16x32_bf16 v[20:23], v[196:199], v[84:87], v[20:23]
v_mfma_f32_16x16x32_bf16 v[24:27], v[200:203], v[84:87], v[24:27]
v_mfma_f32_16x16x32_bf16 v[28:31], v[204:207], v[84:87], v[28:31]
buffer_load_dwordx4 v[84:87], v92, s[24:27], s68 offen offset:3072 sc1
v_add_u32 v12, 120832, v6
ds_read_b64_tr_b16 v[208:209], v12
ds_read_b64_tr_b16 v[210:211], v12 offset:1024
v_add_u32 v13, 120832, v7
ds_read_b64_tr_b16 v[212:213], v13
ds_read_b64_tr_b16 v[214:215], v13 offset:1024
v_add_u32 v14, 120832, v8
ds_read_b64_tr_b16 v[216:217], v14
ds_read_b64_tr_b16 v[218:219], v14 offset:1024
v_add_u32 v15, 120832, v9
ds_read_b64_tr_b16 v[220:221], v15
ds_read_b64_tr_b16 v[222:223], v15 offset:1024
s_waitcnt vmcnt(18)
v_mfma_f32_16x16x32_bf16 v[32:35], v[192:195], v[88:91], v[32:35]
v_mfma_f32_16x16x32_bf16 v[36:39], v[196:199], v[88:91], v[36:39]
v_mfma_f32_16x16x32_bf16 v[40:43], v[200:203], v[88:91], v[40:43]
v_mfma_f32_16x16x32_bf16 v[44:47], v[204:207], v[88:91], v[44:47]
buffer_load_dwordx4 v[88:91], v92, s[24:27], s67 offen sc1
s_waitcnt vmcnt(18)
v_mfma_f32_16x16x32_bf16 v[48:51], v[192:195], v[96:99], v[48:51]
v_mfma_f32_16x16x32_bf16 v[52:55], v[196:199], v[96:99], v[52:55]
v_mfma_f32_16x16x32_bf16 v[56:59], v[200:203], v[96:99], v[56:59]
v_mfma_f32_16x16x32_bf16 v[60:63], v[204:207], v[96:99], v[60:63]
buffer_load_dwordx4 v[96:99], v92, s[24:27], s67 offen offset:1024 sc1
s_waitcnt vmcnt(18)
v_mfma_f32_16x16x32_bf16 v[64:67], v[192:195], v[100:103], v[64:67]
v_mfma_f32_16x16x32_bf16 v[68:71], v[196:199], v[100:103], v[68:71]
v_mfma_f32_16x16x32_bf16 v[72:75], v[200:203], v[100:103], v[72:75]
v_mfma_f32_16x16x32_bf16 v[76:79], v[204:207], v[100:103], v[76:79]
buffer_load_dwordx4 v[100:103], v92, s[24:27], s67 offen offset:2048 sc1
s_waitcnt vmcnt(18)
v_mfma_f32_16x16x32_bf16 v[16:19], v[176:179], v[104:107], v[16:19]
v_mfma_f32_16x16x32_bf16 v[20:23], v[180:183], v[104:107], v[20:23]
v_mfma_f32_16x16x32_bf16 v[24:27], v[184:187], v[104:107], v[24:27]
v_mfma_f32_16x16x32_bf16 v[28:31], v[188:191], v[104:107], v[28:31]
buffer_load_dwordx4 v[104:107], v92, s[24:27], s67 offen offset:3072 sc1
v_add_u32 v12, 83968, v6
ds_read_b64_tr_b16 v[192:193], v12
ds_read_b64_tr_b16 v[194:195], v12 offset:1024
v_add_u32 v13, 83968, v7
ds_read_b64_tr_b16 v[196:197], v13
ds_read_b64_tr_b16 v[198:199], v13 offset:1024
v_add_u32 v14, 83968, v8
ds_read_b64_tr_b16 v[200:201], v14
ds_read_b64_tr_b16 v[202:203], v14 offset:1024
v_add_u32 v15, 83968, v9
ds_read_b64_tr_b16 v[204:205], v15
ds_read_b64_tr_b16 v[206:207], v15 offset:1024
s_waitcnt vmcnt(18)
v_mfma_f32_16x16x32_bf16 v[32:35], v[176:179], v[108:111], v[32:35]
v_mfma_f32_16x16x32_bf16 v[36:39], v[180:183], v[108:111], v[36:39]
v_mfma_f32_16x16x32_bf16 v[40:43], v[184:187], v[108:111], v[40:43]
v_mfma_f32_16x16x32_bf16 v[44:47], v[188:191], v[108:111], v[44:47]
buffer_load_dwordx4 v[108:111], v92, s[24:27], s66 offen sc1
s_waitcnt vmcnt(14)
v_mfma_f32_16x16x32_bf16 v[48:51], v[176:179], v[112:115], v[48:51]
v_mfma_f32_16x16x32_bf16 v[52:55], v[180:183], v[112:115], v[52:55]
v_mfma_f32_16x16x32_bf16 v[56:59], v[184:187], v[112:115], v[56:59]
v_mfma_f32_16x16x32_bf16 v[60:63], v[188:191], v[112:115], v[60:63]
buffer_load_dwordx4 v[112:115], v92, s[24:27], s66 offen offset:1024 sc1
s_waitcnt vmcnt(14)
v_mfma_f32_16x16x32_bf16 v[64:67], v[176:179], v[116:119], v[64:67]
v_mfma_f32_16x16x32_bf16 v[68:71], v[180:183], v[116:119], v[68:71]
v_mfma_f32_16x16x32_bf16 v[72:75], v[184:187], v[116:119], v[72:75]
v_mfma_f32_16x16x32_bf16 v[76:79], v[188:191], v[116:119], v[76:79]
buffer_load_dwordx4 v[116:119], v92, s[24:27], s66 offen offset:2048 sc1
s_waitcnt vmcnt(14)
v_mfma_f32_16x16x32_bf16 v[16:19], v[160:163], v[120:123], v[16:19]
v_mfma_f32_16x16x32_bf16 v[20:23], v[164:167], v[120:123], v[20:23]
v_mfma_f32_16x16x32_bf16 v[24:27], v[168:171], v[120:123], v[24:27]
v_mfma_f32_16x16x32_bf16 v[28:31], v[172:175], v[120:123], v[28:31]
buffer_load_dwordx4 v[120:123], v92, s[24:27], s66 offen offset:3072 sc1
s_waitcnt vmcnt(14)
v_mfma_f32_16x16x32_bf16 v[32:35], v[160:163], v[124:127], v[32:35]
v_mfma_f32_16x16x32_bf16 v[36:39], v[164:167], v[124:127], v[36:39]
v_mfma_f32_16x16x32_bf16 v[40:43], v[168:171], v[124:127], v[40:43]
v_mfma_f32_16x16x32_bf16 v[44:47], v[172:175], v[124:127], v[44:47]
s_waitcnt vmcnt(9)
v_mfma_f32_16x16x32_bf16 v[48:51], v[160:163], v[80:83], v[48:51]
v_mfma_f32_16x16x32_bf16 v[52:55], v[164:167], v[80:83], v[52:55]
v_mfma_f32_16x16x32_bf16 v[56:59], v[168:171], v[80:83], v[56:59]
v_mfma_f32_16x16x32_bf16 v[60:63], v[172:175], v[80:83], v[60:63]
s_waitcnt vmcnt(18)
ds_read_b64_tr_b16 v[176:177], v6 offset:61440
ds_read_b64_tr_b16 v[178:179], v6 offset:62464
ds_read_b64_tr_b16 v[180:181], v7 offset:61440
ds_read_b64_tr_b16 v[182:183], v7 offset:62464
ds_read_b64_tr_b16 v[184:185], v8 offset:61440
ds_read_b64_tr_b16 v[186:187], v8 offset:62464
ds_read_b64_tr_b16 v[188:189], v9 offset:61440
ds_read_b64_tr_b16 v[190:191], v9 offset:62464
s_waitcnt vmcnt(8)
v_mfma_f32_16x16x32_bf16 v[64:67], v[160:163], v[84:87], v[64:67]
v_mfma_f32_16x16x32_bf16 v[68:71], v[164:167], v[84:87], v[68:71]
v_mfma_f32_16x16x32_bf16 v[72:75], v[168:171], v[84:87], v[72:75]
v_mfma_f32_16x16x32_bf16 v[76:79], v[172:175], v[84:87], v[76:79]
s_waitcnt vmcnt(7)
v_mfma_f32_16x16x32_bf16 v[16:19], v[144:147], v[88:91], v[16:19]
v_mfma_f32_16x16x32_bf16 v[20:23], v[148:151], v[88:91], v[20:23]
v_mfma_f32_16x16x32_bf16 v[24:27], v[152:155], v[88:91], v[24:27]
v_mfma_f32_16x16x32_bf16 v[28:31], v[156:159], v[88:91], v[28:31]
s_waitcnt vmcnt(6)
v_mfma_f32_16x16x32_bf16 v[32:35], v[144:147], v[96:99], v[32:35]
v_mfma_f32_16x16x32_bf16 v[36:39], v[148:151], v[96:99], v[36:39]
v_mfma_f32_16x16x32_bf16 v[40:43], v[152:155], v[96:99], v[40:43]
v_mfma_f32_16x16x32_bf16 v[44:47], v[156:159], v[96:99], v[44:47]
s_waitcnt vmcnt(10)
v_add_u32 v12, 139264, v6
ds_read_b64_tr_b16 v[160:161], v12
ds_read_b64_tr_b16 v[162:163], v12 offset:1024
v_add_u32 v13, 139264, v7
ds_read_b64_tr_b16 v[164:165], v13
ds_read_b64_tr_b16 v[166:167], v13 offset:1024
v_add_u32 v14, 139264, v8
ds_read_b64_tr_b16 v[168:169], v14
ds_read_b64_tr_b16 v[170:171], v14 offset:1024
v_add_u32 v15, 139264, v9
ds_read_b64_tr_b16 v[172:173], v15
ds_read_b64_tr_b16 v[174:175], v15 offset:1024
s_waitcnt vmcnt(5)
v_mfma_f32_16x16x32_bf16 v[48:51], v[144:147], v[100:103], v[48:51]
v_mfma_f32_16x16x32_bf16 v[52:55], v[148:151], v[100:103], v[52:55]
v_mfma_f32_16x16x32_bf16 v[56:59], v[152:155], v[100:103], v[56:59]
v_mfma_f32_16x16x32_bf16 v[60:63], v[156:159], v[100:103], v[60:63]
s_waitcnt vmcnt(4)
v_mfma_f32_16x16x32_bf16 v[64:67], v[144:147], v[104:107], v[64:67]
v_mfma_f32_16x16x32_bf16 v[68:71], v[148:151], v[104:107], v[68:71]
v_mfma_f32_16x16x32_bf16 v[72:75], v[152:155], v[104:107], v[72:75]
v_mfma_f32_16x16x32_bf16 v[76:79], v[156:159], v[104:107], v[76:79]
v_add_u32 v11, 162496, v10
ds_read_b32 v4, v11
buffer_load_dword v5, v10, s[24:27], s48 offen sc1
s_waitcnt vmcnt(4)
v_mfma_f32_16x16x32_bf16 v[16:19], v[128:131], v[108:111], v[16:19]
v_mfma_f32_16x16x32_bf16 v[20:23], v[132:135], v[108:111], v[20:23]
v_mfma_f32_16x16x32_bf16 v[24:27], v[136:139], v[108:111], v[24:27]
v_mfma_f32_16x16x32_bf16 v[28:31], v[140:143], v[108:111], v[28:31]
s_waitcnt vmcnt(3)
v_mfma_f32_16x16x32_bf16 v[32:35], v[128:131], v[112:115], v[32:35]
v_mfma_f32_16x16x32_bf16 v[36:39], v[132:135], v[112:115], v[36:39]
v_mfma_f32_16x16x32_bf16 v[40:43], v[136:139], v[112:115], v[40:43]
v_mfma_f32_16x16x32_bf16 v[44:47], v[140:143], v[112:115], v[44:47]
s_waitcnt vmcnt(2)
v_mfma_f32_16x16x32_bf16 v[48:51], v[128:131], v[116:119], v[48:51]
v_mfma_f32_16x16x32_bf16 v[52:55], v[132:135], v[116:119], v[52:55]
v_mfma_f32_16x16x32_bf16 v[56:59], v[136:139], v[116:119], v[56:59]
v_mfma_f32_16x16x32_bf16 v[60:63], v[140:143], v[116:119], v[60:63]
s_waitcnt vmcnt(1)
v_mfma_f32_16x16x32_bf16 v[64:67], v[128:131], v[120:123], v[64:67]
v_mfma_f32_16x16x32_bf16 v[68:71], v[132:135], v[120:123], v[68:71]
v_mfma_f32_16x16x32_bf16 v[72:75], v[136:139], v[120:123], v[72:75]
v_mfma_f32_16x16x32_bf16 v[76:79], v[140:143], v[120:123], v[76:79]
s_mov_b32 s50, s56
s_waitcnt vmcnt(0) lgkmcnt(0)
v_cmp_eq_u32 vcc, v4, v5
s_nop 4
s_andn2_b32 s51, s50, vcc_lo
s_cbranch_scc0 L_P2_1b_go
v_and_b32 v10, 31, v1
v_lshlrev_b32 v10, 2, v10
v_add_u32 v11, 162496, v10
ds_read_b32 v80, v11
s_mov_b32 s49, 0
v_mov_b32 v81, 162048
v_mov_b32 v82, 1
v_lshlrev_b32_e64 v83, 2, v1
v_add_u32 v83, 163136, v83
L_P2_1b_poll:
ds_read_b32 v11, v81 offset:8
s_add_u32 s49, s49, 1
s_waitcnt lgkmcnt(0)
v_readfirstlane_b32 s51, v11
s_cmp_gt_u32 s49, 40000
s_cbranch_scc1 L_P2_1b_go
s_andn2_b32 s51, s50, s51
s_cbranch_scc0 L_P2_1b_go
ds_wrxchg_rtn_b32 v11, v83, v82
s_waitcnt lgkmcnt(0)
v_readfirstlane_b32 s51, v11
s_nop 2
s_cmp_eq_u32 s51, 0
s_cbranch_scc1 L_P2_1b_pl
s_sleep 2
s_branch L_P2_1b_poll
L_P2_1b_pl:
buffer_load_dword v85, v10, s[24:27], s48 offen sc1
s_waitcnt vmcnt(0)
v_cmp_eq_u32 vcc, v80, v85
s_add_u32 s49, s49, 1
s_nop 0
v_mov_b32 v84, vcc_lo
ds_write_b32 v81, v84 offset:8
s_andn2_b32 s51, s50, vcc_lo
s_cbranch_scc0 L_P2_1b_rel
s_sleep 10
s_cmp_gt_u32 s49, 40000
s_cbranch_scc0 L_P2_1b_pl
L_P2_1b_rel:
v_mov_b32 v84, 0
ds_write_b32 v83, v84
L_P2_1b_go:
s_waitcnt vmcnt(0) lgkmcnt(0)
buffer_load_dwordx4 v[96:99], v92, s[24:27], s65 offen sc1
buffer_load_dwordx4 v[100:103], v92, s[24:27], s64 offen sc1
buffer_load_dwordx4 v[104:107], v92, s[24:27], s74 offen sc1
buffer_load_dwordx4 v[108:111], v92, s[24:27], s75 offen sc1
buffer_load_dwordx4 v[112:115], v92, s[24:27], s76 offen sc1
buffer_load_dwordx4 v[116:119], v92, s[24:27], s77 offen sc1
buffer_load_dwordx4 v[120:123], v92, s[24:27], s65 offen offset:1024 sc1
buffer_load_dwordx4 v[124:127], v92, s[24:27], s64 offen offset:1024 sc1
buffer_load_dwordx4 v[128:131], v92, s[24:27], s74 offen offset:1024 sc1
buffer_load_dwordx4 v[132:135], v92, s[24:27], s75 offen offset:1024 sc1
buffer_load_dwordx4 v[136:139], v92, s[24:27], s76 offen offset:1024 sc1
buffer_load_dwordx4 v[140:143], v92, s[24:27], s77 offen offset:1024 sc1
buffer_load_dwordx4 v[144:147], v92, s[24:27], s65 offen offset:2048 sc1
buffer_load_dwordx4 v[148:151], v92, s[24:27], s64 offen offset:2048 sc1
buffer_load_dwordx4 v[152:155], v92, s[24:27], s74 offen offset:2048 sc1
buffer_load_dwordx4 v[156:159], v92, s[24:27], s75 offen offset:2048 sc1
s_waitcnt vmcnt(15)
v_mfma_f32_16x16x32_bf16 v[16:19], v[240:243], v[96:99], v[16:19]
v_mfma_f32_16x16x32_bf16 v[20:23], v[244:247], v[96:99], v[20:23]
v_mfma_f32_16x16x32_bf16 v[24:27], v[248:251], v[96:99], v[24:27]
v_mfma_f32_16x16x32_bf16 v[28:31], v[252:255], v[96:99], v[28:31]
buffer_load_dwordx4 v[96:99], v92, s[24:27], s76 offen offset:2048 sc1
s_waitcnt vmcnt(15)
v_mfma_f32_16x16x32_bf16 v[16:19], v[224:227], v[100:103], v[16:19]
v_mfma_f32_16x16x32_bf16 v[20:23], v[228:231], v[100:103], v[20:23]
v_mfma_f32_16x16x32_bf16 v[24:27], v[232:235], v[100:103], v[24:27]
v_mfma_f32_16x16x32_bf16 v[28:31], v[236:239], v[100:103], v[28:31]
buffer_load_dwordx4 v[100:103], v92, s[24:27], s77 offen offset:2048 sc1
s_waitcnt vmcnt(15)
v_mfma_f32_16x16x32_bf16 v[16:19], v[208:211], v[104:107], v[16:19]
v_mfma_f32_16x16x32_bf16 v[20:23], v[212:215], v[104:107], v[20:23]
v_mfma_f32_16x16x32_bf16 v[24:27], v[216:219], v[104:107], v[24:27]
v_mfma_f32_16x16x32_bf16 v[28:31], v[220:223], v[104:107], v[28:31]
buffer_load_dwordx4 v[104:107], v92, s[24:27], s65 offen offset:3072 sc1
s_waitcnt vmcnt(15)
v_mfma_f32_16x16x32_bf16 v[16:19], v[192:195], v[108:111], v[16:19]
v_mfma_f32_16x16x32_bf16 v[20:23], v[196:199], v[108:111], v[20:23]
v_mfma_f32_16x16x32_bf16 v[24:27], v[200:203], v[108:111], v[24:27]
v_mfma_f32_16x16x32_bf16 v[28:31], v[204:207], v[108:111], v[28:31]
buffer_load_dwordx4 v[108:111], v92, s[24:27], s64 offen offset:3072 sc1
s_waitcnt vmcnt(15)
v_mfma_f32_16x16x32_bf16 v[16:19], v[176:179], v[112:115], v[16:19]
v_mfma_f32_16x16x32_bf16 v[20:23], v[180:183], v[112:115], v[20:23]
v_mfma_f32_16x16x32_bf16 v[24:27], v[184:187], v[112:115], v[24:27]
v_mfma_f32_16x16x32_bf16 v[28:31], v[188:191], v[112:115], v[28:31]
buffer_load_dwordx4 v[112:115], v92, s[24:27], s74 offen offset:3072 sc1
s_waitcnt vmcnt(15)
v_mfma_f32_16x16x32_bf16 v[16:19], v[160:163], v[116:119], v[16:19]
v_mfma_f32_16x16x32_bf16 v[20:23], v[164:167], v[116:119], v[20:23]
v_mfma_f32_16x16x32_bf16 v[24:27], v[168:171], v[116:119], v[24:27]
v_mfma_f32_16x16x32_bf16 v[28:31], v[172:175], v[116:119], v[28:31]
buffer_load_dwordx4 v[116:119], v92, s[24:27], s75 offen offset:3072 sc1
s_waitcnt vmcnt(15)
v_mfma_f32_16x16x32_bf16 v[32:35], v[240:243], v[120:123], v[32:35]
v_mfma_f32_16x16x32_bf16 v[36:39], v[244:247], v[120:123], v[36:39]
v_mfma_f32_16x16x32_bf16 v[40:43], v[248:251], v[120:123], v[40:43]
v_mfma_f32_16x16x32_bf16 v[44:47], v[252:255], v[120:123], v[44:47]
buffer_load_dwordx4 v[120:123], v92, s[24:27], s76 offen offset:3072 sc1
s_waitcnt vmcnt(15)
v_mfma_f32_16x16x32_bf16 v[32:35], v[224:227], v[124:127], v[32:35]
v_mfma_f32_16x16x32_bf16 v[36:39], v[228:231], v[124:127], v[36:39]
v_mfma_f32_16x16x32_bf16 v[40:43], v[232:235], v[124:127], v[40:43]
v_mfma_f32_16x16x32_bf16 v[44:47], v[236:239], v[124:127], v[44:47]
buffer_load_dwordx4 v[124:127], v92, s[24:27], s77 offen offset:3072 sc1
s_waitcnt vmcnt(15)
v_mfma_f32_16x16x32_bf16 v[32:35], v[208:211], v[128:131], v[32:35]
v_mfma_f32_16x16x32_bf16 v[36:39], v[212:215], v[128:131], v[36:39]
v_mfma_f32_16x16x32_bf16 v[40:43], v[216:219], v[128:131], v[40:43]
v_mfma_f32_16x16x32_bf16 v[44:47], v[220:223], v[128:131], v[44:47]
v_add_u32 v10, 61440, v94
v_add_u32 v11, 61440, v95
ds_write_b128 v10, v[16:19] offset:0
ds_write_b128 v11, v[20:23] offset:0
ds_write_b128 v10, v[24:27] offset:128
ds_write_b128 v11, v[28:31] offset:128
ds_inc_u32 v93, v95 offset:0
s_waitcnt vmcnt(14)
v_mfma_f32_16x16x32_bf16 v[32:35], v[192:195], v[132:135], v[32:35]
v_mfma_f32_16x16x32_bf16 v[36:39], v[196:199], v[132:135], v[36:39]
v_mfma_f32_16x16x32_bf16 v[40:43], v[200:203], v[132:135], v[40:43]
v_mfma_f32_16x16x32_bf16 v[44:47], v[204:207], v[132:135], v[44:47]
v_lshlrev_b32 v4, 10, v2
v_lshl_add_u32 v4, v3, 3, v4
s_lshl_b32 s51, s84, 16
s_lshl_b32 s55, s85, 7
s_add_u32 s51, s51, s55
s_add_u32 s51, s51, s86
v_add_u32 v4, s51, v4
s_mov_b32 s55, 49152
buffer_load_dwordx2 v[12:13], v4, s[4:7], s55 offen
v_lshl_add_u32 v6, s42, 2, v2
v_and_b32 v7, 7, v6
v_xor_b32 v7, v7, v3
v_lshlrev_b32_e64 v7, 4, v7
v_lshl_add_u32 v6, v6, 8, v7
v_mov_b32 v7, 162064
s_waitcnt vmcnt(14)
v_mfma_f32_16x16x32_bf16 v[32:35], v[176:179], v[136:139], v[32:35]
v_mfma_f32_16x16x32_bf16 v[36:39], v[180:183], v[136:139], v[36:39]
v_mfma_f32_16x16x32_bf16 v[40:43], v[184:187], v[136:139], v[40:43]
v_mfma_f32_16x16x32_bf16 v[44:47], v[188:191], v[136:139], v[44:47]
s_waitcnt vmcnt(13)
v_mfma_f32_16x16x32_bf16 v[32:35], v[160:163], v[140:143], v[32:35]
v_mfma_f32_16x16x32_bf16 v[36:39], v[164:167], v[140:143], v[36:39]
v_mfma_f32_16x16x32_bf16 v[40:43], v[168:171], v[140:143], v[40:43]
v_mfma_f32_16x16x32_bf16 v[44:47], v[172:175], v[140:143], v[44:47]
s_waitcnt vmcnt(12)
v_mfma_f32_16x16x32_bf16 v[48:51], v[240:243], v[144:147], v[48:51]
v_mfma_f32_16x16x32_bf16 v[52:55], v[244:247], v[144:147], v[52:55]
v_mfma_f32_16x16x32_bf16 v[56:59], v[248:251], v[144:147], v[56:59]
v_mfma_f32_16x16x32_bf16 v[60:63], v[252:255], v[144:147], v[60:63]
s_waitcnt vmcnt(11)
v_mfma_f32_16x16x32_bf16 v[48:51], v[224:227], v[148:151], v[48:51]
v_mfma_f32_16x16x32_bf16 v[52:55], v[228:231], v[148:151], v[52:55]
v_mfma_f32_16x16x32_bf16 v[56:59], v[232:235], v[148:151], v[56:59]
v_mfma_f32_16x16x32_bf16 v[60:63], v[236:239], v[148:151], v[60:63]
s_waitcnt vmcnt(10)
v_mfma_f32_16x16x32_bf16 v[48:51], v[208:211], v[152:155], v[48:51]
v_mfma_f32_16x16x32_bf16 v[52:55], v[212:215], v[152:155], v[52:55]
v_mfma_f32_16x16x32_bf16 v[56:59], v[216:219], v[152:155], v[56:59]
v_mfma_f32_16x16x32_bf16 v[60:63], v[220:223], v[152:155], v[60:63]
v_add_u32 v10, 139264, v94
v_add_u32 v11, 139264, v95
ds_write_b128 v10, v[32:35] offset:0
ds_write_b128 v11, v[36:39] offset:0
ds_write_b128 v10, v[40:43] offset:128
ds_write_b128 v11, v[44:47] offset:128
ds_inc_u32 v93, v95 offset:4
s_waitcnt vmcnt(9)
v_mfma_f32_16x16x32_bf16 v[48:51], v[192:195], v[156:159], v[48:51]
v_mfma_f32_16x16x32_bf16 v[52:55], v[196:199], v[156:159], v[52:55]
v_mfma_f32_16x16x32_bf16 v[56:59], v[200:203], v[156:159], v[56:59]
v_mfma_f32_16x16x32_bf16 v[60:63], v[204:207], v[156:159], v[60:63]
s_waitcnt vmcnt(8)
v_mfma_f32_16x16x32_bf16 v[48:51], v[176:179], v[96:99], v[48:51]
v_mfma_f32_16x16x32_bf16 v[52:55], v[180:183], v[96:99], v[52:55]
v_mfma_f32_16x16x32_bf16 v[56:59], v[184:187], v[96:99], v[56:59]
v_mfma_f32_16x16x32_bf16 v[60:63], v[188:191], v[96:99], v[60:63]
s_waitcnt vmcnt(7)
v_mfma_f32_16x16x32_bf16 v[48:51], v[160:163], v[100:103], v[48:51]
v_mfma_f32_16x16x32_bf16 v[52:55], v[164:167], v[100:103], v[52:55]
v_mfma_f32_16x16x32_bf16 v[56:59], v[168:171], v[100:103], v[56:59]
v_mfma_f32_16x16x32_bf16 v[60:63], v[172:175], v[100:103], v[60:63]
s_waitcnt vmcnt(6)
v_mfma_f32_16x16x32_bf16 v[64:67], v[240:243], v[104:107], v[64:67]
v_mfma_f32_16x16x32_bf16 v[68:71], v[244:247], v[104:107], v[68:71]
v_mfma_f32_16x16x32_bf16 v[72:75], v[248:251], v[104:107], v[72:75]
v_mfma_f32_16x16x32_bf16 v[76:79], v[252:255], v[104:107], v[76:79]
s_waitcnt vmcnt(5)
v_mfma_f32_16x16x32_bf16 v[64:67], v[224:227], v[108:111], v[64:67]
v_mfma_f32_16x16x32_bf16 v[68:71], v[228:231], v[108:111], v[68:71]
v_mfma_f32_16x16x32_bf16 v[72:75], v[232:235], v[108:111], v[72:75]
v_mfma_f32_16x16x32_bf16 v[76:79], v[236:239], v[108:111], v[76:79]
s_waitcnt vmcnt(4)
v_mfma_f32_16x16x32_bf16 v[64:67], v[208:211], v[112:115], v[64:67]
v_mfma_f32_16x16x32_bf16 v[68:71], v[212:215], v[112:115], v[68:71]
v_mfma_f32_16x16x32_bf16 v[72:75], v[216:219], v[112:115], v[72:75]
v_mfma_f32_16x16x32_bf16 v[76:79], v[220:223], v[112:115], v[76:79]
v_add_u32 v10, 120832, v94
v_add_u32 v11, 120832, v95
ds_write_b128 v10, v[48:51] offset:0
ds_write_b128 v11, v[52:55] offset:0
ds_write_b128 v10, v[56:59] offset:128
ds_write_b128 v11, v[60:63] offset:128
ds_inc_u32 v93, v95 offset:8
s_waitcnt vmcnt(3)
v_mfma_f32_16x16x32_bf16 v[64:67], v[192:195], v[116:119], v[64:67]
v_mfma_f32_16x16x32_bf16 v[68:71], v[196:199], v[116:119], v[68:71]
v_mfma_f32_16x16x32_bf16 v[72:75], v[200:203], v[116:119], v[72:75]
v_mfma_f32_16x16x32_bf16 v[76:79], v[204:207], v[116:119], v[76:79]
s_waitcnt vmcnt(2)
v_mfma_f32_16x16x32_bf16 v[64:67], v[176:179], v[120:123], v[64:67]
v_mfma_f32_16x16x32_bf16 v[68:71], v[180:183], v[120:123], v[68:71]
v_mfma_f32_16x16x32_bf16 v[72:75], v[184:187], v[120:123], v[72:75]
v_mfma_f32_16x16x32_bf16 v[76:79], v[188:191], v[120:123], v[76:79]
s_waitcnt vmcnt(1)
v_mfma_f32_16x16x32_bf16 v[64:67], v[160:163], v[124:127], v[64:67]
v_mfma_f32_16x16x32_bf16 v[68:71], v[164:167], v[124:127], v[68:71]
v_mfma_f32_16x16x32_bf16 v[72:75], v[168:171], v[124:127], v[72:75]
v_mfma_f32_16x16x32_bf16 v[76:79], v[172:175], v[124:127], v[76:79]
s_nop 7
v_add_u32 v10, 83968, v94
v_add_u32 v11, 83968, v95
ds_write_b128 v10, v[64:67] offset:0
ds_write_b128 v11, v[68:71] offset:0
ds_write_b128 v10, v[72:75] offset:128
ds_write_b128 v11, v[76:79] offset:128
ds_inc_u32 v93, v95 offset:12
v_add_u32 v10, 83968, v6
v_add_u32 v11, 102400, v6
s_mov_b32 s49, 0
L_fin_w3:
ds_read_b32 v5, v7 offset:12
s_add_u32 s49, s49, 1
s_waitcnt lgkmcnt(0)
v_readfirstlane_b32 s50, v5
s_cmp_gt_u32 s49, 2000000
s_cbranch_scc1 L_fin_g3
s_cmp_ge_u32 s50, 8
s_cbranch_scc1 L_fin_g3
s_sleep 1
s_branch L_fin_w3
L_fin_g3:
ds_read_b128 v[96:99], v10 offset:0
ds_read_b128 v[100:103], v10 offset:4096
ds_read_b128 v[104:107], v10 offset:8192
ds_read_b128 v[108:111], v10 offset:12288
ds_read_b128 v[112:115], v11 offset:0
ds_read_b128 v[116:119], v11 offset:4096
ds_read_b128 v[120:123], v11 offset:8192
ds_read_b128 v[124:127], v11 offset:12288
s_waitcnt lgkmcnt(4)
v_pk_add_f32 v[96:97], v[96:97], v[100:101]
v_pk_add_f32 v[98:99], v[98:99], v[102:103]
v_pk_add_f32 v[104:105], v[104:105], v[108:109]
v_pk_add_f32 v[106:107], v[106:107], v[110:111]
v_pk_add_f32 v[96:97], v[96:97], v[104:105]
v_pk_add_f32 v[98:99], v[98:99], v[106:107]
v_cvt_pk_bf16_f32 v96, v96, v97
v_cvt_pk_bf16_f32 v98, v98, v99
v_and_b32 v97, 0xffff0000, v96
v_lshlrev_b32 v96, 16, v96
v_and_b32 v99, 0xffff0000, v98
v_lshlrev_b32_e64 v98, 16, v98
v_mul_f32 v100, 0xbfb8aa3b, v96
v_mul_f32 v101, 0xbfb8aa3b, v97
v_mul_f32 v102, 0xbfb8aa3b, v98
v_mul_f32 v103, 0xbfb8aa3b, v99
v_exp_f32 v100, v100
v_exp_f32 v101, v101
v_exp_f32 v102, v102
v_exp_f32 v103, v103
s_waitcnt lgkmcnt(0) vmcnt(0)
v_pk_add_f32 v[112:113], v[112:113], v[116:117]
v_pk_add_f32 v[114:115], v[114:115], v[118:119]
v_pk_add_f32 v[120:121], v[120:121], v[124:125]
v_pk_add_f32 v[122:123], v[122:123], v[126:127]
v_pk_add_f32 v[112:113], v[112:113], v[120:121]
v_pk_add_f32 v[114:115], v[114:115], v[122:123]
v_add_f32 v100, 1.0, v100
v_add_f32 v101, 1.0, v101
v_add_f32 v102, 1.0, v102
v_add_f32 v103, 1.0, v103
v_rcp_f32 v100, v100
v_rcp_f32 v101, v101
v_rcp_f32 v102, v102
v_rcp_f32_e64 v103, v103
v_cvt_pk_bf16_f32 v112, v112, v113
v_cvt_pk_bf16_f32 v114, v114, v115
v_and_b32 v113, 0xffff0000, v112
v_lshlrev_b32 v112, 16, v112
v_and_b32 v115, 0xffff0000, v114
v_lshlrev_b32 v114, 16, v114
v_lshlrev_b32 v104, 16, v12
v_and_b32 v105, 0xffff0000, v12
v_lshlrev_b32 v106, 16, v13
v_and_b32 v107, 0xffff0000, v13
v_pk_mul_f32 v[96:97], v[96:97], v[100:101]
v_pk_mul_f32 v[98:99], v[98:99], v[102:103]
v_cvt_pk_bf16_f32 v96, v96, v97
v_cvt_pk_bf16_f32 v98, v98, v99
v_and_b32 v97, 0xffff0000, v96
v_lshlrev_b32 v96, 16, v96
v_and_b32 v99, 0xffff0000, v98
v_lshlrev_b32 v98, 16, v98
v_pk_mul_f32 v[96:97], v[96:97], v[112:113]
v_pk_mul_f32 v[98:99], v[98:99], v[114:115]
v_cvt_pk_bf16_f32 v96, v96, v97
v_cvt_pk_bf16_f32 v98, v98, v99
v_and_b32 v97, 0xffff0000, v96
v_lshlrev_b32 v96, 16, v96
v_and_b32 v99, 0xffff0000, v98
v_lshlrev_b32 v98, 16, v98
v_pk_add_f32 v[96:97], v[96:97], v[104:105]
v_pk_add_f32 v[98:99], v[98:99], v[106:107]
v_cvt_pk_bf16_f32 v134, v96, v97
v_cvt_pk_bf16_f32 v135, v98, v99
s_mov_b32 s48, 49152
buffer_store_dwordx2 v[134:135], v4, s[32:35], s48 offen sc1
s_branch L_P2_fin
.p2align 3
L_P2_0:
s_lshl3_add_u32 s48, s84, s85
s_lshl_b32 s48, s48, 7
s_add_u32 s48, s48, 9805824
s_lshl_b32 s50, s42, 1
s_lshl_b32 s50, 3, s50
s_mul_i32 s51, s84, 294912
s_add_u32 s51, s51, 0
s_mov_b32 s60, s51
s_lshr_b32 s73, s73, 3
s_add_u32 s73, s73, s51
s_lshr_b32 s72, s72, 3
s_add_u32 s72, s72, s51
s_lshr_b32 s71, s71, 3
s_add_u32 s71, s71, s51
s_lshr_b32 s70, s70, 3
s_add_u32 s70, s70, s51
v_lshlrev_b32 v92, 4, v1
v_lshlrev_b32 v93, 2, v1
v_add_u32 v93, 162092, v93
v_mov_b32 v12, 162064
v_cmp_eq_u32 vcc, 0, v1
s_nop 1
v_cndmask_b32 v93, v93, v12, vcc
v_and_b32 v12, 7, v3
v_xor_b32 v12, v12, v2
v_lshlrev_b32 v12, 4, v12
v_lshl_add_u32 v94, v3, 8, v12
v_add_u32 v94, s86, v94
v_xor_b32 v95, 64, v94
v_and_b32 v10, 31, v1
v_lshlrev_b32 v10, 2, v10
v_add_u32 v11, 162496, v10
ds_read_b32 v16, v11
s_mov_b32 s49, 0
v_mov_b32 v17, 162048
v_mov_b32 v18, 1
v_lshlrev_b32_e64 v19, 2, v1
v_add_u32 v19, 163136, v19
L_P2_0a_poll:
ds_read_b32 v11, v17 offset:8
s_add_u32 s49, s49, 1
s_waitcnt lgkmcnt(0)
v_readfirstlane_b32 s51, v11
s_cmp_gt_u32 s49, 40000
s_cbranch_scc1 L_P2_0a_go
s_andn2_b32 s51, s50, s51
s_cbranch_scc0 L_P2_0a_go
ds_wrxchg_rtn_b32 v11, v19, v18
s_waitcnt lgkmcnt(0)
v_readfirstlane_b32 s51, v11
s_nop 2
s_cmp_eq_u32 s51, 0
s_cbranch_scc1 L_P2_0a_pl
s_sleep 2
s_branch L_P2_0a_poll
L_P2_0a_pl:
buffer_load_dword v21, v10, s[24:27], s48 offen sc1
s_waitcnt vmcnt(0)
v_cmp_eq_u32 vcc, v16, v21
s_add_u32 s49, s49, 1
s_nop 0
v_mov_b32 v20, vcc_lo
ds_write_b32 v17, v20 offset:8
s_andn2_b32 s51, s50, vcc_lo
s_cbranch_scc0 L_P2_0a_rel
s_sleep 10
s_cmp_gt_u32 s49, 40000
s_cbranch_scc0 L_P2_0a_pl
L_P2_0a_rel:
v_mov_b32 v20, 0
ds_write_b32 v19, v20
L_P2_0a_go:
s_waitcnt vmcnt(0) lgkmcnt(0)
buffer_load_dwordx4 v[96:99], v92, s[24:27], s73 offen sc1
buffer_load_dwordx4 v[100:103], v92, s[24:27], s72 offen sc1
buffer_load_dwordx4 v[104:107], v92, s[24:27], s71 offen sc1
buffer_load_dwordx4 v[108:111], v92, s[24:27], s70 offen sc1
buffer_load_dwordx4 v[112:115], v92, s[24:27], s73 offen offset:1024 sc1
buffer_load_dwordx4 v[116:119], v92, s[24:27], s72 offen offset:1024 sc1
buffer_load_dwordx4 v[120:123], v92, s[24:27], s71 offen offset:1024 sc1
buffer_load_dwordx4 v[124:127], v92, s[24:27], s70 offen offset:1024 sc1
buffer_load_dwordx4 v[128:131], v92, s[24:27], s73 offen offset:2048 sc1
buffer_load_dwordx4 v[132:135], v92, s[24:27], s72 offen offset:2048 sc1
buffer_load_dwordx4 v[136:139], v92, s[24:27], s71 offen offset:2048 sc1
buffer_load_dwordx4 v[140:143], v92, s[24:27], s70 offen offset:2048 sc1
buffer_load_dwordx4 v[144:147], v92, s[24:27], s73 offen offset:3072 sc1
buffer_load_dwordx4 v[148:151], v92, s[24:27], s72 offen offset:3072 sc1
buffer_load_dwordx4 v[152:155], v92, s[24:27], s71 offen offset:3072 sc1
buffer_load_dwordx4 v[156:159], v92, s[24:27], s70 offen offset:3072 sc1
s_waitcnt vmcnt(15)
v_mfma_f32_16x16x32_bf16 v[16:19], v[240:243], v[96:99], 0
v_mfma_f32_16x16x32_bf16 v[20:23], v[244:247], v[96:99], 0
v_mfma_f32_16x16x32_bf16 v[24:27], v[248:251], v[96:99], 0
v_mfma_f32_16x16x32_bf16 v[28:31], v[252:255], v[96:99], 0
s_waitcnt vmcnt(14)
v_mfma_f32_16x16x32_bf16 v[16:19], v[224:227], v[100:103], v[16:19]
v_mfma_f32_16x16x32_bf16 v[20:23], v[228:231], v[100:103], v[20:23]
v_mfma_f32_16x16x32_bf16 v[24:27], v[232:235], v[100:103], v[24:27]
v_mfma_f32_16x16x32_bf16 v[28:31], v[236:239], v[100:103], v[28:31]
s_waitcnt vmcnt(13)
v_mfma_f32_16x16x32_bf16 v[16:19], v[208:211], v[104:107], v[16:19]
v_mfma_f32_16x16x32_bf16 v[20:23], v[212:215], v[104:107], v[20:23]
v_mfma_f32_16x16x32_bf16 v[24:27], v[216:219], v[104:107], v[24:27]
v_mfma_f32_16x16x32_bf16 v[28:31], v[220:223], v[104:107], v[28:31]
s_waitcnt vmcnt(12)
v_mfma_f32_16x16x32_bf16 v[16:19], v[192:195], v[108:111], v[16:19]
v_mfma_f32_16x16x32_bf16 v[20:23], v[196:199], v[108:111], v[20:23]
v_mfma_f32_16x16x32_bf16 v[24:27], v[200:203], v[108:111], v[24:27]
v_mfma_f32_16x16x32_bf16 v[28:31], v[204:207], v[108:111], v[28:31]
s_waitcnt vmcnt(11)
v_mfma_f32_16x16x32_bf16 v[32:35], v[240:243], v[112:115], 0
v_mfma_f32_16x16x32_bf16 v[36:39], v[244:247], v[112:115], 0
v_mfma_f32_16x16x32_bf16 v[40:43], v[248:251], v[112:115], 0
v_mfma_f32_16x16x32_bf16 v[44:47], v[252:255], v[112:115], 0
s_waitcnt vmcnt(10)
v_mfma_f32_16x16x32_bf16 v[32:35], v[224:227], v[116:119], v[32:35]
v_mfma_f32_16x16x32_bf16 v[36:39], v[228:231], v[116:119], v[36:39]
v_mfma_f32_16x16x32_bf16 v[40:43], v[232:235], v[116:119], v[40:43]
v_mfma_f32_16x16x32_bf16 v[44:47], v[236:239], v[116:119], v[44:47]
s_waitcnt vmcnt(9)
v_mfma_f32_16x16x32_bf16 v[32:35], v[208:211], v[120:123], v[32:35]
v_mfma_f32_16x16x32_bf16 v[36:39], v[212:215], v[120:123], v[36:39]
v_mfma_f32_16x16x32_bf16 v[40:43], v[216:219], v[120:123], v[40:43]
v_mfma_f32_16x16x32_bf16 v[44:47], v[220:223], v[120:123], v[44:47]
v_add_u32 v10, 12288, v94
v_add_u32 v11, 12288, v95
ds_write_b128 v10, v[16:19] offset:0
ds_write_b128 v11, v[20:23] offset:0
ds_write_b128 v10, v[24:27] offset:128
ds_write_b128 v11, v[28:31] offset:128
ds_inc_u32 v93, v95 offset:0
s_waitcnt vmcnt(8)
v_mfma_f32_16x16x32_bf16 v[32:35], v[192:195], v[124:127], v[32:35]
v_mfma_f32_16x16x32_bf16 v[36:39], v[196:199], v[124:127], v[36:39]
v_mfma_f32_16x16x32_bf16 v[40:43], v[200:203], v[124:127], v[40:43]
v_mfma_f32_16x16x32_bf16 v[44:47], v[204:207], v[124:127], v[44:47]
s_waitcnt vmcnt(7)
v_mfma_f32_16x16x32_bf16 v[48:51], v[240:243], v[128:131], 0
v_mfma_f32_16x16x32_bf16 v[52:55], v[244:247], v[128:131], 0
v_mfma_f32_16x16x32_bf16 v[56:59], v[248:251], v[128:131], 0
v_mfma_f32_16x16x32_bf16 v[60:63], v[252:255], v[128:131], 0
s_waitcnt vmcnt(6)
v_mfma_f32_16x16x32_bf16 v[48:51], v[224:227], v[132:135], v[48:51]
v_mfma_f32_16x16x32_bf16 v[52:55], v[228:231], v[132:135], v[52:55]
v_mfma_f32_16x16x32_bf16 v[56:59], v[232:235], v[132:135], v[56:59]
v_mfma_f32_16x16x32_bf16 v[60:63], v[236:239], v[132:135], v[60:63]
s_waitcnt vmcnt(5)
v_mfma_f32_16x16x32_bf16 v[48:51], v[208:211], v[136:139], v[48:51]
v_mfma_f32_16x16x32_bf16 v[52:55], v[212:215], v[136:139], v[52:55]
v_mfma_f32_16x16x32_bf16 v[56:59], v[216:219], v[136:139], v[56:59]
v_mfma_f32_16x16x32_bf16 v[60:63], v[220:223], v[136:139], v[60:63]
v_add_u32 v10, 28672, v94
v_add_u32 v11, 28672, v95
ds_write_b128 v10, v[32:35] offset:0
ds_write_b128 v11, v[36:39] offset:0
ds_write_b128 v10, v[40:43] offset:128
ds_write_b128 v11, v[44:47] offset:128
ds_inc_u32 v93, v95 offset:4
s_waitcnt vmcnt(4)
v_mfma_f32_16x16x32_bf16 v[48:51], v[192:195], v[140:143], v[48:51]
v_mfma_f32_16x16x32_bf16 v[52:55], v[196:199], v[140:143], v[52:55]
v_mfma_f32_16x16x32_bf16 v[56:59], v[200:203], v[140:143], v[56:59]
v_mfma_f32_16x16x32_bf16 v[60:63], v[204:207], v[140:143], v[60:63]
s_waitcnt vmcnt(3)
v_mfma_f32_16x16x32_bf16 v[64:67], v[240:243], v[144:147], 0
v_mfma_f32_16x16x32_bf16 v[68:71], v[244:247], v[144:147], 0
v_mfma_f32_16x16x32_bf16 v[72:75], v[248:251], v[144:147], 0
v_mfma_f32_16x16x32_bf16 v[76:79], v[252:255], v[144:147], 0
s_waitcnt vmcnt(2)
v_mfma_f32_16x16x32_bf16 v[64:67], v[224:227], v[148:151], v[64:67]
v_mfma_f32_16x16x32_bf16 v[68:71], v[228:231], v[148:151], v[68:71]
v_mfma_f32_16x16x32_bf16 v[72:75], v[232:235], v[148:151], v[72:75]
v_mfma_f32_16x16x32_bf16 v[76:79], v[236:239], v[148:151], v[76:79]
s_waitcnt vmcnt(1)
v_mfma_f32_16x16x32_bf16 v[64:67], v[208:211], v[152:155], v[64:67]
v_mfma_f32_16x16x32_bf16 v[68:71], v[212:215], v[152:155], v[68:71]
v_mfma_f32_16x16x32_bf16 v[72:75], v[216:219], v[152:155], v[72:75]
v_mfma_f32_16x16x32_bf16 v[76:79], v[220:223], v[152:155], v[76:79]
v_add_u32 v10, 45056, v94
v_add_u32 v11, 45056, v95
ds_write_b128 v10, v[48:51] offset:0
ds_write_b128 v11, v[52:55] offset:0
ds_write_b128 v10, v[56:59] offset:128
ds_write_b128 v11, v[60:63] offset:128
ds_inc_u32 v93, v95 offset:8
s_waitcnt vmcnt(0)
v_mfma_f32_16x16x32_bf16 v[64:67], v[192:195], v[156:159], v[64:67]
v_mfma_f32_16x16x32_bf16 v[68:71], v[196:199], v[156:159], v[68:71]
v_mfma_f32_16x16x32_bf16 v[72:75], v[200:203], v[156:159], v[72:75]
v_mfma_f32_16x16x32_bf16 v[76:79], v[204:207], v[156:159], v[76:79]
v_lshlrev_b32 v4, 10, v2
v_lshl_add_u32 v4, v3, 3, v4
s_lshl_b32 s51, s84, 16
s_lshl_b32 s55, s85, 7
s_add_u32 s51, s51, s55
s_add_u32 s51, s51, s86
v_add_u32 v4, s51, v4
s_mov_b32 s55, 0
buffer_load_dwordx2 v[160:161], v4, s[4:7], s55 offen
s_mov_b32 s55, 16384
buffer_load_dwordx2 v[162:163], v4, s[4:7], s55 offen
s_mov_b32 s55, 32768
buffer_load_dwordx2 v[164:165], v4, s[4:7], s55 offen
v_lshl_add_u32 v6, s42, 2, v2
v_and_b32 v7, 7, v6
v_xor_b32 v7, v7, v3
v_lshlrev_b32 v7, 4, v7
v_lshl_add_u32 v6, v6, 8, v7
v_mov_b32 v7, 162064
v_add_u32 v10, 102400, v94
v_add_u32 v11, 102400, v95
ds_write_b128 v10, v[64:67] offset:0
ds_write_b128 v11, v[68:71] offset:0
ds_write_b128 v10, v[72:75] offset:128
ds_write_b128 v11, v[76:79] offset:128
ds_inc_u32 v93, v95 offset:12
v_add_u32 v10, 61440, v6
v_add_u32 v11, 12288, v6
s_mov_b32 s49, 0
L_fin_w0:
ds_read_b32 v5, v7 offset:0
s_add_u32 s49, s49, 1
s_waitcnt lgkmcnt(0)
v_readfirstlane_b32 s50, v5
s_cmp_gt_u32 s49, 2000000
s_cbranch_scc1 L_fin_g0
s_cmp_ge_u32 s50, 8
s_cbranch_scc1 L_fin_g0
s_sleep 1
s_branch L_fin_w0
L_fin_g0:
ds_read_b128 v[96:99], v10 offset:0
ds_read_b128 v[100:103], v10 offset:4096
ds_read_b128 v[104:107], v10 offset:8192
ds_read_b128 v[108:111], v10 offset:12288
ds_read_b128 v[112:115], v11 offset:0
ds_read_b128 v[116:119], v11 offset:4096
ds_read_b128 v[120:123], v11 offset:8192
ds_read_b128 v[124:127], v11 offset:12288
s_waitcnt lgkmcnt(4)
v_pk_add_f32 v[96:97], v[96:97], v[100:101]
v_pk_add_f32 v[98:99], v[98:99], v[102:103]
v_pk_add_f32 v[104:105], v[104:105], v[108:109]
v_pk_add_f32 v[106:107], v[106:107], v[110:111]
v_pk_add_f32 v[96:97], v[96:97], v[104:105]
v_pk_add_f32 v[98:99], v[98:99], v[106:107]
v_cvt_pk_bf16_f32 v96, v96, v97
v_cvt_pk_bf16_f32 v98, v98, v99
v_and_b32 v97, 0xffff0000, v96
v_lshlrev_b32 v96, 16, v96
v_and_b32 v99, 0xffff0000, v98
v_lshlrev_b32 v98, 16, v98
v_mul_f32 v100, 0xbfb8aa3b, v96
v_mul_f32 v101, 0xbfb8aa3b, v97
v_mul_f32 v102, 0xbfb8aa3b, v98
v_mul_f32 v103, 0xbfb8aa3b, v99
v_exp_f32 v100, v100
v_exp_f32 v101, v101
v_exp_f32 v102, v102
v_exp_f32 v103, v103
s_waitcnt lgkmcnt(0) vmcnt(0)
v_pk_add_f32 v[112:113], v[112:113], v[116:117]
v_pk_add_f32 v[114:115], v[114:115], v[118:119]
v_pk_add_f32 v[120:121], v[120:121], v[124:125]
v_pk_add_f32 v[122:123], v[122:123], v[126:127]
v_pk_add_f32 v[112:113], v[112:113], v[120:121]
v_pk_add_f32 v[114:115], v[114:115], v[122:123]
v_add_f32 v100, 1.0, v100
v_add_f32 v101, 1.0, v101
v_add_f32 v102, 1.0, v102
v_add_f32 v103, 1.0, v103
v_rcp_f32 v100, v100
v_rcp_f32 v101, v101
v_rcp_f32 v102, v102
v_rcp_f32_e64 v103, v103
v_cvt_pk_bf16_f32 v112, v112, v113
v_cvt_pk_bf16_f32 v114, v114, v115
v_and_b32 v113, 0xffff0000, v112
v_lshlrev_b32 v112, 16, v112
v_and_b32 v115, 0xffff0000, v114
v_lshlrev_b32 v114, 16, v114
v_lshlrev_b32 v104, 16, v160
v_and_b32 v105, 0xffff0000, v160
v_lshlrev_b32 v106, 16, v161
v_and_b32 v107, 0xffff0000, v161
v_pk_mul_f32 v[96:97], v[96:97], v[100:101]
v_pk_mul_f32 v[98:99], v[98:99], v[102:103]
v_cvt_pk_bf16_f32 v96, v96, v97
v_cvt_pk_bf16_f32 v98, v98, v99
v_and_b32 v97, 0xffff0000, v96
v_lshlrev_b32 v96, 16, v96
v_and_b32 v99, 0xffff0000, v98
v_lshlrev_b32 v98, 16, v98
v_pk_mul_f32 v[96:97], v[96:97], v[112:113]
v_pk_mul_f32 v[98:99], v[98:99], v[114:115]
v_cvt_pk_bf16_f32 v96, v96, v97
v_cvt_pk_bf16_f32 v98, v98, v99
v_and_b32 v97, 0xffff0000, v96
v_lshlrev_b32 v96, 16, v96
v_and_b32 v99, 0xffff0000, v98
v_lshlrev_b32 v98, 16, v98
v_pk_add_f32 v[96:97], v[96:97], v[104:105]
v_pk_add_f32 v[98:99], v[98:99], v[106:107]
v_cvt_pk_bf16_f32 v128, v96, v97
v_cvt_pk_bf16_f32 v129, v98, v99
s_mov_b32 s48, 0
buffer_store_dwordx2 v[128:129], v4, s[32:35], s48 offen sc1
v_add_u32 v10, 139264, v6
v_add_u32 v11, 28672, v6
s_mov_b32 s49, 0
L_fin_w1:
ds_read_b32 v5, v7 offset:4
s_add_u32 s49, s49, 1
s_waitcnt lgkmcnt(0)
v_readfirstlane_b32 s50, v5
s_cmp_gt_u32 s49, 2000000
s_cbranch_scc1 L_fin_g1
s_cmp_ge_u32 s50, 8
s_cbranch_scc1 L_fin_g1
s_sleep 1
s_branch L_fin_w1
L_fin_g1:
ds_read_b128 v[96:99], v10 offset:0
ds_read_b128 v[100:103], v10 offset:4096
ds_read_b128 v[104:107], v10 offset:8192
ds_read_b128 v[108:111], v10 offset:12288
ds_read_b128 v[112:115], v11 offset:0
ds_read_b128 v[116:119], v11 offset:4096
ds_read_b128 v[120:123], v11 offset:8192
ds_read_b128 v[124:127], v11 offset:12288
s_waitcnt lgkmcnt(4)
v_pk_add_f32 v[96:97], v[96:97], v[100:101]
v_pk_add_f32 v[98:99], v[98:99], v[102:103]
v_pk_add_f32 v[104:105], v[104:105], v[108:109]
v_pk_add_f32 v[106:107], v[106:107], v[110:111]
v_pk_add_f32 v[96:97], v[96:97], v[104:105]
v_pk_add_f32 v[98:99], v[98:99], v[106:107]
v_cvt_pk_bf16_f32 v96, v96, v97
v_cvt_pk_bf16_f32 v98, v98, v99
v_and_b32 v97, 0xffff0000, v96
v_lshlrev_b32 v96, 16, v96
v_and_b32 v99, 0xffff0000, v98
v_lshlrev_b32_e64 v98, 16, v98
v_mul_f32 v100, 0xbfb8aa3b, v96
v_mul_f32 v101, 0xbfb8aa3b, v97
v_mul_f32 v102, 0xbfb8aa3b, v98
v_mul_f32 v103, 0xbfb8aa3b, v99
v_exp_f32 v100, v100
v_exp_f32 v101, v101
v_exp_f32 v102, v102
v_exp_f32 v103, v103
s_waitcnt lgkmcnt(0)
v_pk_add_f32 v[112:113], v[112:113], v[116:117]
v_pk_add_f32 v[114:115], v[114:115], v[118:119]
v_pk_add_f32 v[120:121], v[120:121], v[124:125]
v_pk_add_f32 v[122:123], v[122:123], v[126:127]
v_pk_add_f32 v[112:113], v[112:113], v[120:121]
v_pk_add_f32 v[114:115], v[114:115], v[122:123]
v_add_f32 v100, 1.0, v100
v_add_f32 v101, 1.0, v101
v_add_f32 v102, 1.0, v102
v_add_f32 v103, 1.0, v103
v_rcp_f32 v100, v100
v_rcp_f32 v101, v101
v_rcp_f32 v102, v102
v_rcp_f32_e64 v103, v103
v_cvt_pk_bf16_f32 v112, v112, v113
v_cvt_pk_bf16_f32 v114, v114, v115
v_and_b32 v113, 0xffff0000, v112
v_lshlrev_b32 v112, 16, v112
v_and_b32 v115, 0xffff0000, v114
v_lshlrev_b32 v114, 16, v114
v_lshlrev_b32 v104, 16, v162
v_and_b32 v105, 0xffff0000, v162
v_lshlrev_b32 v106, 16, v163
v_and_b32 v107, 0xffff0000, v163
v_pk_mul_f32 v[96:97], v[96:97], v[100:101]
v_pk_mul_f32 v[98:99], v[98:99], v[102:103]
v_cvt_pk_bf16_f32 v96, v96, v97
v_cvt_pk_bf16_f32 v98, v98, v99
v_and_b32 v97, 0xffff0000, v96
v_lshlrev_b32 v96, 16, v96
v_and_b32 v99, 0xffff0000, v98
v_lshlrev_b32 v98, 16, v98
v_pk_mul_f32 v[96:97], v[96:97], v[112:113]
v_pk_mul_f32 v[98:99], v[98:99], v[114:115]
v_cvt_pk_bf16_f32 v96, v96, v97
v_cvt_pk_bf16_f32 v98, v98, v99
v_and_b32 v97, 0xffff0000, v96
v_lshlrev_b32 v96, 16, v96
v_and_b32 v99, 0xffff0000, v98
v_lshlrev_b32 v98, 16, v98
v_pk_add_f32 v[96:97], v[96:97], v[104:105]
v_pk_add_f32 v[98:99], v[98:99], v[106:107]
v_cvt_pk_bf16_f32 v130, v96, v97
v_cvt_pk_bf16_f32 v131, v98, v99
s_mov_b32 s48, 16384
buffer_store_dwordx2 v[130:131], v4, s[32:35], s48 offen sc1
v_add_u32 v10, 120832, v6
v_add_u32 v11, 45056, v6
s_mov_b32 s49, 0
L_fin_w2:
ds_read_b32 v5, v7 offset:8
s_add_u32 s49, s49, 1
s_waitcnt lgkmcnt(0)
v_readfirstlane_b32 s50, v5
s_cmp_gt_u32 s49, 2000000
s_cbranch_scc1 L_fin_g2
s_cmp_ge_u32 s50, 8
s_cbranch_scc1 L_fin_g2
s_sleep 1
s_branch L_fin_w2
L_fin_g2:
ds_read_b128 v[96:99], v10 offset:0
ds_read_b128 v[100:103], v10 offset:4096
ds_read_b128 v[104:107], v10 offset:8192
ds_read_b128 v[108:111], v10 offset:12288
ds_read_b128 v[112:115], v11 offset:0
ds_read_b128 v[116:119], v11 offset:4096
ds_read_b128 v[120:123], v11 offset:8192
ds_read_b128 v[124:127], v11 offset:12288
s_waitcnt lgkmcnt(4)
v_pk_add_f32 v[96:97], v[96:97], v[100:101]
v_pk_add_f32 v[98:99], v[98:99], v[102:103]
v_pk_add_f32 v[104:105], v[104:105], v[108:109]
v_pk_add_f32 v[106:107], v[106:107], v[110:111]
v_pk_add_f32 v[96:97], v[96:97], v[104:105]
v_pk_add_f32 v[98:99], v[98:99], v[106:107]
v_cvt_pk_bf16_f32 v96, v96, v97
v_cvt_pk_bf16_f32 v98, v98, v99
v_and_b32 v97, 0xffff0000, v96
v_lshlrev_b32 v96, 16, v96
v_and_b32 v99, 0xffff0000, v98
v_lshlrev_b32 v98, 16, v98
v_mul_f32 v100, 0xbfb8aa3b, v96
v_mul_f32 v101, 0xbfb8aa3b, v97
v_mul_f32 v102, 0xbfb8aa3b, v98
v_mul_f32 v103, 0xbfb8aa3b, v99
v_exp_f32 v100, v100
v_exp_f32 v101, v101
v_exp_f32 v102, v102
v_exp_f32 v103, v103
s_waitcnt lgkmcnt(0)
v_pk_add_f32 v[112:113], v[112:113], v[116:117]
v_pk_add_f32 v[114:115], v[114:115], v[118:119]
v_pk_add_f32 v[120:121], v[120:121], v[124:125]
v_pk_add_f32 v[122:123], v[122:123], v[126:127]
v_pk_add_f32 v[112:113], v[112:113], v[120:121]
v_pk_add_f32 v[114:115], v[114:115], v[122:123]
v_add_f32 v100, 1.0, v100
v_add_f32 v101, 1.0, v101
v_add_f32 v102, 1.0, v102
v_add_f32 v103, 1.0, v103
v_rcp_f32 v100, v100
v_rcp_f32 v101, v101
v_rcp_f32 v102, v102
v_rcp_f32_e64 v103, v103
v_cvt_pk_bf16_f32 v112, v112, v113
v_cvt_pk_bf16_f32 v114, v114, v115
v_and_b32 v113, 0xffff0000, v112
v_lshlrev_b32 v112, 16, v112
v_and_b32 v115, 0xffff0000, v114
v_lshlrev_b32 v114, 16, v114
v_lshlrev_b32 v104, 16, v164
v_and_b32 v105, 0xffff0000, v164
v_lshlrev_b32 v106, 16, v165
v_and_b32 v107, 0xffff0000, v165
v_pk_mul_f32 v[96:97], v[96:97], v[100:101]
v_pk_mul_f32 v[98:99], v[98:99], v[102:103]
v_cvt_pk_bf16_f32 v96, v96, v97
v_cvt_pk_bf16_f32 v98, v98, v99
v_and_b32 v97, 0xffff0000, v96
v_lshlrev_b32 v96, 16, v96
v_and_b32 v99, 0xffff0000, v98
v_lshlrev_b32 v98, 16, v98
v_pk_mul_f32 v[96:97], v[96:97], v[112:113]
v_pk_mul_f32 v[98:99], v[98:99], v[114:115]
v_cvt_pk_bf16_f32 v96, v96, v97
v_cvt_pk_bf16_f32 v98, v98, v99
v_and_b32 v97, 0xffff0000, v96
v_lshlrev_b32 v96, 16, v96
v_and_b32 v99, 0xffff0000, v98
v_lshlrev_b32 v98, 16, v98
v_pk_add_f32 v[96:97], v[96:97], v[104:105]
v_pk_add_f32 v[98:99], v[98:99], v[106:107]
v_cvt_pk_bf16_f32 v132, v96, v97
v_cvt_pk_bf16_f32 v133, v98, v99
s_mov_b32 s48, 32768
buffer_store_dwordx2 v[132:133], v4, s[32:35], s48 offen sc1
L_P2_fin:
s_endpgm
L_end:
s_endpgm
.section .rodata,"a"
.p2align 6
.amdhsa_kernel recurrent_scan__sliding_local_dilated__glu_gated_glu__prompt_kernel
  .amdhsa_next_free_vgpr 256
  .amdhsa_next_free_sgpr 102
  .amdhsa_accum_offset 256
  .amdhsa_group_segment_fixed_size 0
  .amdhsa_kernarg_size 80
  .amdhsa_user_sgpr_count 2
  .amdhsa_user_sgpr_kernarg_segment_ptr 1
  .amdhsa_system_sgpr_workgroup_id_x 1
.end_amdhsa_kernel
```
